```python
import torch

def _softmax(x, axis=-1):
    return torch.softmax(x, dim=axis)

def _gelu(x):
    return torch.nn.functional.gelu(x, approximate='tanh')

def _silu(x):
    return torch.nn.functional.silu(x)

def _sigmoid(x):
    return torch.sigmoid(x)

def _layernorm(x, axis=-1, eps=1e-05):
    m = x.mean(dim=axis, keepdim=True)
    v = x.var(dim=axis, keepdim=True, unbiased=False)
    return (x - m) / torch.sqrt(v + eps)

def _scatter_add(tgt, idx, src, axis=0):
    return tgt.clone().index_add_(axis, idx, src)

def _segment_sum(src, seg, n):
    out = torch.zeros((n,) + src.shape[1:], dtype=src.dtype)
    return out.index_add_(0, seg, src)

def _pad(x, pw):
    flat = tuple((v for pair in reversed(pw) for v in pair))
    return torch.nn.functional.pad(x, flat)
kernel_name = 'adaLN_cond__spectral_fnet__dense_activation_relu__prompt'

def setup_inputs():

    _w = lambda a: (lambda t: t.to(torch.bfloat16) if t.is_floating_point() else t)(torch.as_tensor(a))

    def _A_setup():
        B, S, D = (1, 2048, 640)
        ns = torch.arange(S)[:, None] * torch.arange(S)[None, :]
        nd = torch.arange(D)[:, None] * torch.arange(D)[None, :]
        Ws_re = torch.cos(-2.0 * torch.pi * ns / S).to(float)
        Ws_im = torch.sin(-2.0 * torch.pi * ns / S).to(float)
        Wd_re = torch.cos(-2.0 * torch.pi * nd / D).to(float)
        Wd_im = torch.sin(-2.0 * torch.pi * nd / D).to(float)
        return {'x': _w((lambda *s: torch.randn(*s, dtype=torch.bfloat16) * 0.1)(B, S, D)), 'dft_seq_re': _w(Ws_re), 'dft_seq_im': _w(Ws_im), 'dft_hid_re': _w(Wd_re), 'dft_hid_im': _w(Wd_im)}
    _A_in = _A_setup()

    def _B_setup():
        B, S, D, Dff = (1, 2048, 640, 1536)
        return {'x': _w((lambda *s: torch.randn(*s, dtype=torch.bfloat16) * 0.1)(B, S, D)), 'w1': _w((lambda *s: torch.randn(*s, dtype=torch.bfloat16) * 3.2)(D, Dff)), 'w2': _w((lambda *s: torch.randn(*s, dtype=torch.bfloat16) * 3.2)(Dff, D))}
    _B_in = _B_setup()
    return {'A_x': _A_in['x'], 'A_dft_seq_re': _A_in['dft_seq_re'], 'A_dft_seq_im': _A_in['dft_seq_im'], 'A_dft_hid_re': _A_in['dft_hid_re'], 'A_dft_hid_im': _A_in['dft_hid_im'], 'B_x': _B_in['x'], 'B_w1': _B_in['w1'], 'B_w2': _B_in['w2'], 'c': _w((lambda *s: torch.randn(*s, dtype=torch.bfloat16) * 0.4)(1, 640) * 8.0), 'w_mod': _w((lambda *s: torch.randn(*s, dtype=torch.bfloat16) * 0.4)(640, 6 * 640) * 640 ** (-0.5) * 8.0)}

def reference(A_x, A_dft_seq_re, A_dft_seq_im, A_dft_hid_re, A_dft_hid_im, B_x, B_w1, B_w2, c, w_mod):

    def _A_ref(x, dft_seq_re, dft_seq_im, dft_hid_re, dft_hid_im):
        a = torch.einsum('bsd,ed->bse', x, dft_hid_re)
        b = torch.einsum('bsd,ed->bse', x, dft_hid_im)
        y = torch.einsum('ts,bse->bte', dft_seq_re, a) - torch.einsum('ts,bse->bte', dft_seq_im, b)
        return y

    def _B_ref(x, w1, w2):
        h = torch.einsum('bsd,df->bsf', x, w1)
        zero = torch.zeros_like(h)
        h = torch.maximum(h, zero)
        return torch.einsum('bsf,fd->bsd', h, w2)
    x = A_x
    mod = (_silu(c) @ w_mod).reshape(c.shape[0], 6, 1, -1)
    sa, ca, ga, sb, cb, gb = (mod[:, 0].clone(), mod[:, 1].clone(), mod[:, 2].clone(), mod[:, 3].clone(), mod[:, 4].clone(), mod[:, 5].clone())
    h = _layernorm(x, axis=-1) * (1 + ca) + sa
    x = x + ga * _A_ref(h, A_dft_seq_re, A_dft_seq_im, A_dft_hid_re, A_dft_hid_im)
    h = _layernorm(x, axis=-1) * (1 + cb) + sb
    x = x + gb * _B_ref(h, B_w1, B_w2)
    return x
```

```asm
; @launch kernel=k0_kernel grid=(1000,1,1) block=(256,1,1) lds=40960
; @launch kernel=l1_kernel grid=(256,1,1) block=(512,1,1) lds=163840
; @launch kernel=l2_kernel grid=(256,1,1) block=(512,1,1) lds=147456
; @launch kernel=l3_kernel grid=(256,1,1) block=(512,1,1) lds=147456
; @launch kernel=l4_kernel grid=(256,1,1) block=(512,1,1) lds=147456
.amdgcn_target "amdgcn-amd-amdhsa--gfx950"
.text
.globl k0_kernel
.p2align 8
.type k0_kernel,@function
k0_kernel:
    s_cmp_ge_u32 s2, 1000
    s_cbranch_scc1 k0_end
    s_load_dwordx2 s[4:5], s[0:1], 96
    s_cmp_lt_u32 s2, 120
    s_cbranch_scc1 k0_mod
    s_cmp_lt_u32 s2, 184
    s_cbranch_scc1 k0_ln
    s_cmp_ge_u32 s2, 744
    s_cbranch_scc1 k0_pf
    s_cmp_ge_u32 s2, 664
    s_cbranch_scc1 k0_cp
    s_load_dwordx2 s[6:7], s[0:1], 48
    s_load_dwordx2 s[8:9], s[0:1], 56
    s_sub_u32 s3, s2, 184
    s_waitcnt lgkmcnt(0)
    s_cmp_lt_u32 s3, 240
    s_cbranch_scc1 k0_tr_w1
    s_sub_u32 s3, s3, 240
    s_mov_b32 s12, s8
    s_mov_b32 s13, s9
    s_mov_b32 s14, 0x1e0000
    s_mov_b32 s15, 0x00020000
    s_add_u32 s16, s4, 0x600000
    s_addc_u32 s17, s5, 0
    s_mov_b32 s18, 0x1e0000
    s_mov_b32 s19, 0x00020000
    s_mul_i32 s20, s3, 6554
    s_lshr_b32 s20, s20, 16
    s_mul_i32 s21, s20, 10
    s_sub_u32 s21, s3, s21
    s_mov_b32 s22, 1280
    s_mov_b32 s23, 3072
    s_branch k0_tr_go
k0_tr_w1:
    s_mov_b32 s12, s6
    s_mov_b32 s13, s7
    s_mov_b32 s14, 0x1e0000
    s_mov_b32 s15, 0x00020000
    s_add_u32 s16, s4, 0x400000
    s_addc_u32 s17, s5, 0
    s_mov_b32 s18, 0x1e0000
    s_mov_b32 s19, 0x00020000
    s_mul_i32 s20, s3, 2731
    s_lshr_b32 s20, s20, 16
    s_mul_i32 s21, s20, 24
    s_sub_u32 s21, s3, s21
    s_mov_b32 s22, 3072
    s_mov_b32 s23, 1280
k0_tr_go:
    v_lshrrev_b32 v1, 3, v0
    v_and_b32 v2, 7, v0
    s_lshl_b32 s24, s20, 6
    v_add_u32 v3, s24, v1
    v_mul_lo_u32 v3, v3, s22
    s_lshl_b32 s25, s21, 7
    v_lshlrev_b32 v4, 4, v2
    v_add3_u32 v3, v3, v4, s25
    s_lshl_b32 s26, s22, 5
    buffer_load_dwordx4 v[8:11], v3, s[12:15], 0 offen
    buffer_load_dwordx4 v[12:15], v3, s[12:15], s26 offen
    v_mul_u32_u24 v5, 1056, v2
    v_lshl_add_u32 v5, v1, 1, v5
    s_waitcnt vmcnt(1)
    ds_write_b16 v5, v8 offset:0
    ds_write_b16_d16_hi v5, v8 offset:132
    ds_write_b16 v5, v9 offset:264
    ds_write_b16_d16_hi v5, v9 offset:396
    ds_write_b16 v5, v10 offset:528
    ds_write_b16_d16_hi v5, v10 offset:660
    ds_write_b16 v5, v11 offset:792
    ds_write_b16_d16_hi v5, v11 offset:924
    s_waitcnt vmcnt(0)
    ds_write_b16 v5, v12 offset:64
    ds_write_b16_d16_hi v5, v12 offset:196
    ds_write_b16 v5, v13 offset:328
    ds_write_b16_d16_hi v5, v13 offset:460
    ds_write_b16 v5, v14 offset:592
    ds_write_b16_d16_hi v5, v14 offset:724
    ds_write_b16 v5, v15 offset:856
    ds_write_b16_d16_hi v5, v15 offset:988
    s_waitcnt lgkmcnt(0)
    s_barrier
    v_lshrrev_b32 v1, 2, v0
    v_and_b32 v2, 3, v0
    v_mul_u32_u24 v5, 132, v1
    v_lshl_add_u32 v5, v2, 5, v5
    ds_read2_b32 v[8:9], v5 offset0:0 offset1:1
    ds_read2_b32 v[10:11], v5 offset0:2 offset1:3
    ds_read2_b32 v[12:13], v5 offset0:4 offset1:5
    ds_read2_b32 v[14:15], v5 offset0:6 offset1:7
    s_lshl_b32 s24, s21, 6
    v_add_u32 v3, s24, v1
    v_mul_lo_u32 v3, v3, s23
    s_lshl_b32 s25, s20, 7
    v_lshlrev_b32 v4, 5, v2
    v_add3_u32 v3, v3, v4, s25
    s_waitcnt lgkmcnt(0)
    buffer_store_dwordx4 v[8:11], v3, s[16:19], 0 offen
    buffer_store_dwordx4 v[12:15], v3, s[16:19], 0 offen offset:16
    s_endpgm
k0_pf:
    s_load_dwordx2 s[6:7], s[0:1], 8
    s_load_dwordx2 s[8:9], s[0:1], 16
    s_sub_u32 s3, s2, 744
    s_and_b32 s20, s3, 7
    s_lshr_b32 s21, s3, 3
    s_lshl_b32 s20, s20, 5
    s_add_u32 s3, s20, s21
    s_lshl_b32 s3, s3, 15
    v_lshlrev_b32 v1, 7, v0
    v_add_u32 v1, s3, v1
    s_waitcnt lgkmcnt(0)
    s_mov_b32 s12, s6
    s_mov_b32 s13, s7
    s_mov_b32 s14, 0x800000
    s_mov_b32 s15, 0x00020000
    s_mov_b32 s16, s8
    s_mov_b32 s17, s9
    s_mov_b32 s18, 0x800000
    s_mov_b32 s19, 0x00020000
    buffer_load_dword v2, v1, s[12:15], 0 offen
    buffer_load_dword v3, v1, s[16:19], 0 offen
    s_waitcnt vmcnt(0)
    s_endpgm
k0_cp:
    s_load_dwordx2 s[6:7], s[0:1], 24
    s_load_dwordx2 s[8:9], s[0:1], 32
    s_sub_u32 s3, s2, 664
    s_waitcnt lgkmcnt(0)
    s_cmp_ge_u32 s3, 40
    s_cselect_b32 s6, s8, s6
    s_cselect_b32 s7, s9, s7
    s_cselect_b32 s20, 1280, 0
    s_cselect_b32 s21, 40, 0
    s_sub_u32 s3, s3, s21
    s_mov_b32 s12, s6
    s_mov_b32 s13, s7
    s_mov_b32 s14, 0xc8000
    s_mov_b32 s15, 0x00020000
    s_add_u32 s16, s4, 0x1b00000
    s_addc_u32 s17, s5, 0
    s_mov_b32 s18, 0x190000
    s_mov_b32 s19, 0x00020000
    s_mul_i32 s22, s3, 16*1280
    s_mul_i32 s23, s3, 16*2560
    s_add_u32 s23, s23, s20
    s_mov_b32 s24, 52429
    v_add_u32 v1, 0, v0
    v_mul_lo_u32 v2, v1, s24
    v_lshrrev_b32 v2, 22, v2
    v_lshl_add_u32 v30, v1, 4, s22
    v_mul_u32_u24 v3, 1280, v2
    v_lshl_add_u32 v40, v1, 4, v3
    v_add_u32 v40, s23, v40
    buffer_load_dwordx4 v[8:11], v30, s[12:15], 0 offen
    v_add_u32 v1, 256, v0
    v_mul_lo_u32 v2, v1, s24
    v_lshrrev_b32 v2, 22, v2
    v_lshl_add_u32 v31, v1, 4, s22
    v_mul_u32_u24 v3, 1280, v2
    v_lshl_add_u32 v41, v1, 4, v3
    v_add_u32 v41, s23, v41
    buffer_load_dwordx4 v[12:15], v31, s[12:15], 0 offen
    v_add_u32 v1, 512, v0
    v_mul_lo_u32 v2, v1, s24
    v_lshrrev_b32 v2, 22, v2
    v_lshl_add_u32 v32, v1, 4, s22
    v_mul_u32_u24 v3, 1280, v2
    v_lshl_add_u32 v42, v1, 4, v3
    v_add_u32 v42, s23, v42
    buffer_load_dwordx4 v[16:19], v32, s[12:15], 0 offen
    v_add_u32 v1, 768, v0
    v_mul_lo_u32 v2, v1, s24
    v_lshrrev_b32 v2, 22, v2
    v_lshl_add_u32 v33, v1, 4, s22
    v_mul_u32_u24 v3, 1280, v2
    v_lshl_add_u32 v43, v1, 4, v3
    v_add_u32 v43, s23, v43
    buffer_load_dwordx4 v[20:23], v33, s[12:15], 0 offen
    v_add_u32 v1, 1024, v0
    v_mul_lo_u32 v2, v1, s24
    v_lshrrev_b32 v2, 22, v2
    v_lshl_add_u32 v34, v1, 4, s22
    v_mul_u32_u24 v3, 1280, v2
    v_lshl_add_u32 v44, v1, 4, v3
    v_add_u32 v44, s23, v44
    buffer_load_dwordx4 v[24:27], v34, s[12:15], 0 offen
    s_waitcnt vmcnt(4)
    buffer_store_dwordx4 v[8:11], v40, s[16:19], 0 offen
    s_waitcnt vmcnt(3)
    buffer_store_dwordx4 v[12:15], v41, s[16:19], 0 offen
    s_waitcnt vmcnt(2)
    buffer_store_dwordx4 v[16:19], v42, s[16:19], 0 offen
    s_waitcnt vmcnt(1)
    buffer_store_dwordx4 v[20:23], v43, s[16:19], 0 offen
    s_waitcnt vmcnt(0)
    buffer_store_dwordx4 v[24:27], v44, s[16:19], 0 offen
    s_endpgm
k0_mod:
    s_load_dwordx2 s[6:7], s[0:1], 64
    s_load_dwordx2 s[8:9], s[0:1], 72
    v_and_b32 v1, 3, v0
    v_lshrrev_b32 v2, 2, v0
    v_lshlrev_b32 v3, 1, v2
    v_mul_u32_u24 v4, 7680, v2
    v_lshl_add_u32 v4, v1, 4, v4
    s_lshl_b32 s3, s2, 6
    v_add_u32 v4, s3, v4
    s_waitcnt lgkmcnt(0)
    s_mov_b32 s12, s6
    s_mov_b32 s13, s7
    s_mov_b32 s14, 0x500
    s_mov_b32 s15, 0x00020000
    s_mov_b32 s16, s8
    s_mov_b32 s17, s9
    s_mov_b32 s18, 0x4b0000
    s_mov_b32 s19, 0x00020000
    s_mov_b32 s20, s4
    s_mov_b32 s21, s5
    s_mov_b32 s22, 0x1e00
    s_mov_b32 s23, 0x00020000
    buffer_load_ushort v10, v3, s[12:15], 0 offen offset:0
    buffer_load_ushort v11, v3, s[12:15], 0 offen offset:128
    buffer_load_ushort v12, v3, s[12:15], 0 offen offset:256
    buffer_load_ushort v13, v3, s[12:15], 0 offen offset:384
    buffer_load_ushort v14, v3, s[12:15], 0 offen offset:512
    buffer_load_ushort v15, v3, s[12:15], 0 offen offset:640
    buffer_load_ushort v16, v3, s[12:15], 0 offen offset:768
    buffer_load_ushort v17, v3, s[12:15], 0 offen offset:896
    buffer_load_ushort v18, v3, s[12:15], 0 offen offset:1024
    buffer_load_ushort v19, v3, s[12:15], 0 offen offset:1152
    s_mov_b32 s24, 0
    buffer_load_dwordx4 v[20:23], v4, s[16:19], s24 offen
    s_mov_b32 s24, 491520
    buffer_load_dwordx4 v[24:27], v4, s[16:19], s24 offen
    s_mov_b32 s24, 983040
    buffer_load_dwordx4 v[28:31], v4, s[16:19], s24 offen
    s_mov_b32 s24, 1474560
    buffer_load_dwordx4 v[32:35], v4, s[16:19], s24 offen
    s_mov_b32 s24, 1966080
    buffer_load_dwordx4 v[36:39], v4, s[16:19], s24 offen
    s_mov_b32 s24, 2457600
    buffer_load_dwordx4 v[40:43], v4, s[16:19], s24 offen
    s_mov_b32 s24, 2949120
    buffer_load_dwordx4 v[44:47], v4, s[16:19], s24 offen
    s_mov_b32 s24, 3440640
    buffer_load_dwordx4 v[48:51], v4, s[16:19], s24 offen
    s_mov_b32 s24, 3932160
    buffer_load_dwordx4 v[52:55], v4, s[16:19], s24 offen
    s_mov_b32 s24, 4423680
    buffer_load_dwordx4 v[56:59], v4, s[16:19], s24 offen
    v_mov_b32 v60, 0
    v_mov_b32 v61, 0
    v_mov_b32 v62, 0
    v_mov_b32 v63, 0
    v_mov_b32 v64, 0
    v_mov_b32 v65, 0
    v_mov_b32 v66, 0
    v_mov_b32 v67, 0
    s_waitcnt vmcnt(10)
    v_lshlrev_b32 v10, 16, v10
    v_lshlrev_b32 v11, 16, v11
    v_lshlrev_b32 v12, 16, v12
    v_lshlrev_b32 v13, 16, v13
    v_lshlrev_b32 v14, 16, v14
    v_lshlrev_b32 v15, 16, v15
    v_lshlrev_b32 v16, 16, v16
    v_lshlrev_b32 v17, 16, v17
    v_lshlrev_b32 v18, 16, v18
    v_lshlrev_b32 v19, 16, v19
    v_mul_f32 v70, 0xbfb8aa3b, v10
    v_mul_f32 v71, 0xbfb8aa3b, v11
    v_mul_f32 v72, 0xbfb8aa3b, v12
    v_mul_f32 v73, 0xbfb8aa3b, v13
    v_mul_f32 v74, 0xbfb8aa3b, v14
    v_mul_f32 v75, 0xbfb8aa3b, v15
    v_mul_f32 v76, 0xbfb8aa3b, v16
    v_mul_f32 v77, 0xbfb8aa3b, v17
    v_mul_f32 v78, 0xbfb8aa3b, v18
    v_mul_f32 v79, 0xbfb8aa3b, v19
    v_exp_f32 v70, v70
    v_exp_f32 v71, v71
    v_exp_f32 v72, v72
    v_exp_f32 v73, v73
    v_exp_f32 v74, v74
    v_exp_f32 v75, v75
    v_exp_f32 v76, v76
    v_exp_f32 v77, v77
    v_exp_f32 v78, v78
    v_exp_f32 v79, v79
    s_nop 0
    v_add_f32 v70, 1.0, v70
    v_add_f32 v71, 1.0, v71
    v_add_f32 v72, 1.0, v72
    v_add_f32 v73, 1.0, v73
    v_add_f32 v74, 1.0, v74
    v_add_f32 v75, 1.0, v75
    v_add_f32 v76, 1.0, v76
    v_add_f32 v77, 1.0, v77
    v_add_f32 v78, 1.0, v78
    v_add_f32 v79, 1.0, v79
    v_rcp_f32 v70, v70
    v_rcp_f32 v71, v71
    v_rcp_f32 v72, v72
    v_rcp_f32 v73, v73
    v_rcp_f32 v74, v74
    v_rcp_f32 v75, v75
    v_rcp_f32 v76, v76
    v_rcp_f32 v77, v77
    v_rcp_f32 v78, v78
    v_rcp_f32 v79, v79
    s_nop 0
    v_mul_f32 v10, v10, v70
    v_mul_f32 v11, v11, v71
    v_mul_f32 v12, v12, v72
    v_mul_f32 v13, v13, v73
    v_mul_f32 v14, v14, v74
    v_mul_f32 v15, v15, v75
    v_mul_f32 v16, v16, v76
    v_mul_f32 v17, v17, v77
    v_mul_f32 v18, v18, v78
    v_mul_f32 v19, v19, v79
    v_cvt_pk_bf16_f32 v10, v10, v10
    v_cvt_pk_bf16_f32 v11, v11, v11
    v_cvt_pk_bf16_f32 v12, v12, v12
    v_cvt_pk_bf16_f32 v13, v13, v13
    v_cvt_pk_bf16_f32 v14, v14, v14
    v_cvt_pk_bf16_f32 v15, v15, v15
    v_cvt_pk_bf16_f32 v16, v16, v16
    v_cvt_pk_bf16_f32 v17, v17, v17
    v_cvt_pk_bf16_f32 v18, v18, v18
    v_cvt_pk_bf16_f32 v19, v19, v19
    v_lshlrev_b32 v10, 16, v10
    v_lshlrev_b32 v11, 16, v11
    v_lshlrev_b32 v12, 16, v12
    v_lshlrev_b32 v13, 16, v13
    v_lshlrev_b32 v14, 16, v14
    v_lshlrev_b32 v15, 16, v15
    v_lshlrev_b32 v16, 16, v16
    v_lshlrev_b32 v17, 16, v17
    v_lshlrev_b32 v18, 16, v18
    v_lshlrev_b32 v19, 16, v19
    s_waitcnt vmcnt(9)
    v_lshlrev_b32 v70, 16, v20
    v_and_b32 v71, 0xffff0000, v20
    v_fmac_f32 v60, v10, v70
    v_fmac_f32 v61, v10, v71
    v_lshlrev_b32 v70, 16, v21
    v_and_b32 v71, 0xffff0000, v21
    v_fmac_f32 v62, v10, v70
    v_fmac_f32 v63, v10, v71
    v_lshlrev_b32 v70, 16, v22
    v_and_b32 v71, 0xffff0000, v22
    v_fmac_f32 v64, v10, v70
    v_fmac_f32 v65, v10, v71
    v_lshlrev_b32 v70, 16, v23
    v_and_b32 v71, 0xffff0000, v23
    v_fmac_f32 v66, v10, v70
    v_fmac_f32 v67, v10, v71
    s_waitcnt vmcnt(8)
    v_lshlrev_b32 v70, 16, v24
    v_and_b32 v71, 0xffff0000, v24
    v_fmac_f32 v60, v11, v70
    v_fmac_f32 v61, v11, v71
    v_lshlrev_b32 v70, 16, v25
    v_and_b32 v71, 0xffff0000, v25
    v_fmac_f32 v62, v11, v70
    v_fmac_f32 v63, v11, v71
    v_lshlrev_b32 v70, 16, v26
    v_and_b32 v71, 0xffff0000, v26
    v_fmac_f32 v64, v11, v70
    v_fmac_f32 v65, v11, v71
    v_lshlrev_b32 v70, 16, v27
    v_and_b32 v71, 0xffff0000, v27
    v_fmac_f32 v66, v11, v70
    v_fmac_f32 v67, v11, v71
    s_waitcnt vmcnt(7)
    v_lshlrev_b32 v70, 16, v28
    v_and_b32 v71, 0xffff0000, v28
    v_fmac_f32 v60, v12, v70
    v_fmac_f32 v61, v12, v71
    v_lshlrev_b32 v70, 16, v29
    v_and_b32 v71, 0xffff0000, v29
    v_fmac_f32 v62, v12, v70
    v_fmac_f32 v63, v12, v71
    v_lshlrev_b32 v70, 16, v30
    v_and_b32 v71, 0xffff0000, v30
    v_fmac_f32 v64, v12, v70
    v_fmac_f32 v65, v12, v71
    v_lshlrev_b32 v70, 16, v31
    v_and_b32 v71, 0xffff0000, v31
    v_fmac_f32 v66, v12, v70
    v_fmac_f32 v67, v12, v71
    s_waitcnt vmcnt(6)
    v_lshlrev_b32 v70, 16, v32
    v_and_b32 v71, 0xffff0000, v32
    v_fmac_f32 v60, v13, v70
    v_fmac_f32 v61, v13, v71
    v_lshlrev_b32 v70, 16, v33
    v_and_b32 v71, 0xffff0000, v33
    v_fmac_f32 v62, v13, v70
    v_fmac_f32 v63, v13, v71
    v_lshlrev_b32 v70, 16, v34
    v_and_b32 v71, 0xffff0000, v34
    v_fmac_f32 v64, v13, v70
    v_fmac_f32 v65, v13, v71
    v_lshlrev_b32 v70, 16, v35
    v_and_b32 v71, 0xffff0000, v35
    v_fmac_f32 v66, v13, v70
    v_fmac_f32 v67, v13, v71
    s_waitcnt vmcnt(5)
    v_lshlrev_b32 v70, 16, v36
    v_and_b32 v71, 0xffff0000, v36
    v_fmac_f32 v60, v14, v70
    v_fmac_f32 v61, v14, v71
    v_lshlrev_b32 v70, 16, v37
    v_and_b32 v71, 0xffff0000, v37
    v_fmac_f32 v62, v14, v70
    v_fmac_f32 v63, v14, v71
    v_lshlrev_b32 v70, 16, v38
    v_and_b32 v71, 0xffff0000, v38
    v_fmac_f32 v64, v14, v70
    v_fmac_f32 v65, v14, v71
    v_lshlrev_b32 v70, 16, v39
    v_and_b32 v71, 0xffff0000, v39
    v_fmac_f32 v66, v14, v70
    v_fmac_f32 v67, v14, v71
    s_waitcnt vmcnt(4)
    v_lshlrev_b32 v70, 16, v40
    v_and_b32 v71, 0xffff0000, v40
    v_fmac_f32 v60, v15, v70
    v_fmac_f32 v61, v15, v71
    v_lshlrev_b32 v70, 16, v41
    v_and_b32 v71, 0xffff0000, v41
    v_fmac_f32 v62, v15, v70
    v_fmac_f32 v63, v15, v71
    v_lshlrev_b32 v70, 16, v42
    v_and_b32 v71, 0xffff0000, v42
    v_fmac_f32 v64, v15, v70
    v_fmac_f32 v65, v15, v71
    v_lshlrev_b32 v70, 16, v43
    v_and_b32 v71, 0xffff0000, v43
    v_fmac_f32 v66, v15, v70
    v_fmac_f32 v67, v15, v71
    s_waitcnt vmcnt(3)
    v_lshlrev_b32 v70, 16, v44
    v_and_b32 v71, 0xffff0000, v44
    v_fmac_f32 v60, v16, v70
    v_fmac_f32 v61, v16, v71
    v_lshlrev_b32 v70, 16, v45
    v_and_b32 v71, 0xffff0000, v45
    v_fmac_f32 v62, v16, v70
    v_fmac_f32 v63, v16, v71
    v_lshlrev_b32 v70, 16, v46
    v_and_b32 v71, 0xffff0000, v46
    v_fmac_f32 v64, v16, v70
    v_fmac_f32 v65, v16, v71
    v_lshlrev_b32 v70, 16, v47
    v_and_b32 v71, 0xffff0000, v47
    v_fmac_f32 v66, v16, v70
    v_fmac_f32 v67, v16, v71
    s_waitcnt vmcnt(2)
    v_lshlrev_b32 v70, 16, v48
    v_and_b32 v71, 0xffff0000, v48
    v_fmac_f32 v60, v17, v70
    v_fmac_f32 v61, v17, v71
    v_lshlrev_b32 v70, 16, v49
    v_and_b32 v71, 0xffff0000, v49
    v_fmac_f32 v62, v17, v70
    v_fmac_f32 v63, v17, v71
    v_lshlrev_b32 v70, 16, v50
    v_and_b32 v71, 0xffff0000, v50
    v_fmac_f32 v64, v17, v70
    v_fmac_f32 v65, v17, v71
    v_lshlrev_b32 v70, 16, v51
    v_and_b32 v71, 0xffff0000, v51
    v_fmac_f32 v66, v17, v70
    v_fmac_f32 v67, v17, v71
    s_waitcnt vmcnt(1)
    v_lshlrev_b32 v70, 16, v52
    v_and_b32 v71, 0xffff0000, v52
    v_fmac_f32 v60, v18, v70
    v_fmac_f32 v61, v18, v71
    v_lshlrev_b32 v70, 16, v53
    v_and_b32 v71, 0xffff0000, v53
    v_fmac_f32 v62, v18, v70
    v_fmac_f32 v63, v18, v71
    v_lshlrev_b32 v70, 16, v54
    v_and_b32 v71, 0xffff0000, v54
    v_fmac_f32 v64, v18, v70
    v_fmac_f32 v65, v18, v71
    v_lshlrev_b32 v70, 16, v55
    v_and_b32 v71, 0xffff0000, v55
    v_fmac_f32 v66, v18, v70
    v_fmac_f32 v67, v18, v71
    s_waitcnt vmcnt(0)
    v_lshlrev_b32 v70, 16, v56
    v_and_b32 v71, 0xffff0000, v56
    v_fmac_f32 v60, v19, v70
    v_fmac_f32 v61, v19, v71
    v_lshlrev_b32 v70, 16, v57
    v_and_b32 v71, 0xffff0000, v57
    v_fmac_f32 v62, v19, v70
    v_fmac_f32 v63, v19, v71
    v_lshlrev_b32 v70, 16, v58
    v_and_b32 v71, 0xffff0000, v58
    v_fmac_f32 v64, v19, v70
    v_fmac_f32 v65, v19, v71
    v_lshlrev_b32 v70, 16, v59
    v_and_b32 v71, 0xffff0000, v59
    v_fmac_f32 v66, v19, v70
    v_fmac_f32 v67, v19, v71
    v_lshlrev_b32 v5, 7, v2
    v_lshl_add_u32 v5, v1, 5, v5
    ds_write_b128 v5, v[60:63]
    ds_write_b128 v5, v[64:67] offset:16
    s_waitcnt lgkmcnt(0)
    s_barrier
    v_and_b32 v1, 31, v0
    v_lshrrev_b32 v2, 5, v0
    v_lshlrev_b32 v5, 10, v2
    v_lshl_add_u32 v5, v1, 2, v5
    ds_read_b32 v10, v5 offset:0
    ds_read_b32 v11, v5 offset:128
    ds_read_b32 v12, v5 offset:256
    ds_read_b32 v13, v5 offset:384
    ds_read_b32 v14, v5 offset:512
    ds_read_b32 v15, v5 offset:640
    ds_read_b32 v16, v5 offset:768
    ds_read_b32 v17, v5 offset:896
    s_waitcnt lgkmcnt(0)
    v_add_f32 v10, v10, v11
    v_add_f32 v10, v10, v12
    v_add_f32 v10, v10, v13
    v_add_f32 v10, v10, v14
    v_add_f32 v10, v10, v15
    v_add_f32 v10, v10, v16
    v_add_f32 v10, v10, v17
    v_lshlrev_b32 v5, 7, v2
    v_lshl_add_u32 v5, v1, 2, v5
    ds_write_b32 v5, v10 offset:8192
    s_waitcnt lgkmcnt(0)
    s_barrier
    v_cmp_gt_u32 vcc, 32, v0
    s_and_saveexec_b64 s[26:27], vcc
    s_cbranch_execz k0_end
    v_lshlrev_b32 v5, 2, v0
    ds_read_b32 v10, v5 offset:8192
    ds_read_b32 v11, v5 offset:8320
    ds_read_b32 v12, v5 offset:8448
    ds_read_b32 v13, v5 offset:8576
    ds_read_b32 v14, v5 offset:8704
    ds_read_b32 v15, v5 offset:8832
    ds_read_b32 v16, v5 offset:8960
    ds_read_b32 v17, v5 offset:9088
    s_waitcnt lgkmcnt(0)
    v_add_f32 v10, v10, v11
    v_add_f32 v10, v10, v12
    v_add_f32 v10, v10, v13
    v_add_f32 v10, v10, v14
    v_add_f32 v10, v10, v15
    v_add_f32 v10, v10, v16
    v_add_f32 v10, v10, v17
    v_cvt_pk_bf16_f32 v10, v10, v10
    s_lshl_b32 s3, s2, 6
    v_lshl_add_u32 v5, v0, 1, s3
    buffer_store_short v10, v5, s[20:23], 0 offen
    s_endpgm
k0_ln:
    s_load_dwordx2 s[6:7], s[0:1], 0
    s_sub_u32 s3, s2, 120
    v_and_b32 v1, 15, v0
    v_lshrrev_b32 v2, 4, v0
    s_mul_i32 s24, s3, 32*1280
    v_mul_u32_u24 v3, 2560, v2
    v_lshl_add_u32 v3, v1, 4, v3
    v_add_u32 v3, s24, v3
    s_waitcnt lgkmcnt(0)
    s_mov_b32 s12, s6
    s_mov_b32 s13, s7
    s_mov_b32 s14, 0x280000
    s_mov_b32 s15, 0x00020000
    s_add_u32 s16, s4, 0x100000
    s_addc_u32 s17, s5, 0
    s_mov_b32 s18, 0x280000
    s_mov_b32 s19, 0x00020000
    buffer_load_dwordx4 v[50:53], v3, s[12:15], 0 offen offset:0
    buffer_load_dwordx4 v[54:57], v3, s[12:15], 0 offen offset:256
    buffer_load_dwordx4 v[58:61], v3, s[12:15], 0 offen offset:512
    buffer_load_dwordx4 v[62:65], v3, s[12:15], 0 offen offset:768
    buffer_load_dwordx4 v[66:69], v3, s[12:15], 0 offen offset:1024
    buffer_load_dwordx4 v[70:73], v3, s[12:15], 0 offen offset:1280
    buffer_load_dwordx4 v[74:77], v3, s[12:15], 0 offen offset:1536
    buffer_load_dwordx4 v[78:81], v3, s[12:15], 0 offen offset:1792
    buffer_load_dwordx4 v[82:85], v3, s[12:15], 0 offen offset:2048
    buffer_load_dwordx4 v[86:89], v3, s[12:15], 0 offen offset:2304
    s_waitcnt vmcnt(0)
    v_lshlrev_b32 v10, 16, v50
    v_and_b32 v11, 0xffff0000, v50
    v_lshlrev_b32 v12, 16, v51
    v_and_b32 v13, 0xffff0000, v51
    v_lshlrev_b32 v14, 16, v52
    v_and_b32 v15, 0xffff0000, v52
    v_lshlrev_b32 v16, 16, v53
    v_and_b32 v17, 0xffff0000, v53
    v_lshlrev_b32 v18, 16, v54
    v_and_b32 v19, 0xffff0000, v54
    v_lshlrev_b32 v20, 16, v55
    v_and_b32 v21, 0xffff0000, v55
    v_lshlrev_b32 v22, 16, v56
    v_and_b32 v23, 0xffff0000, v56
    v_lshlrev_b32 v24, 16, v57
    v_and_b32 v25, 0xffff0000, v57
    v_lshlrev_b32 v26, 16, v58
    v_and_b32 v27, 0xffff0000, v58
    v_lshlrev_b32 v28, 16, v59
    v_and_b32 v29, 0xffff0000, v59
    v_lshlrev_b32 v30, 16, v60
    v_and_b32 v31, 0xffff0000, v60
    v_lshlrev_b32 v32, 16, v61
    v_and_b32 v33, 0xffff0000, v61
    v_lshlrev_b32 v34, 16, v62
    v_and_b32 v35, 0xffff0000, v62
    v_lshlrev_b32 v36, 16, v63
    v_and_b32 v37, 0xffff0000, v63
    v_lshlrev_b32 v38, 16, v64
    v_and_b32 v39, 0xffff0000, v64
    v_lshlrev_b32 v40, 16, v65
    v_and_b32 v41, 0xffff0000, v65
    v_lshlrev_b32 v42, 16, v66
    v_and_b32 v43, 0xffff0000, v66
    v_lshlrev_b32 v44, 16, v67
    v_and_b32 v45, 0xffff0000, v67
    v_lshlrev_b32 v46, 16, v68
    v_and_b32 v47, 0xffff0000, v68
    v_lshlrev_b32 v48, 16, v69
    v_and_b32 v49, 0xffff0000, v69
    v_lshlrev_b32 v50, 16, v70
    v_and_b32 v51, 0xffff0000, v70
    v_lshlrev_b32 v52, 16, v71
    v_and_b32 v53, 0xffff0000, v71
    v_lshlrev_b32 v54, 16, v72
    v_and_b32 v55, 0xffff0000, v72
    v_lshlrev_b32 v56, 16, v73
    v_and_b32 v57, 0xffff0000, v73
    v_lshlrev_b32 v58, 16, v74
    v_and_b32 v59, 0xffff0000, v74
    v_lshlrev_b32 v60, 16, v75
    v_and_b32 v61, 0xffff0000, v75
    v_lshlrev_b32 v62, 16, v76
    v_and_b32 v63, 0xffff0000, v76
    v_lshlrev_b32 v64, 16, v77
    v_and_b32 v65, 0xffff0000, v77
    v_lshlrev_b32 v66, 16, v78
    v_and_b32 v67, 0xffff0000, v78
    v_lshlrev_b32 v68, 16, v79
    v_and_b32 v69, 0xffff0000, v79
    v_lshlrev_b32 v70, 16, v80
    v_and_b32 v71, 0xffff0000, v80
    v_lshlrev_b32 v72, 16, v81
    v_and_b32 v73, 0xffff0000, v81
    v_lshlrev_b32 v74, 16, v82
    v_and_b32 v75, 0xffff0000, v82
    v_lshlrev_b32 v76, 16, v83
    v_and_b32 v77, 0xffff0000, v83
    v_lshlrev_b32 v78, 16, v84
    v_and_b32 v79, 0xffff0000, v84
    v_lshlrev_b32 v80, 16, v85
    v_and_b32 v81, 0xffff0000, v85
    v_lshlrev_b32 v82, 16, v86
    v_and_b32 v83, 0xffff0000, v86
    v_lshlrev_b32 v84, 16, v87
    v_and_b32 v85, 0xffff0000, v87
    v_lshlrev_b32 v86, 16, v88
    v_and_b32 v87, 0xffff0000, v88
    v_lshlrev_b32 v88, 16, v89
    v_and_b32 v89, 0xffff0000, v89
    v_add_f32 v90, v10, v11
    v_add_f32 v91, v12, v13
    v_add_f32 v90, v90, v14
    v_add_f32 v91, v91, v15
    v_add_f32 v90, v90, v16
    v_add_f32 v91, v91, v17
    v_add_f32 v90, v90, v18
    v_add_f32 v91, v91, v19
    v_add_f32 v90, v90, v20
    v_add_f32 v91, v91, v21
    v_add_f32 v90, v90, v22
    v_add_f32 v91, v91, v23
    v_add_f32 v90, v90, v24
    v_add_f32 v91, v91, v25
    v_add_f32 v90, v90, v26
    v_add_f32 v91, v91, v27
    v_add_f32 v90, v90, v28
    v_add_f32 v91, v91, v29
    v_add_f32 v90, v90, v30
    v_add_f32 v91, v91, v31
    v_add_f32 v90, v90, v32
    v_add_f32 v91, v91, v33
    v_add_f32 v90, v90, v34
    v_add_f32 v91, v91, v35
    v_add_f32 v90, v90, v36
    v_add_f32 v91, v91, v37
    v_add_f32 v90, v90, v38
    v_add_f32 v91, v91, v39
    v_add_f32 v90, v90, v40
    v_add_f32 v91, v91, v41
    v_add_f32 v90, v90, v42
    v_add_f32 v91, v91, v43
    v_add_f32 v90, v90, v44
    v_add_f32 v91, v91, v45
    v_add_f32 v90, v90, v46
    v_add_f32 v91, v91, v47
    v_add_f32 v90, v90, v48
    v_add_f32 v91, v91, v49
    v_add_f32 v90, v90, v91
    s_nop 1
    v_add_f32_dpp v91, v90, v90 row_ror:8 row_mask:0xf bank_mask:0xf
    v_mov_b32 v90, v91
    s_nop 1
    v_add_f32_dpp v91, v90, v90 row_ror:4 row_mask:0xf bank_mask:0xf
    v_mov_b32 v90, v91
    s_nop 1
    v_add_f32_dpp v91, v90, v90 row_ror:2 row_mask:0xf bank_mask:0xf
    v_mov_b32 v90, v91
    s_nop 1
    v_add_f32_dpp v91, v90, v90 row_ror:1 row_mask:0xf bank_mask:0xf
    v_mov_b32 v90, v91
    v_mul_f32 v90, 0x3acccccd, v90
    v_mov_b32 v92, 0
    v_mov_b32 v93, 0
    v_sub_f32 v94, v10, v90
    v_sub_f32 v95, v11, v90
    v_fmac_f32 v92, v94, v94
    v_fmac_f32 v93, v95, v95
    v_sub_f32 v94, v12, v90
    v_sub_f32 v95, v13, v90
    v_fmac_f32 v92, v94, v94
    v_fmac_f32 v93, v95, v95
    v_sub_f32 v94, v14, v90
    v_sub_f32 v95, v15, v90
    v_fmac_f32 v92, v94, v94
    v_fmac_f32 v93, v95, v95
    v_sub_f32 v94, v16, v90
    v_sub_f32 v95, v17, v90
    v_fmac_f32 v92, v94, v94
    v_fmac_f32 v93, v95, v95
    v_sub_f32 v94, v18, v90
    v_sub_f32 v95, v19, v90
    v_fmac_f32 v92, v94, v94
    v_fmac_f32 v93, v95, v95
    v_sub_f32 v94, v20, v90
    v_sub_f32 v95, v21, v90
    v_fmac_f32 v92, v94, v94
    v_fmac_f32 v93, v95, v95
    v_sub_f32 v94, v22, v90
    v_sub_f32 v95, v23, v90
    v_fmac_f32 v92, v94, v94
    v_fmac_f32 v93, v95, v95
    v_sub_f32 v94, v24, v90
    v_sub_f32 v95, v25, v90
    v_fmac_f32 v92, v94, v94
    v_fmac_f32 v93, v95, v95
    v_sub_f32 v94, v26, v90
    v_sub_f32 v95, v27, v90
    v_fmac_f32 v92, v94, v94
    v_fmac_f32 v93, v95, v95
    v_sub_f32 v94, v28, v90
    v_sub_f32 v95, v29, v90
    v_fmac_f32 v92, v94, v94
    v_fmac_f32 v93, v95, v95
    v_sub_f32 v94, v30, v90
    v_sub_f32 v95, v31, v90
    v_fmac_f32 v92, v94, v94
    v_fmac_f32 v93, v95, v95
    v_sub_f32 v94, v32, v90
    v_sub_f32 v95, v33, v90
    v_fmac_f32 v92, v94, v94
    v_fmac_f32 v93, v95, v95
    v_sub_f32 v94, v34, v90
    v_sub_f32 v95, v35, v90
    v_fmac_f32 v92, v94, v94
    v_fmac_f32 v93, v95, v95
    v_sub_f32 v94, v36, v90
    v_sub_f32 v95, v37, v90
    v_fmac_f32 v92, v94, v94
    v_fmac_f32 v93, v95, v95
    v_sub_f32 v94, v38, v90
    v_sub_f32 v95, v39, v90
    v_fmac_f32 v92, v94, v94
    v_fmac_f32 v93, v95, v95
    v_sub_f32 v94, v40, v90
    v_sub_f32 v95, v41, v90
    v_fmac_f32 v92, v94, v94
    v_fmac_f32 v93, v95, v95
    v_sub_f32 v94, v42, v90
    v_sub_f32 v95, v43, v90
    v_fmac_f32 v92, v94, v94
    v_fmac_f32 v93, v95, v95
    v_sub_f32 v94, v44, v90
    v_sub_f32 v95, v45, v90
    v_fmac_f32 v92, v94, v94
    v_fmac_f32 v93, v95, v95
    v_sub_f32 v94, v46, v90
    v_sub_f32 v95, v47, v90
    v_fmac_f32 v92, v94, v94
    v_fmac_f32 v93, v95, v95
    v_sub_f32 v94, v48, v90
    v_sub_f32 v95, v49, v90
    v_fmac_f32 v92, v94, v94
    v_fmac_f32 v93, v95, v95
    v_add_f32 v92, v92, v93
    s_nop 1
    v_add_f32_dpp v93, v92, v92 row_ror:8 row_mask:0xf bank_mask:0xf
    v_mov_b32 v92, v93
    s_nop 1
    v_add_f32_dpp v93, v92, v92 row_ror:4 row_mask:0xf bank_mask:0xf
    v_mov_b32 v92, v93
    s_nop 1
    v_add_f32_dpp v93, v92, v92 row_ror:2 row_mask:0xf bank_mask:0xf
    v_mov_b32 v92, v93
    s_nop 1
    v_add_f32_dpp v93, v92, v92 row_ror:1 row_mask:0xf bank_mask:0xf
    v_mov_b32 v92, v93
    v_mul_f32 v92, 0x3acccccd, v92
    v_cvt_pk_bf16_f32 v93, v90, v92
    v_lshlrev_b32 v90, 16, v93
    v_and_b32 v92, 0xffff0000, v93
    v_add_f32 v92, 0x3727c5ac, v92
    v_cvt_pk_bf16_f32 v92, v92, v92
    v_lshlrev_b32 v92, 16, v92
    v_sqrt_f32 v92, v92
    s_nop 0
    v_cvt_pk_bf16_f32 v92, v92, v92
    v_lshlrev_b32 v92, 16, v92
    v_rcp_f32 v92, v92
    s_nop 0
    v_add_f32 v98, v50, v51
    v_add_f32 v99, v52, v53
    v_add_f32 v98, v98, v54
    v_add_f32 v99, v99, v55
    v_add_f32 v98, v98, v56
    v_add_f32 v99, v99, v57
    v_add_f32 v98, v98, v58
    v_add_f32 v99, v99, v59
    v_add_f32 v98, v98, v60
    v_add_f32 v99, v99, v61
    v_add_f32 v98, v98, v62
    v_add_f32 v99, v99, v63
    v_add_f32 v98, v98, v64
    v_add_f32 v99, v99, v65
    v_add_f32 v98, v98, v66
    v_add_f32 v99, v99, v67
    v_add_f32 v98, v98, v68
    v_add_f32 v99, v99, v69
    v_add_f32 v98, v98, v70
    v_add_f32 v99, v99, v71
    v_add_f32 v98, v98, v72
    v_add_f32 v99, v99, v73
    v_add_f32 v98, v98, v74
    v_add_f32 v99, v99, v75
    v_add_f32 v98, v98, v76
    v_add_f32 v99, v99, v77
    v_add_f32 v98, v98, v78
    v_add_f32 v99, v99, v79
    v_add_f32 v98, v98, v80
    v_add_f32 v99, v99, v81
    v_add_f32 v98, v98, v82
    v_add_f32 v99, v99, v83
    v_add_f32 v98, v98, v84
    v_add_f32 v99, v99, v85
    v_add_f32 v98, v98, v86
    v_add_f32 v99, v99, v87
    v_add_f32 v98, v98, v88
    v_add_f32 v99, v99, v89
    v_add_f32 v98, v98, v99
    s_nop 1
    v_add_f32_dpp v99, v98, v98 row_ror:8 row_mask:0xf bank_mask:0xf
    v_mov_b32 v98, v99
    s_nop 1
    v_add_f32_dpp v99, v98, v98 row_ror:4 row_mask:0xf bank_mask:0xf
    v_mov_b32 v98, v99
    s_nop 1
    v_add_f32_dpp v99, v98, v98 row_ror:2 row_mask:0xf bank_mask:0xf
    v_mov_b32 v98, v99
    s_nop 1
    v_add_f32_dpp v99, v98, v98 row_ror:1 row_mask:0xf bank_mask:0xf
    v_mov_b32 v98, v99
    v_mul_f32 v98, 0x3acccccd, v98
    v_mov_b32 v100, 0
    v_mov_b32 v101, 0
    v_sub_f32 v102, v50, v98
    v_sub_f32 v103, v51, v98
    v_fmac_f32 v100, v102, v102
    v_fmac_f32 v101, v103, v103
    v_sub_f32 v102, v52, v98
    v_sub_f32 v103, v53, v98
    v_fmac_f32 v100, v102, v102
    v_fmac_f32 v101, v103, v103
    v_sub_f32 v102, v54, v98
    v_sub_f32 v103, v55, v98
    v_fmac_f32 v100, v102, v102
    v_fmac_f32 v101, v103, v103
    v_sub_f32 v102, v56, v98
    v_sub_f32 v103, v57, v98
    v_fmac_f32 v100, v102, v102
    v_fmac_f32 v101, v103, v103
    v_sub_f32 v102, v58, v98
    v_sub_f32 v103, v59, v98
    v_fmac_f32 v100, v102, v102
    v_fmac_f32 v101, v103, v103
    v_sub_f32 v102, v60, v98
    v_sub_f32 v103, v61, v98
    v_fmac_f32 v100, v102, v102
    v_fmac_f32 v101, v103, v103
    v_sub_f32 v102, v62, v98
    v_sub_f32 v103, v63, v98
    v_fmac_f32 v100, v102, v102
    v_fmac_f32 v101, v103, v103
    v_sub_f32 v102, v64, v98
    v_sub_f32 v103, v65, v98
    v_fmac_f32 v100, v102, v102
    v_fmac_f32 v101, v103, v103
    v_sub_f32 v102, v66, v98
    v_sub_f32 v103, v67, v98
    v_fmac_f32 v100, v102, v102
    v_fmac_f32 v101, v103, v103
    v_sub_f32 v102, v68, v98
    v_sub_f32 v103, v69, v98
    v_fmac_f32 v100, v102, v102
    v_fmac_f32 v101, v103, v103
    v_sub_f32 v102, v70, v98
    v_sub_f32 v103, v71, v98
    v_fmac_f32 v100, v102, v102
    v_fmac_f32 v101, v103, v103
    v_sub_f32 v102, v72, v98
    v_sub_f32 v103, v73, v98
    v_fmac_f32 v100, v102, v102
    v_fmac_f32 v101, v103, v103
    v_sub_f32 v102, v74, v98
    v_sub_f32 v103, v75, v98
    v_fmac_f32 v100, v102, v102
    v_fmac_f32 v101, v103, v103
    v_sub_f32 v102, v76, v98
    v_sub_f32 v103, v77, v98
    v_fmac_f32 v100, v102, v102
    v_fmac_f32 v101, v103, v103
    v_sub_f32 v102, v78, v98
    v_sub_f32 v103, v79, v98
    v_fmac_f32 v100, v102, v102
    v_fmac_f32 v101, v103, v103
    v_sub_f32 v102, v80, v98
    v_sub_f32 v103, v81, v98
    v_fmac_f32 v100, v102, v102
    v_fmac_f32 v101, v103, v103
    v_sub_f32 v102, v82, v98
    v_sub_f32 v103, v83, v98
    v_fmac_f32 v100, v102, v102
    v_fmac_f32 v101, v103, v103
    v_sub_f32 v102, v84, v98
    v_sub_f32 v103, v85, v98
    v_fmac_f32 v100, v102, v102
    v_fmac_f32 v101, v103, v103
    v_sub_f32 v102, v86, v98
    v_sub_f32 v103, v87, v98
    v_fmac_f32 v100, v102, v102
    v_fmac_f32 v101, v103, v103
    v_sub_f32 v102, v88, v98
    v_sub_f32 v103, v89, v98
    v_fmac_f32 v100, v102, v102
    v_fmac_f32 v101, v103, v103
    v_add_f32 v100, v100, v101
    s_nop 1
    v_add_f32_dpp v101, v100, v100 row_ror:8 row_mask:0xf bank_mask:0xf
    v_mov_b32 v100, v101
    s_nop 1
    v_add_f32_dpp v101, v100, v100 row_ror:4 row_mask:0xf bank_mask:0xf
    v_mov_b32 v100, v101
    s_nop 1
    v_add_f32_dpp v101, v100, v100 row_ror:2 row_mask:0xf bank_mask:0xf
    v_mov_b32 v100, v101
    s_nop 1
    v_add_f32_dpp v101, v100, v100 row_ror:1 row_mask:0xf bank_mask:0xf
    v_mov_b32 v100, v101
    v_mul_f32 v100, 0x3acccccd, v100
    v_cvt_pk_bf16_f32 v101, v98, v100
    v_lshlrev_b32 v98, 16, v101
    v_and_b32 v100, 0xffff0000, v101
    v_add_f32 v100, 0x3727c5ac, v100
    v_cvt_pk_bf16_f32 v100, v100, v100
    v_lshlrev_b32 v100, 16, v100
    v_sqrt_f32 v100, v100
    s_nop 0
    v_cvt_pk_bf16_f32 v100, v100, v100
    v_lshlrev_b32 v100, 16, v100
    v_rcp_f32 v100, v100
    s_nop 0
    v_lshrrev_b32 v4, 2, v2
    v_and_b32 v5, 3, v1
    v_xor_b32 v4, v4, v5
    v_lshlrev_b32 v4, 4, v4
    v_and_b32 v5, 3, v2
    v_lshl_add_u32 v4, v5, 2, v4
    v_lshl_add_u32 v4, v1, 9, v4
    v_sub_f32 v106, v10, v90
    v_sub_f32 v107, v50, v98
    v_cvt_pk_bf16_f32 v108, v106, v107
    v_lshlrev_b32 v106, 16, v108
    v_and_b32 v107, 0xffff0000, v108
    v_mul_f32 v106, v106, v92
    v_mul_f32 v107, v107, v100
    v_cvt_pk_bf16_f32 v109, v106, v107
    ds_write_b32 v4, v109 offset:0
    v_sub_f32 v110, v11, v90
    v_sub_f32 v111, v51, v98
    v_cvt_pk_bf16_f32 v112, v110, v111
    v_lshlrev_b32 v110, 16, v112
    v_and_b32 v111, 0xffff0000, v112
    v_mul_f32 v110, v110, v92
    v_mul_f32 v111, v111, v100
    v_cvt_pk_bf16_f32 v113, v110, v111
    ds_write_b32 v4, v113 offset:64
    v_sub_f32 v114, v12, v90
    v_sub_f32 v115, v52, v98
    v_cvt_pk_bf16_f32 v116, v114, v115
    v_lshlrev_b32 v114, 16, v116
    v_and_b32 v115, 0xffff0000, v116
    v_mul_f32 v114, v114, v92
    v_mul_f32 v115, v115, v100
    v_cvt_pk_bf16_f32 v117, v114, v115
    ds_write_b32 v4, v117 offset:128
    v_sub_f32 v118, v13, v90
    v_sub_f32 v119, v53, v98
    v_cvt_pk_bf16_f32 v120, v118, v119
    v_lshlrev_b32 v118, 16, v120
    v_and_b32 v119, 0xffff0000, v120
    v_mul_f32 v118, v118, v92
    v_mul_f32 v119, v119, v100
    v_cvt_pk_bf16_f32 v121, v118, v119
    ds_write_b32 v4, v121 offset:192
    v_sub_f32 v106, v14, v90
    v_sub_f32 v107, v54, v98
    v_cvt_pk_bf16_f32 v108, v106, v107
    v_lshlrev_b32 v106, 16, v108
    v_and_b32 v107, 0xffff0000, v108
    v_mul_f32 v106, v106, v92
    v_mul_f32 v107, v107, v100
    v_cvt_pk_bf16_f32 v109, v106, v107
    ds_write_b32 v4, v109 offset:256
    v_sub_f32 v110, v15, v90
    v_sub_f32 v111, v55, v98
    v_cvt_pk_bf16_f32 v112, v110, v111
    v_lshlrev_b32 v110, 16, v112
    v_and_b32 v111, 0xffff0000, v112
    v_mul_f32 v110, v110, v92
    v_mul_f32 v111, v111, v100
    v_cvt_pk_bf16_f32 v113, v110, v111
    ds_write_b32 v4, v113 offset:320
    v_sub_f32 v114, v16, v90
    v_sub_f32 v115, v56, v98
    v_cvt_pk_bf16_f32 v116, v114, v115
    v_lshlrev_b32 v114, 16, v116
    v_and_b32 v115, 0xffff0000, v116
    v_mul_f32 v114, v114, v92
    v_mul_f32 v115, v115, v100
    v_cvt_pk_bf16_f32 v117, v114, v115
    ds_write_b32 v4, v117 offset:384
    v_sub_f32 v118, v17, v90
    v_sub_f32 v119, v57, v98
    v_cvt_pk_bf16_f32 v120, v118, v119
    v_lshlrev_b32 v118, 16, v120
    v_and_b32 v119, 0xffff0000, v120
    v_mul_f32 v118, v118, v92
    v_mul_f32 v119, v119, v100
    v_cvt_pk_bf16_f32 v121, v118, v119
    ds_write_b32 v4, v121 offset:448
    v_sub_f32 v106, v18, v90
    v_sub_f32 v107, v58, v98
    v_cvt_pk_bf16_f32 v108, v106, v107
    v_lshlrev_b32 v106, 16, v108
    v_and_b32 v107, 0xffff0000, v108
    v_mul_f32 v106, v106, v92
    v_mul_f32 v107, v107, v100
    v_cvt_pk_bf16_f32 v109, v106, v107
    ds_write_b32 v4, v109 offset:8192
    v_sub_f32 v110, v19, v90
    v_sub_f32 v111, v59, v98
    v_cvt_pk_bf16_f32 v112, v110, v111
    v_lshlrev_b32 v110, 16, v112
    v_and_b32 v111, 0xffff0000, v112
    v_mul_f32 v110, v110, v92
    v_mul_f32 v111, v111, v100
    v_cvt_pk_bf16_f32 v113, v110, v111
    ds_write_b32 v4, v113 offset:8256
    v_sub_f32 v114, v20, v90
    v_sub_f32 v115, v60, v98
    v_cvt_pk_bf16_f32 v116, v114, v115
    v_lshlrev_b32 v114, 16, v116
    v_and_b32 v115, 0xffff0000, v116
    v_mul_f32 v114, v114, v92
    v_mul_f32 v115, v115, v100
    v_cvt_pk_bf16_f32 v117, v114, v115
    ds_write_b32 v4, v117 offset:8320
    v_sub_f32 v118, v21, v90
    v_sub_f32 v119, v61, v98
    v_cvt_pk_bf16_f32 v120, v118, v119
    v_lshlrev_b32 v118, 16, v120
    v_and_b32 v119, 0xffff0000, v120
    v_mul_f32 v118, v118, v92
    v_mul_f32 v119, v119, v100
    v_cvt_pk_bf16_f32 v121, v118, v119
    ds_write_b32 v4, v121 offset:8384
    v_sub_f32 v106, v22, v90
    v_sub_f32 v107, v62, v98
    v_cvt_pk_bf16_f32 v108, v106, v107
    v_lshlrev_b32 v106, 16, v108
    v_and_b32 v107, 0xffff0000, v108
    v_mul_f32 v106, v106, v92
    v_mul_f32 v107, v107, v100
    v_cvt_pk_bf16_f32 v109, v106, v107
    ds_write_b32 v4, v109 offset:8448
    v_sub_f32 v110, v23, v90
    v_sub_f32 v111, v63, v98
    v_cvt_pk_bf16_f32 v112, v110, v111
    v_lshlrev_b32 v110, 16, v112
    v_and_b32 v111, 0xffff0000, v112
    v_mul_f32 v110, v110, v92
    v_mul_f32 v111, v111, v100
    v_cvt_pk_bf16_f32 v113, v110, v111
    ds_write_b32 v4, v113 offset:8512
    v_sub_f32 v114, v24, v90
    v_sub_f32 v115, v64, v98
    v_cvt_pk_bf16_f32 v116, v114, v115
    v_lshlrev_b32 v114, 16, v116
    v_and_b32 v115, 0xffff0000, v116
    v_mul_f32 v114, v114, v92
    v_mul_f32 v115, v115, v100
    v_cvt_pk_bf16_f32 v117, v114, v115
    ds_write_b32 v4, v117 offset:8576
    v_sub_f32 v118, v25, v90
    v_sub_f32 v119, v65, v98
    v_cvt_pk_bf16_f32 v120, v118, v119
    v_lshlrev_b32 v118, 16, v120
    v_and_b32 v119, 0xffff0000, v120
    v_mul_f32 v118, v118, v92
    v_mul_f32 v119, v119, v100
    v_cvt_pk_bf16_f32 v121, v118, v119
    ds_write_b32 v4, v121 offset:8640
    v_sub_f32 v106, v26, v90
    v_sub_f32 v107, v66, v98
    v_cvt_pk_bf16_f32 v108, v106, v107
    v_lshlrev_b32 v106, 16, v108
    v_and_b32 v107, 0xffff0000, v108
    v_mul_f32 v106, v106, v92
    v_mul_f32 v107, v107, v100
    v_cvt_pk_bf16_f32 v109, v106, v107
    ds_write_b32 v4, v109 offset:16384
    v_sub_f32 v110, v27, v90
    v_sub_f32 v111, v67, v98
    v_cvt_pk_bf16_f32 v112, v110, v111
    v_lshlrev_b32 v110, 16, v112
    v_and_b32 v111, 0xffff0000, v112
    v_mul_f32 v110, v110, v92
    v_mul_f32 v111, v111, v100
    v_cvt_pk_bf16_f32 v113, v110, v111
    ds_write_b32 v4, v113 offset:16448
    v_sub_f32 v114, v28, v90
    v_sub_f32 v115, v68, v98
    v_cvt_pk_bf16_f32 v116, v114, v115
    v_lshlrev_b32 v114, 16, v116
    v_and_b32 v115, 0xffff0000, v116
    v_mul_f32 v114, v114, v92
    v_mul_f32 v115, v115, v100
    v_cvt_pk_bf16_f32 v117, v114, v115
    ds_write_b32 v4, v117 offset:16512
    v_sub_f32 v118, v29, v90
    v_sub_f32 v119, v69, v98
    v_cvt_pk_bf16_f32 v120, v118, v119
    v_lshlrev_b32 v118, 16, v120
    v_and_b32 v119, 0xffff0000, v120
    v_mul_f32 v118, v118, v92
    v_mul_f32 v119, v119, v100
    v_cvt_pk_bf16_f32 v121, v118, v119
    ds_write_b32 v4, v121 offset:16576
    v_sub_f32 v106, v30, v90
    v_sub_f32 v107, v70, v98
    v_cvt_pk_bf16_f32 v108, v106, v107
    v_lshlrev_b32 v106, 16, v108
    v_and_b32 v107, 0xffff0000, v108
    v_mul_f32 v106, v106, v92
    v_mul_f32 v107, v107, v100
    v_cvt_pk_bf16_f32 v109, v106, v107
    ds_write_b32 v4, v109 offset:16640
    v_sub_f32 v110, v31, v90
    v_sub_f32 v111, v71, v98
    v_cvt_pk_bf16_f32 v112, v110, v111
    v_lshlrev_b32 v110, 16, v112
    v_and_b32 v111, 0xffff0000, v112
    v_mul_f32 v110, v110, v92
    v_mul_f32 v111, v111, v100
    v_cvt_pk_bf16_f32 v113, v110, v111
    ds_write_b32 v4, v113 offset:16704
    v_sub_f32 v114, v32, v90
    v_sub_f32 v115, v72, v98
    v_cvt_pk_bf16_f32 v116, v114, v115
    v_lshlrev_b32 v114, 16, v116
    v_and_b32 v115, 0xffff0000, v116
    v_mul_f32 v114, v114, v92
    v_mul_f32 v115, v115, v100
    v_cvt_pk_bf16_f32 v117, v114, v115
    ds_write_b32 v4, v117 offset:16768
    v_sub_f32 v118, v33, v90
    v_sub_f32 v119, v73, v98
    v_cvt_pk_bf16_f32 v120, v118, v119
    v_lshlrev_b32 v118, 16, v120
    v_and_b32 v119, 0xffff0000, v120
    v_mul_f32 v118, v118, v92
    v_mul_f32 v119, v119, v100
    v_cvt_pk_bf16_f32 v121, v118, v119
    ds_write_b32 v4, v121 offset:16832
    v_sub_f32 v106, v34, v90
    v_sub_f32 v107, v74, v98
    v_cvt_pk_bf16_f32 v108, v106, v107
    v_lshlrev_b32 v106, 16, v108
    v_and_b32 v107, 0xffff0000, v108
    v_mul_f32 v106, v106, v92
    v_mul_f32 v107, v107, v100
    v_cvt_pk_bf16_f32 v109, v106, v107
    ds_write_b32 v4, v109 offset:24576
    v_sub_f32 v110, v35, v90
    v_sub_f32 v111, v75, v98
    v_cvt_pk_bf16_f32 v112, v110, v111
    v_lshlrev_b32 v110, 16, v112
    v_and_b32 v111, 0xffff0000, v112
    v_mul_f32 v110, v110, v92
    v_mul_f32 v111, v111, v100
    v_cvt_pk_bf16_f32 v113, v110, v111
    ds_write_b32 v4, v113 offset:24640
    v_sub_f32 v114, v36, v90
    v_sub_f32 v115, v76, v98
    v_cvt_pk_bf16_f32 v116, v114, v115
    v_lshlrev_b32 v114, 16, v116
    v_and_b32 v115, 0xffff0000, v116
    v_mul_f32 v114, v114, v92
    v_mul_f32 v115, v115, v100
    v_cvt_pk_bf16_f32 v117, v114, v115
    ds_write_b32 v4, v117 offset:24704
    v_sub_f32 v118, v37, v90
    v_sub_f32 v119, v77, v98
    v_cvt_pk_bf16_f32 v120, v118, v119
    v_lshlrev_b32 v118, 16, v120
    v_and_b32 v119, 0xffff0000, v120
    v_mul_f32 v118, v118, v92
    v_mul_f32 v119, v119, v100
    v_cvt_pk_bf16_f32 v121, v118, v119
    ds_write_b32 v4, v121 offset:24768
    v_sub_f32 v106, v38, v90
    v_sub_f32 v107, v78, v98
    v_cvt_pk_bf16_f32 v108, v106, v107
    v_lshlrev_b32 v106, 16, v108
    v_and_b32 v107, 0xffff0000, v108
    v_mul_f32 v106, v106, v92
    v_mul_f32 v107, v107, v100
    v_cvt_pk_bf16_f32 v109, v106, v107
    ds_write_b32 v4, v109 offset:24832
    v_sub_f32 v110, v39, v90
    v_sub_f32 v111, v79, v98
    v_cvt_pk_bf16_f32 v112, v110, v111
    v_lshlrev_b32 v110, 16, v112
    v_and_b32 v111, 0xffff0000, v112
    v_mul_f32 v110, v110, v92
    v_mul_f32 v111, v111, v100
    v_cvt_pk_bf16_f32 v113, v110, v111
    ds_write_b32 v4, v113 offset:24896
    v_sub_f32 v114, v40, v90
    v_sub_f32 v115, v80, v98
    v_cvt_pk_bf16_f32 v116, v114, v115
    v_lshlrev_b32 v114, 16, v116
    v_and_b32 v115, 0xffff0000, v116
    v_mul_f32 v114, v114, v92
    v_mul_f32 v115, v115, v100
    v_cvt_pk_bf16_f32 v117, v114, v115
    ds_write_b32 v4, v117 offset:24960
    v_sub_f32 v118, v41, v90
    v_sub_f32 v119, v81, v98
    v_cvt_pk_bf16_f32 v120, v118, v119
    v_lshlrev_b32 v118, 16, v120
    v_and_b32 v119, 0xffff0000, v120
    v_mul_f32 v118, v118, v92
    v_mul_f32 v119, v119, v100
    v_cvt_pk_bf16_f32 v121, v118, v119
    ds_write_b32 v4, v121 offset:25024
    v_sub_f32 v106, v42, v90
    v_sub_f32 v107, v82, v98
    v_cvt_pk_bf16_f32 v108, v106, v107
    v_lshlrev_b32 v106, 16, v108
    v_and_b32 v107, 0xffff0000, v108
    v_mul_f32 v106, v106, v92
    v_mul_f32 v107, v107, v100
    v_cvt_pk_bf16_f32 v109, v106, v107
    ds_write_b32 v4, v109 offset:32768
    v_sub_f32 v110, v43, v90
    v_sub_f32 v111, v83, v98
    v_cvt_pk_bf16_f32 v112, v110, v111
    v_lshlrev_b32 v110, 16, v112
    v_and_b32 v111, 0xffff0000, v112
    v_mul_f32 v110, v110, v92
    v_mul_f32 v111, v111, v100
    v_cvt_pk_bf16_f32 v113, v110, v111
    ds_write_b32 v4, v113 offset:32832
    v_sub_f32 v114, v44, v90
    v_sub_f32 v115, v84, v98
    v_cvt_pk_bf16_f32 v116, v114, v115
    v_lshlrev_b32 v114, 16, v116
    v_and_b32 v115, 0xffff0000, v116
    v_mul_f32 v114, v114, v92
    v_mul_f32 v115, v115, v100
    v_cvt_pk_bf16_f32 v117, v114, v115
    ds_write_b32 v4, v117 offset:32896
    v_sub_f32 v118, v45, v90
    v_sub_f32 v119, v85, v98
    v_cvt_pk_bf16_f32 v120, v118, v119
    v_lshlrev_b32 v118, 16, v120
    v_and_b32 v119, 0xffff0000, v120
    v_mul_f32 v118, v118, v92
    v_mul_f32 v119, v119, v100
    v_cvt_pk_bf16_f32 v121, v118, v119
    ds_write_b32 v4, v121 offset:32960
    v_sub_f32 v106, v46, v90
    v_sub_f32 v107, v86, v98
    v_cvt_pk_bf16_f32 v108, v106, v107
    v_lshlrev_b32 v106, 16, v108
    v_and_b32 v107, 0xffff0000, v108
    v_mul_f32 v106, v106, v92
    v_mul_f32 v107, v107, v100
    v_cvt_pk_bf16_f32 v109, v106, v107
    ds_write_b32 v4, v109 offset:33024
    v_sub_f32 v110, v47, v90
    v_sub_f32 v111, v87, v98
    v_cvt_pk_bf16_f32 v112, v110, v111
    v_lshlrev_b32 v110, 16, v112
    v_and_b32 v111, 0xffff0000, v112
    v_mul_f32 v110, v110, v92
    v_mul_f32 v111, v111, v100
    v_cvt_pk_bf16_f32 v113, v110, v111
    ds_write_b32 v4, v113 offset:33088
    v_sub_f32 v114, v48, v90
    v_sub_f32 v115, v88, v98
    v_cvt_pk_bf16_f32 v116, v114, v115
    v_lshlrev_b32 v114, 16, v116
    v_and_b32 v115, 0xffff0000, v116
    v_mul_f32 v114, v114, v92
    v_mul_f32 v115, v115, v100
    v_cvt_pk_bf16_f32 v117, v114, v115
    ds_write_b32 v4, v117 offset:33152
    v_sub_f32 v118, v49, v90
    v_sub_f32 v119, v89, v98
    v_cvt_pk_bf16_f32 v120, v118, v119
    v_lshlrev_b32 v118, 16, v120
    v_and_b32 v119, 0xffff0000, v120
    v_mul_f32 v118, v118, v92
    v_mul_f32 v119, v119, v100
    v_cvt_pk_bf16_f32 v121, v118, v119
    ds_write_b32 v4, v121 offset:33216
    s_waitcnt lgkmcnt(0)
    s_barrier
    v_lshlrev_b32 v4, 4, v0
    ds_read_b128 v[10:13], v4 offset:0
    ds_read_b128 v[14:17], v4 offset:4096
    ds_read_b128 v[18:21], v4 offset:8192
    ds_read_b128 v[22:25], v4 offset:12288
    ds_read_b128 v[26:29], v4 offset:16384
    ds_read_b128 v[30:33], v4 offset:20480
    ds_read_b128 v[34:37], v4 offset:24576
    ds_read_b128 v[38:41], v4 offset:28672
    ds_read_b128 v[42:45], v4 offset:32768
    ds_read_b128 v[46:49], v4 offset:36864
    v_lshrrev_b32 v5, 5, v0
    v_xor_b32 v5, v5, v0
    v_and_b32 v5, 3, v5
    v_lshrrev_b32 v6, 2, v0
    v_lshlrev_b32 v6, 12, v6
    v_lshl_add_u32 v6, v5, 4, v6
    s_lshl_b32 s24, s3, 6
    v_add_u32 v6, s24, v6
    s_mov_b32 s25, 0
    s_waitcnt lgkmcnt(9)
    buffer_store_dwordx4 v[10:13], v6, s[16:19], s25 offen
    s_mov_b32 s25, 262144
    s_waitcnt lgkmcnt(8)
    buffer_store_dwordx4 v[14:17], v6, s[16:19], s25 offen
    s_mov_b32 s25, 524288
    s_waitcnt lgkmcnt(7)
    buffer_store_dwordx4 v[18:21], v6, s[16:19], s25 offen
    s_mov_b32 s25, 786432
    s_waitcnt lgkmcnt(6)
    buffer_store_dwordx4 v[22:25], v6, s[16:19], s25 offen
    s_mov_b32 s25, 1048576
    s_waitcnt lgkmcnt(5)
    buffer_store_dwordx4 v[26:29], v6, s[16:19], s25 offen
    s_mov_b32 s25, 1310720
    s_waitcnt lgkmcnt(4)
    buffer_store_dwordx4 v[30:33], v6, s[16:19], s25 offen
    s_mov_b32 s25, 1572864
    s_waitcnt lgkmcnt(3)
    buffer_store_dwordx4 v[34:37], v6, s[16:19], s25 offen
    s_mov_b32 s25, 1835008
    s_waitcnt lgkmcnt(2)
    buffer_store_dwordx4 v[38:41], v6, s[16:19], s25 offen
    s_mov_b32 s25, 2097152
    s_waitcnt lgkmcnt(1)
    buffer_store_dwordx4 v[42:45], v6, s[16:19], s25 offen
    s_mov_b32 s25, 2359296
    s_waitcnt lgkmcnt(0)
    buffer_store_dwordx4 v[46:49], v6, s[16:19], s25 offen
k0_end:
    s_endpgm
.globl l1_kernel
.p2align 8
.type l1_kernel,@function
l1_kernel:
    s_cmp_ge_u32 s2, 256
    s_cbranch_scc1 l1_kernel_end
    s_load_dwordx2 s[4:5], s[0:1], 96
    s_load_dwordx2 s[30:31], s[0:1], 8
    s_load_dwordx2 s[32:33], s[0:1], 16
    v_lshrrev_b32 v4, 6, v0
    v_and_b32 v1, 63, v0
    v_and_b32 v2, 15, v0
    v_readfirstlane_b32 s40, v4
    v_lshrrev_b32 v3, 4, v1
    s_and_b32 s41, s2, 7
    s_lshr_b32 s42, s2, 3
    s_lshr_b32 s43, s42, 3
    s_mul_i32 s41, s41, 4
    s_add_u32 s41, s41, s43
    s_and_b32 s42, s42, 7
    s_mul_i32 s44, s42, 80
    s_mov_b32 s45, s40
    s_mov_b32 s46, 0
    s_and_b32 s41, s2, 7
    s_lshl_b32 s41, s41, 1
    s_and_b32 s47, s43, 1
    s_add_u32 s41, s41, s47
    s_lshr_b32 s47, s43, 1
    s_lshl_b32 s47, s47, 4
    s_add_u32 s41, s41, s47
    s_and_b32 s47, s41, 15
    s_lshl_b32 s47, s47, 7
    s_mov_b32 s39, s47
    s_cmp_ge_u32 s40, 4
    s_cbranch_scc1 l1_kernel_prod
    s_waitcnt lgkmcnt(0)
    s_cmp_ge_u32 s41, 16
    s_cselect_b32 s30, s32, s30
    s_cselect_b32 s31, s33, s31
    s_mov_b32 s8, s30
    s_mov_b32 s9, s31
    s_mov_b32 s10, 0x800000
    s_mov_b32 s11, 0x00020000
    s_add_u32 s12, s4, 0x100000
    s_addc_u32 s13, s5, 0
    s_mov_b32 s14, 0x280000
    s_mov_b32 s15, 0x00020000
    s_cmp_ge_u32 s41, 16
    s_cselect_b32 s35, 0x80000000, 0
    s_cselect_b32 s36, 1280, 0
    s_mov_b32 s20, s4
    s_mov_b32 s21, s5
    s_mov_b32 s22, 0x1e00
    s_mov_b32 s23, 0x00020000
    s_add_u32 s24, s4, 0x800000
    s_addc_u32 s25, s5, 0
    s_mov_b32 s26, 0x500000
    s_mov_b32 s27, 0x00020000
    v_lshrrev_b32 v4, 1, v2
    v_xor_b32 v4, v3, v4
    s_mul_i32 s53, s46, 16384
    s_mul_i32 s56, s45, 4096
    s_add_u32 s53, s53, s56
    s_mul_i32 s56, s46, 10240
    s_add_u32 s56, s56, 16384
    v_xor_b32 v5, 0, v4
    v_lshlrev_b32 v5, 4, v5
    v_lshl_add_u32 v5, v2, 7, v5
    v_add_u32 v7, s53, v5
    v_add_u32 v19, s56, v5
    v_add_u32 v9, 26624, v7
    v_add_u32 v21, 26624, v19
    v_add_u32 v11, 53248, v7
    v_add_u32 v23, 53248, v19
    v_add_u32 v13, 79872, v7
    v_add_u32 v25, 79872, v19
    v_add_u32 v15, 106496, v7
    v_add_u32 v27, 106496, v19
    v_add_u32 v17, 133120, v7
    v_add_u32 v29, 133120, v19
    v_xor_b32 v5, 4, v4
    v_lshlrev_b32 v5, 4, v5
    v_lshl_add_u32 v5, v2, 7, v5
    v_add_u32 v8, s53, v5
    v_add_u32 v20, s56, v5
    v_add_u32 v10, 26624, v8
    v_add_u32 v22, 26624, v20
    v_add_u32 v12, 53248, v8
    v_add_u32 v24, 53248, v20
    v_add_u32 v14, 79872, v8
    v_add_u32 v26, 79872, v20
    v_add_u32 v16, 106496, v8
    v_add_u32 v28, 106496, v20
    v_add_u32 v18, 133120, v8
    v_add_u32 v30, 133120, v20
    v_mov_b32 v164, 0x3f803f80
    v_mov_b32 v165, 0x3f803f80
    v_mov_b32 v166, 0x3f803f80
    v_mov_b32 v167, 0x3f803f80
    v_mov_b32 v156, 0
    v_mov_b32 v157, 0
    v_mov_b32 v158, 0
    v_mov_b32 v159, 0
    v_mov_b32 v160, 0
    v_mov_b32 v161, 0
    v_mov_b32 v162, 0
    v_mov_b32 v163, 0
    v_mov_b32 v116, 0
    v_mov_b32 v117, 0
    v_mov_b32 v118, 0
    v_mov_b32 v119, 0
    v_mov_b32 v120, 0
    v_mov_b32 v121, 0
    v_mov_b32 v122, 0
    v_mov_b32 v123, 0
    v_mov_b32 v124, 0
    v_mov_b32 v125, 0
    v_mov_b32 v126, 0
    v_mov_b32 v127, 0
    v_mov_b32 v128, 0
    v_mov_b32 v129, 0
    v_mov_b32 v130, 0
    v_mov_b32 v131, 0
    v_mov_b32 v132, 0
    v_mov_b32 v133, 0
    v_mov_b32 v134, 0
    v_mov_b32 v135, 0
    v_mov_b32 v136, 0
    v_mov_b32 v137, 0
    v_mov_b32 v138, 0
    v_mov_b32 v139, 0
    v_mov_b32 v140, 0
    v_mov_b32 v141, 0
    v_mov_b32 v142, 0
    v_mov_b32 v143, 0
    v_mov_b32 v144, 0
    v_mov_b32 v145, 0
    v_mov_b32 v146, 0
    v_mov_b32 v147, 0
    v_mov_b32 v148, 0
    v_mov_b32 v149, 0
    v_mov_b32 v150, 0
    v_mov_b32 v151, 0
    v_mov_b32 v152, 0
    v_mov_b32 v153, 0
    v_mov_b32 v154, 0
    v_mov_b32 v155, 0
    s_lshl_b32 s60, s44, 1
    v_lshl_add_u32 v168, v3, 3, s60
    s_mov_b32 s61, 1280
    buffer_load_dwordx2 v[180:181], v168, s[20:23], 0 offen offset:0
    buffer_load_dwordx2 v[182:183], v168, s[20:23], 0 offen offset:32
    buffer_load_dwordx2 v[184:185], v168, s[20:23], 0 offen offset:64
    buffer_load_dwordx2 v[186:187], v168, s[20:23], 0 offen offset:96
    buffer_load_dwordx2 v[188:189], v168, s[20:23], 0 offen offset:128
    buffer_load_dwordx2 v[200:201], v168, s[20:23], s61 offen offset:0
    buffer_load_dwordx2 v[202:203], v168, s[20:23], s61 offen offset:32
    buffer_load_dwordx2 v[204:205], v168, s[20:23], s61 offen offset:64
    buffer_load_dwordx2 v[206:207], v168, s[20:23], s61 offen offset:96
    buffer_load_dwordx2 v[208:209], v168, s[20:23], s61 offen offset:128
    s_lshl_b32 s38, s45, 5
    s_add_u32 s38, s38, s39
    s_mul_i32 s57, s40, 5632
    s_lshl_b32 s58, s44, 1
    s_mov_b32 s59, 2560
    v_add_u32 v4, 0, v1
    v_mul_u32_u24 v5, 6554, v4
    v_lshrrev_b32 v5, 16, v5
    v_mul_u32_u24 v6, 10, v5
    v_sub_u32 v6, v4, v6
    v_lshlrev_b32 v6, 4, v6
    v_mul_u32_u24 v211, 176, v5
    v_add3_u32 v211, v211, v6, s57
    v_add_u32 v221, s58, v6
    v_add_u32 v5, s38, v5
    v_mul_lo_u32 v216, v5, s59
    v_add_u32 v216, v216, v221
    v_add_u32 v4, 64, v1
    v_mul_u32_u24 v5, 6554, v4
    v_lshrrev_b32 v5, 16, v5
    v_mul_u32_u24 v6, 10, v5
    v_sub_u32 v6, v4, v6
    v_lshlrev_b32 v6, 4, v6
    v_mul_u32_u24 v212, 176, v5
    v_add3_u32 v212, v212, v6, s57
    v_add_u32 v222, s58, v6
    v_add_u32 v5, s38, v5
    v_mul_lo_u32 v217, v5, s59
    v_add_u32 v217, v217, v222
    v_add_u32 v4, 128, v1
    v_mul_u32_u24 v5, 6554, v4
    v_lshrrev_b32 v5, 16, v5
    v_mul_u32_u24 v6, 10, v5
    v_sub_u32 v6, v4, v6
    v_lshlrev_b32 v6, 4, v6
    v_mul_u32_u24 v213, 176, v5
    v_add3_u32 v213, v213, v6, s57
    v_add_u32 v223, s58, v6
    v_add_u32 v5, s38, v5
    v_mul_lo_u32 v218, v5, s59
    v_add_u32 v218, v218, v223
    v_add_u32 v4, 192, v1
    v_mul_u32_u24 v5, 6554, v4
    v_lshrrev_b32 v5, 16, v5
    v_mul_u32_u24 v6, 10, v5
    v_sub_u32 v6, v4, v6
    v_lshlrev_b32 v6, 4, v6
    v_mul_u32_u24 v214, 176, v5
    v_add3_u32 v214, v214, v6, s57
    v_add_u32 v224, s58, v6
    v_add_u32 v5, s38, v5
    v_mul_lo_u32 v219, v5, s59
    v_add_u32 v219, v219, v224
    v_add_u32 v4, 256, v1
    v_mul_u32_u24 v5, 6554, v4
    v_lshrrev_b32 v5, 16, v5
    v_mul_u32_u24 v6, 10, v5
    v_sub_u32 v6, v4, v6
    v_lshlrev_b32 v6, 4, v6
    v_mul_u32_u24 v215, 176, v5
    v_add3_u32 v215, v215, v6, s57
    v_add_u32 v225, s58, v6
    v_add_u32 v5, s38, v5
    v_mul_lo_u32 v220, v5, s59
    v_add_u32 v220, v220, v225
    v_mul_u32_u24 v226, 176, v2
    v_lshl_add_u32 v226, v3, 3, v226
    v_add_u32 v226, s57, v226
    s_barrier
    ds_read_b128 v[32:35], v7 offset:0
    ds_read_b128 v[48:51], v19 offset:0
    ds_read_b128 v[52:55], v19 offset:2048
    ds_read_b128 v[56:59], v19 offset:4096
    ds_read_b128 v[60:63], v19 offset:6144
    ds_read_b128 v[64:67], v19 offset:8192
    ds_read_b128 v[36:39], v7 offset:2048
    s_waitcnt lgkmcnt(0)
    v_mfma_f32_16x16x32_bf16 v[116:119], v[48:51], v[32:35], v[116:119]
    ds_read_b128 v[40:43], v8 offset:0
    v_mfma_f32_16x16x32_bf16 v[120:123], v[52:55], v[32:35], v[120:123]
    ds_read_b128 v[68:71], v20 offset:0
    v_mfma_f32_16x16x32_bf16 v[124:127], v[56:59], v[32:35], v[124:127]
    ds_read_b128 v[72:75], v20 offset:2048
    v_mfma_f32_16x16x32_bf16 v[128:131], v[60:63], v[32:35], v[128:131]
    ds_read_b128 v[76:79], v20 offset:4096
    v_mfma_f32_16x16x32_bf16 v[132:135], v[64:67], v[32:35], v[132:135]
    ds_read_b128 v[80:83], v20 offset:6144
    v_mfma_f32_16x16x32_bf16 v[156:159], v[164:167], v[32:35], v[156:159]
    ds_read_b128 v[84:87], v20 offset:8192
    v_mfma_f32_16x16x32_bf16 v[136:139], v[48:51], v[36:39], v[136:139]
    ds_read_b128 v[44:47], v8 offset:2048
    v_mfma_f32_16x16x32_bf16 v[140:143], v[52:55], v[36:39], v[140:143]
    v_mfma_f32_16x16x32_bf16 v[144:147], v[56:59], v[36:39], v[144:147]
    v_mfma_f32_16x16x32_bf16 v[148:151], v[60:63], v[36:39], v[148:151]
    v_mfma_f32_16x16x32_bf16 v[152:155], v[64:67], v[36:39], v[152:155]
    v_mfma_f32_16x16x32_bf16 v[160:163], v[164:167], v[36:39], v[160:163]
    s_waitcnt lgkmcnt(0)
    s_barrier
    v_mfma_f32_16x16x32_bf16 v[116:119], v[68:71], v[40:43], v[116:119]
    ds_read_b128 v[32:35], v9 offset:0
    v_mfma_f32_16x16x32_bf16 v[120:123], v[72:75], v[40:43], v[120:123]
    ds_read_b128 v[48:51], v21 offset:0
    v_mfma_f32_16x16x32_bf16 v[124:127], v[76:79], v[40:43], v[124:127]
    ds_read_b128 v[52:55], v21 offset:2048
    v_mfma_f32_16x16x32_bf16 v[128:131], v[80:83], v[40:43], v[128:131]
    ds_read_b128 v[56:59], v21 offset:4096
    v_mfma_f32_16x16x32_bf16 v[132:135], v[84:87], v[40:43], v[132:135]
    ds_read_b128 v[60:63], v21 offset:6144
    v_mfma_f32_16x16x32_bf16 v[156:159], v[164:167], v[40:43], v[156:159]
    ds_read_b128 v[64:67], v21 offset:8192
    v_mfma_f32_16x16x32_bf16 v[136:139], v[68:71], v[44:47], v[136:139]
    ds_read_b128 v[36:39], v9 offset:2048
    v_mfma_f32_16x16x32_bf16 v[140:143], v[72:75], v[44:47], v[140:143]
    v_mfma_f32_16x16x32_bf16 v[144:147], v[76:79], v[44:47], v[144:147]
    v_mfma_f32_16x16x32_bf16 v[148:151], v[80:83], v[44:47], v[148:151]
    v_mfma_f32_16x16x32_bf16 v[152:155], v[84:87], v[44:47], v[152:155]
    v_mfma_f32_16x16x32_bf16 v[160:163], v[164:167], v[44:47], v[160:163]
    s_waitcnt lgkmcnt(0)
    v_mfma_f32_16x16x32_bf16 v[116:119], v[48:51], v[32:35], v[116:119]
    ds_read_b128 v[40:43], v10 offset:0
    v_mfma_f32_16x16x32_bf16 v[120:123], v[52:55], v[32:35], v[120:123]
    ds_read_b128 v[68:71], v22 offset:0
    v_mfma_f32_16x16x32_bf16 v[124:127], v[56:59], v[32:35], v[124:127]
    ds_read_b128 v[72:75], v22 offset:2048
    v_mfma_f32_16x16x32_bf16 v[128:131], v[60:63], v[32:35], v[128:131]
    ds_read_b128 v[76:79], v22 offset:4096
    v_mfma_f32_16x16x32_bf16 v[132:135], v[64:67], v[32:35], v[132:135]
    ds_read_b128 v[80:83], v22 offset:6144
    v_mfma_f32_16x16x32_bf16 v[156:159], v[164:167], v[32:35], v[156:159]
    ds_read_b128 v[84:87], v22 offset:8192
    v_mfma_f32_16x16x32_bf16 v[136:139], v[48:51], v[36:39], v[136:139]
    ds_read_b128 v[44:47], v10 offset:2048
    v_mfma_f32_16x16x32_bf16 v[140:143], v[52:55], v[36:39], v[140:143]
    v_mfma_f32_16x16x32_bf16 v[144:147], v[56:59], v[36:39], v[144:147]
    v_mfma_f32_16x16x32_bf16 v[148:151], v[60:63], v[36:39], v[148:151]
    v_mfma_f32_16x16x32_bf16 v[152:155], v[64:67], v[36:39], v[152:155]
    v_mfma_f32_16x16x32_bf16 v[160:163], v[164:167], v[36:39], v[160:163]
    s_waitcnt lgkmcnt(0)
    s_barrier
    s_waitcnt vmcnt(0)
    v_mfma_f32_16x16x32_bf16 v[116:119], v[68:71], v[40:43], v[116:119]
    ds_read_b128 v[32:35], v11 offset:0
    v_mfma_f32_16x16x32_bf16 v[120:123], v[72:75], v[40:43], v[120:123]
    ds_read_b128 v[48:51], v23 offset:0
    v_mfma_f32_16x16x32_bf16 v[124:127], v[76:79], v[40:43], v[124:127]
    ds_read_b128 v[52:55], v23 offset:2048
    v_mfma_f32_16x16x32_bf16 v[128:131], v[80:83], v[40:43], v[128:131]
    ds_read_b128 v[56:59], v23 offset:4096
    v_mfma_f32_16x16x32_bf16 v[132:135], v[84:87], v[40:43], v[132:135]
    ds_read_b128 v[60:63], v23 offset:6144
    v_mfma_f32_16x16x32_bf16 v[156:159], v[164:167], v[40:43], v[156:159]
    ds_read_b128 v[64:67], v23 offset:8192
    v_mfma_f32_16x16x32_bf16 v[136:139], v[68:71], v[44:47], v[136:139]
    ds_read_b128 v[36:39], v11 offset:2048
    v_mfma_f32_16x16x32_bf16 v[140:143], v[72:75], v[44:47], v[140:143]
    v_lshlrev_b32 v170, 16, v180
    v_and_b32 v171, 0xffff0000, v180
    v_mfma_f32_16x16x32_bf16 v[144:147], v[76:79], v[44:47], v[144:147]
    v_lshlrev_b32 v172, 16, v181
    v_and_b32 v173, 0xffff0000, v181
    v_mfma_f32_16x16x32_bf16 v[148:151], v[80:83], v[44:47], v[148:151]
    v_lshlrev_b32 v174, 16, v182
    v_and_b32 v175, 0xffff0000, v182
    v_mfma_f32_16x16x32_bf16 v[152:155], v[84:87], v[44:47], v[152:155]
    v_lshlrev_b32 v176, 16, v183
    v_and_b32 v177, 0xffff0000, v183
    v_mfma_f32_16x16x32_bf16 v[160:163], v[164:167], v[44:47], v[160:163]
    v_lshlrev_b32 v178, 16, v184
    v_and_b32 v179, 0xffff0000, v184
    s_waitcnt lgkmcnt(0)
    v_mfma_f32_16x16x32_bf16 v[116:119], v[48:51], v[32:35], v[116:119]
    ds_read_b128 v[40:43], v12 offset:0
    v_mfma_f32_16x16x32_bf16 v[120:123], v[52:55], v[32:35], v[120:123]
    ds_read_b128 v[68:71], v24 offset:0
    v_mfma_f32_16x16x32_bf16 v[124:127], v[56:59], v[32:35], v[124:127]
    ds_read_b128 v[72:75], v24 offset:2048
    v_mfma_f32_16x16x32_bf16 v[128:131], v[60:63], v[32:35], v[128:131]
    ds_read_b128 v[76:79], v24 offset:4096
    v_mfma_f32_16x16x32_bf16 v[132:135], v[64:67], v[32:35], v[132:135]
    ds_read_b128 v[80:83], v24 offset:6144
    v_mfma_f32_16x16x32_bf16 v[156:159], v[164:167], v[32:35], v[156:159]
    ds_read_b128 v[84:87], v24 offset:8192
    v_mfma_f32_16x16x32_bf16 v[136:139], v[48:51], v[36:39], v[136:139]
    ds_read_b128 v[44:47], v12 offset:2048
    v_mfma_f32_16x16x32_bf16 v[140:143], v[52:55], v[36:39], v[140:143]
    v_lshlrev_b32 v180, 16, v185
    v_and_b32 v181, 0xffff0000, v185
    v_mfma_f32_16x16x32_bf16 v[144:147], v[56:59], v[36:39], v[144:147]
    v_lshlrev_b32 v182, 16, v186
    v_and_b32 v183, 0xffff0000, v186
    v_mfma_f32_16x16x32_bf16 v[148:151], v[60:63], v[36:39], v[148:151]
    v_lshlrev_b32 v184, 16, v187
    v_and_b32 v185, 0xffff0000, v187
    v_mfma_f32_16x16x32_bf16 v[152:155], v[64:67], v[36:39], v[152:155]
    v_lshlrev_b32 v186, 16, v188
    v_and_b32 v187, 0xffff0000, v188
    v_mfma_f32_16x16x32_bf16 v[160:163], v[164:167], v[36:39], v[160:163]
    v_lshlrev_b32 v188, 16, v189
    v_and_b32 v189, 0xffff0000, v189
    s_waitcnt lgkmcnt(0)
    s_barrier
    v_mfma_f32_16x16x32_bf16 v[116:119], v[68:71], v[40:43], v[116:119]
    ds_read_b128 v[32:35], v13 offset:0
    v_mfma_f32_16x16x32_bf16 v[120:123], v[72:75], v[40:43], v[120:123]
    ds_read_b128 v[48:51], v25 offset:0
    v_mfma_f32_16x16x32_bf16 v[124:127], v[76:79], v[40:43], v[124:127]
    ds_read_b128 v[52:55], v25 offset:2048
    v_mfma_f32_16x16x32_bf16 v[128:131], v[80:83], v[40:43], v[128:131]
    ds_read_b128 v[56:59], v25 offset:4096
    v_mfma_f32_16x16x32_bf16 v[132:135], v[84:87], v[40:43], v[132:135]
    ds_read_b128 v[60:63], v25 offset:6144
    v_mfma_f32_16x16x32_bf16 v[156:159], v[164:167], v[40:43], v[156:159]
    ds_read_b128 v[64:67], v25 offset:8192
    v_mfma_f32_16x16x32_bf16 v[136:139], v[68:71], v[44:47], v[136:139]
    ds_read_b128 v[36:39], v13 offset:2048
    v_mfma_f32_16x16x32_bf16 v[140:143], v[72:75], v[44:47], v[140:143]
    v_lshlrev_b32 v190, 16, v200
    v_and_b32 v191, 0xffff0000, v200
    v_mfma_f32_16x16x32_bf16 v[144:147], v[76:79], v[44:47], v[144:147]
    v_lshlrev_b32 v192, 16, v201
    v_and_b32 v193, 0xffff0000, v201
    v_mfma_f32_16x16x32_bf16 v[148:151], v[80:83], v[44:47], v[148:151]
    v_lshlrev_b32 v194, 16, v202
    v_and_b32 v195, 0xffff0000, v202
    v_mfma_f32_16x16x32_bf16 v[152:155], v[84:87], v[44:47], v[152:155]
    v_lshlrev_b32 v196, 16, v203
    v_and_b32 v197, 0xffff0000, v203
    v_mfma_f32_16x16x32_bf16 v[160:163], v[164:167], v[44:47], v[160:163]
    v_lshlrev_b32 v198, 16, v204
    v_and_b32 v199, 0xffff0000, v204
    s_waitcnt lgkmcnt(0)
    v_mfma_f32_16x16x32_bf16 v[116:119], v[48:51], v[32:35], v[116:119]
    ds_read_b128 v[40:43], v14 offset:0
    v_mfma_f32_16x16x32_bf16 v[120:123], v[52:55], v[32:35], v[120:123]
    ds_read_b128 v[68:71], v26 offset:0
    v_mfma_f32_16x16x32_bf16 v[124:127], v[56:59], v[32:35], v[124:127]
    ds_read_b128 v[72:75], v26 offset:2048
    v_mfma_f32_16x16x32_bf16 v[128:131], v[60:63], v[32:35], v[128:131]
    ds_read_b128 v[76:79], v26 offset:4096
    v_mfma_f32_16x16x32_bf16 v[132:135], v[64:67], v[32:35], v[132:135]
    ds_read_b128 v[80:83], v26 offset:6144
    v_mfma_f32_16x16x32_bf16 v[156:159], v[164:167], v[32:35], v[156:159]
    ds_read_b128 v[84:87], v26 offset:8192
    v_mfma_f32_16x16x32_bf16 v[136:139], v[48:51], v[36:39], v[136:139]
    ds_read_b128 v[44:47], v14 offset:2048
    v_mfma_f32_16x16x32_bf16 v[140:143], v[52:55], v[36:39], v[140:143]
    v_lshlrev_b32 v200, 16, v205
    v_and_b32 v201, 0xffff0000, v205
    v_mfma_f32_16x16x32_bf16 v[144:147], v[56:59], v[36:39], v[144:147]
    v_lshlrev_b32 v202, 16, v206
    v_and_b32 v203, 0xffff0000, v206
    v_mfma_f32_16x16x32_bf16 v[148:151], v[60:63], v[36:39], v[148:151]
    v_lshlrev_b32 v204, 16, v207
    v_and_b32 v205, 0xffff0000, v207
    v_mfma_f32_16x16x32_bf16 v[152:155], v[64:67], v[36:39], v[152:155]
    v_lshlrev_b32 v206, 16, v208
    v_and_b32 v207, 0xffff0000, v208
    v_mfma_f32_16x16x32_bf16 v[160:163], v[164:167], v[36:39], v[160:163]
    v_lshlrev_b32 v208, 16, v209
    v_and_b32 v209, 0xffff0000, v209
    s_waitcnt lgkmcnt(0)
    s_barrier
    v_mfma_f32_16x16x32_bf16 v[116:119], v[68:71], v[40:43], v[116:119]
    ds_read_b128 v[32:35], v15 offset:0
    v_mfma_f32_16x16x32_bf16 v[120:123], v[72:75], v[40:43], v[120:123]
    ds_read_b128 v[48:51], v27 offset:0
    v_mfma_f32_16x16x32_bf16 v[124:127], v[76:79], v[40:43], v[124:127]
    ds_read_b128 v[52:55], v27 offset:2048
    v_mfma_f32_16x16x32_bf16 v[128:131], v[80:83], v[40:43], v[128:131]
    ds_read_b128 v[56:59], v27 offset:4096
    v_mfma_f32_16x16x32_bf16 v[132:135], v[84:87], v[40:43], v[132:135]
    ds_read_b128 v[60:63], v27 offset:6144
    v_mfma_f32_16x16x32_bf16 v[156:159], v[164:167], v[40:43], v[156:159]
    ds_read_b128 v[64:67], v27 offset:8192
    v_mfma_f32_16x16x32_bf16 v[136:139], v[68:71], v[44:47], v[136:139]
    ds_read_b128 v[36:39], v15 offset:2048
    v_mfma_f32_16x16x32_bf16 v[140:143], v[72:75], v[44:47], v[140:143]
    v_add_f32 v190, 1.0, v190
    v_add_f32 v191, 1.0, v191
    v_mfma_f32_16x16x32_bf16 v[144:147], v[76:79], v[44:47], v[144:147]
    v_cvt_pk_bf16_f32 v210, v190, v191
    v_lshlrev_b32 v190, 16, v210
    v_mfma_f32_16x16x32_bf16 v[148:151], v[80:83], v[44:47], v[148:151]
    v_and_b32 v191, 0xffff0000, v210
    v_add_f32 v192, 1.0, v192
    v_mfma_f32_16x16x32_bf16 v[152:155], v[84:87], v[44:47], v[152:155]
    v_add_f32 v193, 1.0, v193
    v_cvt_pk_bf16_f32 v210, v192, v193
    v_mfma_f32_16x16x32_bf16 v[160:163], v[164:167], v[44:47], v[160:163]
    v_lshlrev_b32 v192, 16, v210
    v_and_b32 v193, 0xffff0000, v210
    s_waitcnt lgkmcnt(0)
    v_mfma_f32_16x16x32_bf16 v[116:119], v[48:51], v[32:35], v[116:119]
    ds_read_b128 v[40:43], v16 offset:0
    v_mfma_f32_16x16x32_bf16 v[120:123], v[52:55], v[32:35], v[120:123]
    ds_read_b128 v[68:71], v28 offset:0
    v_mfma_f32_16x16x32_bf16 v[124:127], v[56:59], v[32:35], v[124:127]
    ds_read_b128 v[72:75], v28 offset:2048
    v_mfma_f32_16x16x32_bf16 v[128:131], v[60:63], v[32:35], v[128:131]
    ds_read_b128 v[76:79], v28 offset:4096
    v_mfma_f32_16x16x32_bf16 v[132:135], v[64:67], v[32:35], v[132:135]
    ds_read_b128 v[80:83], v28 offset:6144
    v_mfma_f32_16x16x32_bf16 v[156:159], v[164:167], v[32:35], v[156:159]
    ds_read_b128 v[84:87], v28 offset:8192
    v_mfma_f32_16x16x32_bf16 v[136:139], v[48:51], v[36:39], v[136:139]
    ds_read_b128 v[44:47], v16 offset:2048
    v_mfma_f32_16x16x32_bf16 v[140:143], v[52:55], v[36:39], v[140:143]
    v_add_f32 v194, 1.0, v194
    v_add_f32 v195, 1.0, v195
    v_mfma_f32_16x16x32_bf16 v[144:147], v[56:59], v[36:39], v[144:147]
    v_cvt_pk_bf16_f32 v210, v194, v195
    v_lshlrev_b32 v194, 16, v210
    v_mfma_f32_16x16x32_bf16 v[148:151], v[60:63], v[36:39], v[148:151]
    v_and_b32 v195, 0xffff0000, v210
    v_add_f32 v196, 1.0, v196
    v_mfma_f32_16x16x32_bf16 v[152:155], v[64:67], v[36:39], v[152:155]
    v_add_f32 v197, 1.0, v197
    v_cvt_pk_bf16_f32 v210, v196, v197
    v_mfma_f32_16x16x32_bf16 v[160:163], v[164:167], v[36:39], v[160:163]
    v_lshlrev_b32 v196, 16, v210
    v_and_b32 v197, 0xffff0000, v210
    s_waitcnt lgkmcnt(0)
    s_barrier
    v_mfma_f32_16x16x32_bf16 v[116:119], v[68:71], v[40:43], v[116:119]
    ds_read_b128 v[32:35], v17 offset:0
    v_mfma_f32_16x16x32_bf16 v[120:123], v[72:75], v[40:43], v[120:123]
    ds_read_b128 v[48:51], v29 offset:0
    v_mfma_f32_16x16x32_bf16 v[124:127], v[76:79], v[40:43], v[124:127]
    ds_read_b128 v[52:55], v29 offset:2048
    v_mfma_f32_16x16x32_bf16 v[128:131], v[80:83], v[40:43], v[128:131]
    ds_read_b128 v[56:59], v29 offset:4096
    v_mfma_f32_16x16x32_bf16 v[132:135], v[84:87], v[40:43], v[132:135]
    ds_read_b128 v[60:63], v29 offset:6144
    v_mfma_f32_16x16x32_bf16 v[156:159], v[164:167], v[40:43], v[156:159]
    ds_read_b128 v[64:67], v29 offset:8192
    v_mfma_f32_16x16x32_bf16 v[136:139], v[68:71], v[44:47], v[136:139]
    ds_read_b128 v[36:39], v17 offset:2048
    v_mfma_f32_16x16x32_bf16 v[140:143], v[72:75], v[44:47], v[140:143]
    v_add_f32 v198, 1.0, v198
    v_add_f32 v199, 1.0, v199
    v_mfma_f32_16x16x32_bf16 v[144:147], v[76:79], v[44:47], v[144:147]
    v_cvt_pk_bf16_f32 v210, v198, v199
    v_lshlrev_b32 v198, 16, v210
    v_mfma_f32_16x16x32_bf16 v[148:151], v[80:83], v[44:47], v[148:151]
    v_and_b32 v199, 0xffff0000, v210
    v_add_f32 v200, 1.0, v200
    v_mfma_f32_16x16x32_bf16 v[152:155], v[84:87], v[44:47], v[152:155]
    v_add_f32 v201, 1.0, v201
    v_cvt_pk_bf16_f32 v210, v200, v201
    v_mfma_f32_16x16x32_bf16 v[160:163], v[164:167], v[44:47], v[160:163]
    v_lshlrev_b32 v200, 16, v210
    v_and_b32 v201, 0xffff0000, v210
    s_waitcnt lgkmcnt(0)
    v_mfma_f32_16x16x32_bf16 v[116:119], v[48:51], v[32:35], v[116:119]
    ds_read_b128 v[40:43], v18 offset:0
    v_mfma_f32_16x16x32_bf16 v[120:123], v[52:55], v[32:35], v[120:123]
    ds_read_b128 v[68:71], v30 offset:0
    v_mfma_f32_16x16x32_bf16 v[124:127], v[56:59], v[32:35], v[124:127]
    ds_read_b128 v[72:75], v30 offset:2048
    v_mfma_f32_16x16x32_bf16 v[128:131], v[60:63], v[32:35], v[128:131]
    ds_read_b128 v[76:79], v30 offset:4096
    v_mfma_f32_16x16x32_bf16 v[132:135], v[64:67], v[32:35], v[132:135]
    ds_read_b128 v[80:83], v30 offset:6144
    v_mfma_f32_16x16x32_bf16 v[156:159], v[164:167], v[32:35], v[156:159]
    ds_read_b128 v[84:87], v30 offset:8192
    v_mfma_f32_16x16x32_bf16 v[136:139], v[48:51], v[36:39], v[136:139]
    ds_read_b128 v[44:47], v18 offset:2048
    v_mfma_f32_16x16x32_bf16 v[140:143], v[52:55], v[36:39], v[140:143]
    v_add_f32 v202, 1.0, v202
    v_add_f32 v203, 1.0, v203
    v_mfma_f32_16x16x32_bf16 v[144:147], v[56:59], v[36:39], v[144:147]
    v_cvt_pk_bf16_f32 v210, v202, v203
    v_lshlrev_b32 v202, 16, v210
    v_mfma_f32_16x16x32_bf16 v[148:151], v[60:63], v[36:39], v[148:151]
    v_and_b32 v203, 0xffff0000, v210
    v_add_f32 v204, 1.0, v204
    v_mfma_f32_16x16x32_bf16 v[152:155], v[64:67], v[36:39], v[152:155]
    v_add_f32 v205, 1.0, v205
    v_cvt_pk_bf16_f32 v210, v204, v205
    v_mfma_f32_16x16x32_bf16 v[160:163], v[164:167], v[36:39], v[160:163]
    v_lshlrev_b32 v204, 16, v210
    v_and_b32 v205, 0xffff0000, v210
    s_waitcnt lgkmcnt(0)
    s_barrier
    v_mfma_f32_16x16x32_bf16 v[116:119], v[68:71], v[40:43], v[116:119]
    ds_read_b128 v[32:35], v7 offset:0
    v_mfma_f32_16x16x32_bf16 v[120:123], v[72:75], v[40:43], v[120:123]
    ds_read_b128 v[48:51], v19 offset:0
    v_mfma_f32_16x16x32_bf16 v[124:127], v[76:79], v[40:43], v[124:127]
    ds_read_b128 v[52:55], v19 offset:2048
    v_mfma_f32_16x16x32_bf16 v[128:131], v[80:83], v[40:43], v[128:131]
    ds_read_b128 v[56:59], v19 offset:4096
    v_mfma_f32_16x16x32_bf16 v[132:135], v[84:87], v[40:43], v[132:135]
    ds_read_b128 v[60:63], v19 offset:6144
    v_mfma_f32_16x16x32_bf16 v[156:159], v[164:167], v[40:43], v[156:159]
    ds_read_b128 v[64:67], v19 offset:8192
    v_mfma_f32_16x16x32_bf16 v[136:139], v[68:71], v[44:47], v[136:139]
    ds_read_b128 v[36:39], v7 offset:2048
    v_mfma_f32_16x16x32_bf16 v[140:143], v[72:75], v[44:47], v[140:143]
    v_add_f32 v206, 1.0, v206
    v_add_f32 v207, 1.0, v207
    v_mfma_f32_16x16x32_bf16 v[144:147], v[76:79], v[44:47], v[144:147]
    v_cvt_pk_bf16_f32 v210, v206, v207
    v_lshlrev_b32 v206, 16, v210
    v_mfma_f32_16x16x32_bf16 v[148:151], v[80:83], v[44:47], v[148:151]
    v_and_b32 v207, 0xffff0000, v210
    v_add_f32 v208, 1.0, v208
    v_mfma_f32_16x16x32_bf16 v[152:155], v[84:87], v[44:47], v[152:155]
    v_add_f32 v209, 1.0, v209
    v_cvt_pk_bf16_f32 v210, v208, v209
    v_mfma_f32_16x16x32_bf16 v[160:163], v[164:167], v[44:47], v[160:163]
    v_lshlrev_b32 v208, 16, v210
    v_and_b32 v209, 0xffff0000, v210
    s_waitcnt lgkmcnt(0)
    v_mfma_f32_16x16x32_bf16 v[116:119], v[48:51], v[32:35], v[116:119]
    ds_read_b128 v[40:43], v8 offset:0
    v_mfma_f32_16x16x32_bf16 v[120:123], v[52:55], v[32:35], v[120:123]
    ds_read_b128 v[68:71], v20 offset:0
    v_mfma_f32_16x16x32_bf16 v[124:127], v[56:59], v[32:35], v[124:127]
    ds_read_b128 v[72:75], v20 offset:2048
    v_mfma_f32_16x16x32_bf16 v[128:131], v[60:63], v[32:35], v[128:131]
    ds_read_b128 v[76:79], v20 offset:4096
    v_mfma_f32_16x16x32_bf16 v[132:135], v[64:67], v[32:35], v[132:135]
    ds_read_b128 v[80:83], v20 offset:6144
    v_mfma_f32_16x16x32_bf16 v[156:159], v[164:167], v[32:35], v[156:159]
    ds_read_b128 v[84:87], v20 offset:8192
    v_mfma_f32_16x16x32_bf16 v[136:139], v[48:51], v[36:39], v[136:139]
    ds_read_b128 v[44:47], v8 offset:2048
    v_mfma_f32_16x16x32_bf16 v[140:143], v[52:55], v[36:39], v[140:143]
    v_xor_b32 v190, s35, v190
    v_xor_b32 v170, s35, v170
    v_mfma_f32_16x16x32_bf16 v[144:147], v[56:59], v[36:39], v[144:147]
    v_xor_b32 v191, s35, v191
    v_xor_b32 v171, s35, v171
    v_mfma_f32_16x16x32_bf16 v[148:151], v[60:63], v[36:39], v[148:151]
    v_xor_b32 v192, s35, v192
    v_xor_b32 v172, s35, v172
    v_mfma_f32_16x16x32_bf16 v[152:155], v[64:67], v[36:39], v[152:155]
    v_xor_b32 v193, s35, v193
    v_xor_b32 v173, s35, v173
    v_mfma_f32_16x16x32_bf16 v[160:163], v[164:167], v[36:39], v[160:163]
    v_xor_b32 v194, s35, v194
    v_xor_b32 v174, s35, v174
    s_waitcnt lgkmcnt(0)
    s_barrier
    v_mfma_f32_16x16x32_bf16 v[116:119], v[68:71], v[40:43], v[116:119]
    ds_read_b128 v[32:35], v9 offset:0
    v_mfma_f32_16x16x32_bf16 v[120:123], v[72:75], v[40:43], v[120:123]
    ds_read_b128 v[48:51], v21 offset:0
    v_mfma_f32_16x16x32_bf16 v[124:127], v[76:79], v[40:43], v[124:127]
    ds_read_b128 v[52:55], v21 offset:2048
    v_mfma_f32_16x16x32_bf16 v[128:131], v[80:83], v[40:43], v[128:131]
    ds_read_b128 v[56:59], v21 offset:4096
    v_mfma_f32_16x16x32_bf16 v[132:135], v[84:87], v[40:43], v[132:135]
    ds_read_b128 v[60:63], v21 offset:6144
    v_mfma_f32_16x16x32_bf16 v[156:159], v[164:167], v[40:43], v[156:159]
    ds_read_b128 v[64:67], v21 offset:8192
    v_mfma_f32_16x16x32_bf16 v[136:139], v[68:71], v[44:47], v[136:139]
    ds_read_b128 v[36:39], v9 offset:2048
    v_mfma_f32_16x16x32_bf16 v[140:143], v[72:75], v[44:47], v[140:143]
    v_xor_b32 v195, s35, v195
    v_xor_b32 v175, s35, v175
    v_mfma_f32_16x16x32_bf16 v[144:147], v[76:79], v[44:47], v[144:147]
    v_xor_b32 v196, s35, v196
    v_xor_b32 v176, s35, v176
    v_mfma_f32_16x16x32_bf16 v[148:151], v[80:83], v[44:47], v[148:151]
    v_xor_b32 v197, s35, v197
    v_xor_b32 v177, s35, v177
    v_mfma_f32_16x16x32_bf16 v[152:155], v[84:87], v[44:47], v[152:155]
    v_xor_b32 v198, s35, v198
    v_xor_b32 v178, s35, v178
    v_mfma_f32_16x16x32_bf16 v[160:163], v[164:167], v[44:47], v[160:163]
    v_xor_b32 v199, s35, v199
    v_xor_b32 v179, s35, v179
    s_waitcnt lgkmcnt(0)
    v_mfma_f32_16x16x32_bf16 v[116:119], v[48:51], v[32:35], v[116:119]
    ds_read_b128 v[40:43], v10 offset:0
    v_mfma_f32_16x16x32_bf16 v[120:123], v[52:55], v[32:35], v[120:123]
    ds_read_b128 v[68:71], v22 offset:0
    v_mfma_f32_16x16x32_bf16 v[124:127], v[56:59], v[32:35], v[124:127]
    ds_read_b128 v[72:75], v22 offset:2048
    v_mfma_f32_16x16x32_bf16 v[128:131], v[60:63], v[32:35], v[128:131]
    ds_read_b128 v[76:79], v22 offset:4096
    v_mfma_f32_16x16x32_bf16 v[132:135], v[64:67], v[32:35], v[132:135]
    ds_read_b128 v[80:83], v22 offset:6144
    v_mfma_f32_16x16x32_bf16 v[156:159], v[164:167], v[32:35], v[156:159]
    ds_read_b128 v[84:87], v22 offset:8192
    v_mfma_f32_16x16x32_bf16 v[136:139], v[48:51], v[36:39], v[136:139]
    ds_read_b128 v[44:47], v10 offset:2048
    v_mfma_f32_16x16x32_bf16 v[140:143], v[52:55], v[36:39], v[140:143]
    v_xor_b32 v200, s35, v200
    v_xor_b32 v180, s35, v180
    v_mfma_f32_16x16x32_bf16 v[144:147], v[56:59], v[36:39], v[144:147]
    v_xor_b32 v201, s35, v201
    v_xor_b32 v181, s35, v181
    v_mfma_f32_16x16x32_bf16 v[148:151], v[60:63], v[36:39], v[148:151]
    v_xor_b32 v202, s35, v202
    v_xor_b32 v182, s35, v182
    v_mfma_f32_16x16x32_bf16 v[152:155], v[64:67], v[36:39], v[152:155]
    v_xor_b32 v203, s35, v203
    v_xor_b32 v183, s35, v183
    v_mfma_f32_16x16x32_bf16 v[160:163], v[164:167], v[36:39], v[160:163]
    v_xor_b32 v204, s35, v204
    v_xor_b32 v184, s35, v184
    s_waitcnt lgkmcnt(0)
    s_barrier
    v_mfma_f32_16x16x32_bf16 v[116:119], v[68:71], v[40:43], v[116:119]
    ds_read_b128 v[32:35], v11 offset:0
    v_mfma_f32_16x16x32_bf16 v[120:123], v[72:75], v[40:43], v[120:123]
    ds_read_b128 v[48:51], v23 offset:0
    v_mfma_f32_16x16x32_bf16 v[124:127], v[76:79], v[40:43], v[124:127]
    ds_read_b128 v[52:55], v23 offset:2048
    v_mfma_f32_16x16x32_bf16 v[128:131], v[80:83], v[40:43], v[128:131]
    ds_read_b128 v[56:59], v23 offset:4096
    v_mfma_f32_16x16x32_bf16 v[132:135], v[84:87], v[40:43], v[132:135]
    ds_read_b128 v[60:63], v23 offset:6144
    v_mfma_f32_16x16x32_bf16 v[156:159], v[164:167], v[40:43], v[156:159]
    ds_read_b128 v[64:67], v23 offset:8192
    v_mfma_f32_16x16x32_bf16 v[136:139], v[68:71], v[44:47], v[136:139]
    ds_read_b128 v[36:39], v11 offset:2048
    v_mfma_f32_16x16x32_bf16 v[140:143], v[72:75], v[44:47], v[140:143]
    v_xor_b32 v205, s35, v205
    v_xor_b32 v185, s35, v185
    v_mfma_f32_16x16x32_bf16 v[144:147], v[76:79], v[44:47], v[144:147]
    v_xor_b32 v206, s35, v206
    v_xor_b32 v186, s35, v186
    v_mfma_f32_16x16x32_bf16 v[148:151], v[80:83], v[44:47], v[148:151]
    v_xor_b32 v207, s35, v207
    v_xor_b32 v187, s35, v187
    v_mfma_f32_16x16x32_bf16 v[152:155], v[84:87], v[44:47], v[152:155]
    v_xor_b32 v208, s35, v208
    v_xor_b32 v188, s35, v188
    v_mfma_f32_16x16x32_bf16 v[160:163], v[164:167], v[44:47], v[160:163]
    v_xor_b32 v209, s35, v209
    v_xor_b32 v189, s35, v189
    s_waitcnt lgkmcnt(0)
    v_mfma_f32_16x16x32_bf16 v[116:119], v[48:51], v[32:35], v[116:119]
    ds_read_b128 v[40:43], v12 offset:0
    v_mfma_f32_16x16x32_bf16 v[120:123], v[52:55], v[32:35], v[120:123]
    ds_read_b128 v[68:71], v24 offset:0
    v_mfma_f32_16x16x32_bf16 v[124:127], v[56:59], v[32:35], v[124:127]
    ds_read_b128 v[72:75], v24 offset:2048
    v_mfma_f32_16x16x32_bf16 v[128:131], v[60:63], v[32:35], v[128:131]
    ds_read_b128 v[76:79], v24 offset:4096
    v_mfma_f32_16x16x32_bf16 v[132:135], v[64:67], v[32:35], v[132:135]
    ds_read_b128 v[80:83], v24 offset:6144
    v_mfma_f32_16x16x32_bf16 v[156:159], v[164:167], v[32:35], v[156:159]
    ds_read_b128 v[84:87], v24 offset:8192
    v_mfma_f32_16x16x32_bf16 v[136:139], v[48:51], v[36:39], v[136:139]
    ds_read_b128 v[44:47], v12 offset:2048
    v_mfma_f32_16x16x32_bf16 v[140:143], v[52:55], v[36:39], v[140:143]
    v_mfma_f32_16x16x32_bf16 v[144:147], v[56:59], v[36:39], v[144:147]
    v_mfma_f32_16x16x32_bf16 v[148:151], v[60:63], v[36:39], v[148:151]
    v_mfma_f32_16x16x32_bf16 v[152:155], v[64:67], v[36:39], v[152:155]
    v_mfma_f32_16x16x32_bf16 v[160:163], v[164:167], v[36:39], v[160:163]
    s_waitcnt lgkmcnt(0)
    s_barrier
    v_mfma_f32_16x16x32_bf16 v[116:119], v[68:71], v[40:43], v[116:119]
    ds_read_b128 v[32:35], v13 offset:0
    v_mfma_f32_16x16x32_bf16 v[120:123], v[72:75], v[40:43], v[120:123]
    ds_read_b128 v[48:51], v25 offset:0
    v_mfma_f32_16x16x32_bf16 v[124:127], v[76:79], v[40:43], v[124:127]
    ds_read_b128 v[52:55], v25 offset:2048
    v_mfma_f32_16x16x32_bf16 v[128:131], v[80:83], v[40:43], v[128:131]
    ds_read_b128 v[56:59], v25 offset:4096
    v_mfma_f32_16x16x32_bf16 v[132:135], v[84:87], v[40:43], v[132:135]
    ds_read_b128 v[60:63], v25 offset:6144
    v_mfma_f32_16x16x32_bf16 v[156:159], v[164:167], v[40:43], v[156:159]
    ds_read_b128 v[64:67], v25 offset:8192
    v_mfma_f32_16x16x32_bf16 v[136:139], v[68:71], v[44:47], v[136:139]
    ds_read_b128 v[36:39], v13 offset:2048
    v_mfma_f32_16x16x32_bf16 v[140:143], v[72:75], v[44:47], v[140:143]
    v_mfma_f32_16x16x32_bf16 v[144:147], v[76:79], v[44:47], v[144:147]
    v_mfma_f32_16x16x32_bf16 v[148:151], v[80:83], v[44:47], v[148:151]
    v_mfma_f32_16x16x32_bf16 v[152:155], v[84:87], v[44:47], v[152:155]
    v_mfma_f32_16x16x32_bf16 v[160:163], v[164:167], v[44:47], v[160:163]
    s_waitcnt lgkmcnt(0)
    v_mfma_f32_16x16x32_bf16 v[116:119], v[48:51], v[32:35], v[116:119]
    ds_read_b128 v[40:43], v14 offset:0
    v_mfma_f32_16x16x32_bf16 v[120:123], v[52:55], v[32:35], v[120:123]
    ds_read_b128 v[68:71], v26 offset:0
    v_mfma_f32_16x16x32_bf16 v[124:127], v[56:59], v[32:35], v[124:127]
    ds_read_b128 v[72:75], v26 offset:2048
    v_mfma_f32_16x16x32_bf16 v[128:131], v[60:63], v[32:35], v[128:131]
    ds_read_b128 v[76:79], v26 offset:4096
    v_mfma_f32_16x16x32_bf16 v[132:135], v[64:67], v[32:35], v[132:135]
    ds_read_b128 v[80:83], v26 offset:6144
    v_mfma_f32_16x16x32_bf16 v[156:159], v[164:167], v[32:35], v[156:159]
    ds_read_b128 v[84:87], v26 offset:8192
    v_mfma_f32_16x16x32_bf16 v[136:139], v[48:51], v[36:39], v[136:139]
    ds_read_b128 v[44:47], v14 offset:2048
    v_mfma_f32_16x16x32_bf16 v[140:143], v[52:55], v[36:39], v[140:143]
    v_mfma_f32_16x16x32_bf16 v[144:147], v[56:59], v[36:39], v[144:147]
    v_mfma_f32_16x16x32_bf16 v[148:151], v[60:63], v[36:39], v[148:151]
    v_mfma_f32_16x16x32_bf16 v[152:155], v[64:67], v[36:39], v[152:155]
    v_mfma_f32_16x16x32_bf16 v[160:163], v[164:167], v[36:39], v[160:163]
    s_waitcnt lgkmcnt(0)
    s_barrier
    v_mfma_f32_16x16x32_bf16 v[116:119], v[68:71], v[40:43], v[116:119]
    ds_read_b128 v[32:35], v15 offset:0
    v_mfma_f32_16x16x32_bf16 v[120:123], v[72:75], v[40:43], v[120:123]
    ds_read_b128 v[48:51], v27 offset:0
    v_mfma_f32_16x16x32_bf16 v[124:127], v[76:79], v[40:43], v[124:127]
    ds_read_b128 v[52:55], v27 offset:2048
    v_mfma_f32_16x16x32_bf16 v[128:131], v[80:83], v[40:43], v[128:131]
    ds_read_b128 v[56:59], v27 offset:4096
    v_mfma_f32_16x16x32_bf16 v[132:135], v[84:87], v[40:43], v[132:135]
    ds_read_b128 v[60:63], v27 offset:6144
    v_mfma_f32_16x16x32_bf16 v[156:159], v[164:167], v[40:43], v[156:159]
    ds_read_b128 v[64:67], v27 offset:8192
    v_mfma_f32_16x16x32_bf16 v[136:139], v[68:71], v[44:47], v[136:139]
    ds_read_b128 v[36:39], v15 offset:2048
    v_mfma_f32_16x16x32_bf16 v[140:143], v[72:75], v[44:47], v[140:143]
    v_mfma_f32_16x16x32_bf16 v[144:147], v[76:79], v[44:47], v[144:147]
    v_mfma_f32_16x16x32_bf16 v[148:151], v[80:83], v[44:47], v[148:151]
    v_mfma_f32_16x16x32_bf16 v[152:155], v[84:87], v[44:47], v[152:155]
    v_mfma_f32_16x16x32_bf16 v[160:163], v[164:167], v[44:47], v[160:163]
    s_waitcnt lgkmcnt(0)
    v_mfma_f32_16x16x32_bf16 v[116:119], v[48:51], v[32:35], v[116:119]
    ds_read_b128 v[40:43], v16 offset:0
    v_mfma_f32_16x16x32_bf16 v[120:123], v[52:55], v[32:35], v[120:123]
    ds_read_b128 v[68:71], v28 offset:0
    v_mfma_f32_16x16x32_bf16 v[124:127], v[56:59], v[32:35], v[124:127]
    ds_read_b128 v[72:75], v28 offset:2048
    v_mfma_f32_16x16x32_bf16 v[128:131], v[60:63], v[32:35], v[128:131]
    ds_read_b128 v[76:79], v28 offset:4096
    v_mfma_f32_16x16x32_bf16 v[132:135], v[64:67], v[32:35], v[132:135]
    ds_read_b128 v[80:83], v28 offset:6144
    v_mfma_f32_16x16x32_bf16 v[156:159], v[164:167], v[32:35], v[156:159]
    ds_read_b128 v[84:87], v28 offset:8192
    v_mfma_f32_16x16x32_bf16 v[136:139], v[48:51], v[36:39], v[136:139]
    ds_read_b128 v[44:47], v16 offset:2048
    v_mfma_f32_16x16x32_bf16 v[140:143], v[52:55], v[36:39], v[140:143]
    v_mfma_f32_16x16x32_bf16 v[144:147], v[56:59], v[36:39], v[144:147]
    v_mfma_f32_16x16x32_bf16 v[148:151], v[60:63], v[36:39], v[148:151]
    v_mfma_f32_16x16x32_bf16 v[152:155], v[64:67], v[36:39], v[152:155]
    v_mfma_f32_16x16x32_bf16 v[160:163], v[164:167], v[36:39], v[160:163]
    s_waitcnt lgkmcnt(0)
    s_barrier
    v_mfma_f32_16x16x32_bf16 v[116:119], v[68:71], v[40:43], v[116:119]
    ds_read_b128 v[32:35], v17 offset:0
    v_mfma_f32_16x16x32_bf16 v[120:123], v[72:75], v[40:43], v[120:123]
    ds_read_b128 v[48:51], v29 offset:0
    v_mfma_f32_16x16x32_bf16 v[124:127], v[76:79], v[40:43], v[124:127]
    ds_read_b128 v[52:55], v29 offset:2048
    v_mfma_f32_16x16x32_bf16 v[128:131], v[80:83], v[40:43], v[128:131]
    ds_read_b128 v[56:59], v29 offset:4096
    v_mfma_f32_16x16x32_bf16 v[132:135], v[84:87], v[40:43], v[132:135]
    ds_read_b128 v[60:63], v29 offset:6144
    v_mfma_f32_16x16x32_bf16 v[156:159], v[164:167], v[40:43], v[156:159]
    ds_read_b128 v[64:67], v29 offset:8192
    v_mfma_f32_16x16x32_bf16 v[136:139], v[68:71], v[44:47], v[136:139]
    ds_read_b128 v[36:39], v17 offset:2048
    v_mfma_f32_16x16x32_bf16 v[140:143], v[72:75], v[44:47], v[140:143]
    v_mfma_f32_16x16x32_bf16 v[144:147], v[76:79], v[44:47], v[144:147]
    v_mfma_f32_16x16x32_bf16 v[148:151], v[80:83], v[44:47], v[148:151]
    v_mfma_f32_16x16x32_bf16 v[152:155], v[84:87], v[44:47], v[152:155]
    v_mfma_f32_16x16x32_bf16 v[160:163], v[164:167], v[44:47], v[160:163]
    s_waitcnt lgkmcnt(0)
    v_mfma_f32_16x16x32_bf16 v[116:119], v[48:51], v[32:35], v[116:119]
    ds_read_b128 v[40:43], v18 offset:0
    v_mfma_f32_16x16x32_bf16 v[120:123], v[52:55], v[32:35], v[120:123]
    ds_read_b128 v[68:71], v30 offset:0
    v_mfma_f32_16x16x32_bf16 v[124:127], v[56:59], v[32:35], v[124:127]
    ds_read_b128 v[72:75], v30 offset:2048
    v_mfma_f32_16x16x32_bf16 v[128:131], v[60:63], v[32:35], v[128:131]
    ds_read_b128 v[76:79], v30 offset:4096
    v_mfma_f32_16x16x32_bf16 v[132:135], v[64:67], v[32:35], v[132:135]
    ds_read_b128 v[80:83], v30 offset:6144
    v_mfma_f32_16x16x32_bf16 v[156:159], v[164:167], v[32:35], v[156:159]
    ds_read_b128 v[84:87], v30 offset:8192
    v_mfma_f32_16x16x32_bf16 v[136:139], v[48:51], v[36:39], v[136:139]
    ds_read_b128 v[44:47], v18 offset:2048
    v_mfma_f32_16x16x32_bf16 v[140:143], v[52:55], v[36:39], v[140:143]
    v_mfma_f32_16x16x32_bf16 v[144:147], v[56:59], v[36:39], v[144:147]
    v_mfma_f32_16x16x32_bf16 v[148:151], v[60:63], v[36:39], v[148:151]
    v_mfma_f32_16x16x32_bf16 v[152:155], v[64:67], v[36:39], v[152:155]
    v_mfma_f32_16x16x32_bf16 v[160:163], v[164:167], v[36:39], v[160:163]
    s_waitcnt lgkmcnt(0)
    s_barrier
    v_mfma_f32_16x16x32_bf16 v[116:119], v[68:71], v[40:43], v[116:119]
    ds_read_b128 v[32:35], v7 offset:0
    v_mfma_f32_16x16x32_bf16 v[120:123], v[72:75], v[40:43], v[120:123]
    ds_read_b128 v[48:51], v19 offset:0
    v_mfma_f32_16x16x32_bf16 v[124:127], v[76:79], v[40:43], v[124:127]
    ds_read_b128 v[52:55], v19 offset:2048
    v_mfma_f32_16x16x32_bf16 v[128:131], v[80:83], v[40:43], v[128:131]
    ds_read_b128 v[56:59], v19 offset:4096
    v_mfma_f32_16x16x32_bf16 v[132:135], v[84:87], v[40:43], v[132:135]
    ds_read_b128 v[60:63], v19 offset:6144
    v_mfma_f32_16x16x32_bf16 v[156:159], v[164:167], v[40:43], v[156:159]
    ds_read_b128 v[64:67], v19 offset:8192
    v_mfma_f32_16x16x32_bf16 v[136:139], v[68:71], v[44:47], v[136:139]
    ds_read_b128 v[36:39], v7 offset:2048
    v_mfma_f32_16x16x32_bf16 v[140:143], v[72:75], v[44:47], v[140:143]
    v_mfma_f32_16x16x32_bf16 v[144:147], v[76:79], v[44:47], v[144:147]
    v_mfma_f32_16x16x32_bf16 v[148:151], v[80:83], v[44:47], v[148:151]
    v_mfma_f32_16x16x32_bf16 v[152:155], v[84:87], v[44:47], v[152:155]
    v_mfma_f32_16x16x32_bf16 v[160:163], v[164:167], v[44:47], v[160:163]
    s_waitcnt lgkmcnt(0)
    v_mfma_f32_16x16x32_bf16 v[116:119], v[48:51], v[32:35], v[116:119]
    ds_read_b128 v[40:43], v8 offset:0
    v_mfma_f32_16x16x32_bf16 v[120:123], v[52:55], v[32:35], v[120:123]
    ds_read_b128 v[68:71], v20 offset:0
    v_mfma_f32_16x16x32_bf16 v[124:127], v[56:59], v[32:35], v[124:127]
    ds_read_b128 v[72:75], v20 offset:2048
    v_mfma_f32_16x16x32_bf16 v[128:131], v[60:63], v[32:35], v[128:131]
    ds_read_b128 v[76:79], v20 offset:4096
    v_mfma_f32_16x16x32_bf16 v[132:135], v[64:67], v[32:35], v[132:135]
    ds_read_b128 v[80:83], v20 offset:6144
    v_mfma_f32_16x16x32_bf16 v[156:159], v[164:167], v[32:35], v[156:159]
    ds_read_b128 v[84:87], v20 offset:8192
    v_mfma_f32_16x16x32_bf16 v[136:139], v[48:51], v[36:39], v[136:139]
    ds_read_b128 v[44:47], v8 offset:2048
    v_mfma_f32_16x16x32_bf16 v[140:143], v[52:55], v[36:39], v[140:143]
    v_mfma_f32_16x16x32_bf16 v[144:147], v[56:59], v[36:39], v[144:147]
    v_mfma_f32_16x16x32_bf16 v[148:151], v[60:63], v[36:39], v[148:151]
    v_mfma_f32_16x16x32_bf16 v[152:155], v[64:67], v[36:39], v[152:155]
    v_mfma_f32_16x16x32_bf16 v[160:163], v[164:167], v[36:39], v[160:163]
    s_waitcnt lgkmcnt(0)
    s_barrier
    v_mfma_f32_16x16x32_bf16 v[116:119], v[68:71], v[40:43], v[116:119]
    ds_read_b128 v[32:35], v9 offset:0
    v_mfma_f32_16x16x32_bf16 v[120:123], v[72:75], v[40:43], v[120:123]
    ds_read_b128 v[48:51], v21 offset:0
    v_mfma_f32_16x16x32_bf16 v[124:127], v[76:79], v[40:43], v[124:127]
    ds_read_b128 v[52:55], v21 offset:2048
    v_mfma_f32_16x16x32_bf16 v[128:131], v[80:83], v[40:43], v[128:131]
    ds_read_b128 v[56:59], v21 offset:4096
    v_mfma_f32_16x16x32_bf16 v[132:135], v[84:87], v[40:43], v[132:135]
    ds_read_b128 v[60:63], v21 offset:6144
    v_mfma_f32_16x16x32_bf16 v[156:159], v[164:167], v[40:43], v[156:159]
    ds_read_b128 v[64:67], v21 offset:8192
    v_mfma_f32_16x16x32_bf16 v[136:139], v[68:71], v[44:47], v[136:139]
    ds_read_b128 v[36:39], v9 offset:2048
    v_mfma_f32_16x16x32_bf16 v[140:143], v[72:75], v[44:47], v[140:143]
    v_mfma_f32_16x16x32_bf16 v[144:147], v[76:79], v[44:47], v[144:147]
    v_mfma_f32_16x16x32_bf16 v[148:151], v[80:83], v[44:47], v[148:151]
    v_mfma_f32_16x16x32_bf16 v[152:155], v[84:87], v[44:47], v[152:155]
    v_mfma_f32_16x16x32_bf16 v[160:163], v[164:167], v[44:47], v[160:163]
    s_waitcnt lgkmcnt(0)
    v_mfma_f32_16x16x32_bf16 v[116:119], v[48:51], v[32:35], v[116:119]
    ds_read_b128 v[40:43], v10 offset:0
    v_mfma_f32_16x16x32_bf16 v[120:123], v[52:55], v[32:35], v[120:123]
    ds_read_b128 v[68:71], v22 offset:0
    v_mfma_f32_16x16x32_bf16 v[124:127], v[56:59], v[32:35], v[124:127]
    ds_read_b128 v[72:75], v22 offset:2048
    v_mfma_f32_16x16x32_bf16 v[128:131], v[60:63], v[32:35], v[128:131]
    ds_read_b128 v[76:79], v22 offset:4096
    v_mfma_f32_16x16x32_bf16 v[132:135], v[64:67], v[32:35], v[132:135]
    ds_read_b128 v[80:83], v22 offset:6144
    v_mfma_f32_16x16x32_bf16 v[156:159], v[164:167], v[32:35], v[156:159]
    ds_read_b128 v[84:87], v22 offset:8192
    v_mfma_f32_16x16x32_bf16 v[136:139], v[48:51], v[36:39], v[136:139]
    ds_read_b128 v[44:47], v10 offset:2048
    v_mfma_f32_16x16x32_bf16 v[140:143], v[52:55], v[36:39], v[140:143]
    v_mfma_f32_16x16x32_bf16 v[144:147], v[56:59], v[36:39], v[144:147]
    v_mfma_f32_16x16x32_bf16 v[148:151], v[60:63], v[36:39], v[148:151]
    v_mfma_f32_16x16x32_bf16 v[152:155], v[64:67], v[36:39], v[152:155]
    v_mfma_f32_16x16x32_bf16 v[160:163], v[164:167], v[36:39], v[160:163]
    s_waitcnt lgkmcnt(0)
    s_barrier
    v_mfma_f32_16x16x32_bf16 v[116:119], v[68:71], v[40:43], v[116:119]
    ds_read_b128 v[32:35], v11 offset:0
    v_mfma_f32_16x16x32_bf16 v[120:123], v[72:75], v[40:43], v[120:123]
    ds_read_b128 v[48:51], v23 offset:0
    v_mfma_f32_16x16x32_bf16 v[124:127], v[76:79], v[40:43], v[124:127]
    ds_read_b128 v[52:55], v23 offset:2048
    v_mfma_f32_16x16x32_bf16 v[128:131], v[80:83], v[40:43], v[128:131]
    ds_read_b128 v[56:59], v23 offset:4096
    v_mfma_f32_16x16x32_bf16 v[132:135], v[84:87], v[40:43], v[132:135]
    ds_read_b128 v[60:63], v23 offset:6144
    v_mfma_f32_16x16x32_bf16 v[156:159], v[164:167], v[40:43], v[156:159]
    ds_read_b128 v[64:67], v23 offset:8192
    v_mfma_f32_16x16x32_bf16 v[136:139], v[68:71], v[44:47], v[136:139]
    ds_read_b128 v[36:39], v11 offset:2048
    v_mfma_f32_16x16x32_bf16 v[140:143], v[72:75], v[44:47], v[140:143]
    v_mfma_f32_16x16x32_bf16 v[144:147], v[76:79], v[44:47], v[144:147]
    v_mfma_f32_16x16x32_bf16 v[148:151], v[80:83], v[44:47], v[148:151]
    v_mfma_f32_16x16x32_bf16 v[152:155], v[84:87], v[44:47], v[152:155]
    v_mfma_f32_16x16x32_bf16 v[160:163], v[164:167], v[44:47], v[160:163]
    s_waitcnt lgkmcnt(0)
    v_mfma_f32_16x16x32_bf16 v[116:119], v[48:51], v[32:35], v[116:119]
    ds_read_b128 v[40:43], v12 offset:0
    v_mfma_f32_16x16x32_bf16 v[120:123], v[52:55], v[32:35], v[120:123]
    ds_read_b128 v[68:71], v24 offset:0
    v_mfma_f32_16x16x32_bf16 v[124:127], v[56:59], v[32:35], v[124:127]
    ds_read_b128 v[72:75], v24 offset:2048
    v_mfma_f32_16x16x32_bf16 v[128:131], v[60:63], v[32:35], v[128:131]
    ds_read_b128 v[76:79], v24 offset:4096
    v_mfma_f32_16x16x32_bf16 v[132:135], v[64:67], v[32:35], v[132:135]
    ds_read_b128 v[80:83], v24 offset:6144
    v_mfma_f32_16x16x32_bf16 v[156:159], v[164:167], v[32:35], v[156:159]
    ds_read_b128 v[84:87], v24 offset:8192
    v_mfma_f32_16x16x32_bf16 v[136:139], v[48:51], v[36:39], v[136:139]
    ds_read_b128 v[44:47], v12 offset:2048
    v_mfma_f32_16x16x32_bf16 v[140:143], v[52:55], v[36:39], v[140:143]
    v_mfma_f32_16x16x32_bf16 v[144:147], v[56:59], v[36:39], v[144:147]
    v_mfma_f32_16x16x32_bf16 v[148:151], v[60:63], v[36:39], v[148:151]
    v_mfma_f32_16x16x32_bf16 v[152:155], v[64:67], v[36:39], v[152:155]
    v_mfma_f32_16x16x32_bf16 v[160:163], v[164:167], v[36:39], v[160:163]
    s_waitcnt lgkmcnt(0)
    s_barrier
    v_mfma_f32_16x16x32_bf16 v[116:119], v[68:71], v[40:43], v[116:119]
    ds_read_b128 v[32:35], v13 offset:0
    v_mfma_f32_16x16x32_bf16 v[120:123], v[72:75], v[40:43], v[120:123]
    ds_read_b128 v[48:51], v25 offset:0
    v_mfma_f32_16x16x32_bf16 v[124:127], v[76:79], v[40:43], v[124:127]
    ds_read_b128 v[52:55], v25 offset:2048
    v_mfma_f32_16x16x32_bf16 v[128:131], v[80:83], v[40:43], v[128:131]
    ds_read_b128 v[56:59], v25 offset:4096
    v_mfma_f32_16x16x32_bf16 v[132:135], v[84:87], v[40:43], v[132:135]
    ds_read_b128 v[60:63], v25 offset:6144
    v_mfma_f32_16x16x32_bf16 v[156:159], v[164:167], v[40:43], v[156:159]
    ds_read_b128 v[64:67], v25 offset:8192
    v_mfma_f32_16x16x32_bf16 v[136:139], v[68:71], v[44:47], v[136:139]
    ds_read_b128 v[36:39], v13 offset:2048
    v_mfma_f32_16x16x32_bf16 v[140:143], v[72:75], v[44:47], v[140:143]
    v_mfma_f32_16x16x32_bf16 v[144:147], v[76:79], v[44:47], v[144:147]
    v_mfma_f32_16x16x32_bf16 v[148:151], v[80:83], v[44:47], v[148:151]
    v_mfma_f32_16x16x32_bf16 v[152:155], v[84:87], v[44:47], v[152:155]
    v_mfma_f32_16x16x32_bf16 v[160:163], v[164:167], v[44:47], v[160:163]
    s_waitcnt lgkmcnt(0)
    v_mfma_f32_16x16x32_bf16 v[116:119], v[48:51], v[32:35], v[116:119]
    ds_read_b128 v[40:43], v14 offset:0
    v_mfma_f32_16x16x32_bf16 v[120:123], v[52:55], v[32:35], v[120:123]
    ds_read_b128 v[68:71], v26 offset:0
    v_mfma_f32_16x16x32_bf16 v[124:127], v[56:59], v[32:35], v[124:127]
    ds_read_b128 v[72:75], v26 offset:2048
    v_mfma_f32_16x16x32_bf16 v[128:131], v[60:63], v[32:35], v[128:131]
    ds_read_b128 v[76:79], v26 offset:4096
    v_mfma_f32_16x16x32_bf16 v[132:135], v[64:67], v[32:35], v[132:135]
    ds_read_b128 v[80:83], v26 offset:6144
    v_mfma_f32_16x16x32_bf16 v[156:159], v[164:167], v[32:35], v[156:159]
    ds_read_b128 v[84:87], v26 offset:8192
    v_mfma_f32_16x16x32_bf16 v[136:139], v[48:51], v[36:39], v[136:139]
    ds_read_b128 v[44:47], v14 offset:2048
    v_mfma_f32_16x16x32_bf16 v[140:143], v[52:55], v[36:39], v[140:143]
    v_mfma_f32_16x16x32_bf16 v[144:147], v[56:59], v[36:39], v[144:147]
    v_mfma_f32_16x16x32_bf16 v[148:151], v[60:63], v[36:39], v[148:151]
    v_mfma_f32_16x16x32_bf16 v[152:155], v[64:67], v[36:39], v[152:155]
    v_mfma_f32_16x16x32_bf16 v[160:163], v[164:167], v[36:39], v[160:163]
    s_waitcnt lgkmcnt(0)
    s_barrier
    v_mfma_f32_16x16x32_bf16 v[116:119], v[68:71], v[40:43], v[116:119]
    ds_read_b128 v[32:35], v15 offset:0
    v_mfma_f32_16x16x32_bf16 v[120:123], v[72:75], v[40:43], v[120:123]
    ds_read_b128 v[48:51], v27 offset:0
    v_mfma_f32_16x16x32_bf16 v[124:127], v[76:79], v[40:43], v[124:127]
    ds_read_b128 v[52:55], v27 offset:2048
    v_mfma_f32_16x16x32_bf16 v[128:131], v[80:83], v[40:43], v[128:131]
    ds_read_b128 v[56:59], v27 offset:4096
    v_mfma_f32_16x16x32_bf16 v[132:135], v[84:87], v[40:43], v[132:135]
    ds_read_b128 v[60:63], v27 offset:6144
    v_mfma_f32_16x16x32_bf16 v[156:159], v[164:167], v[40:43], v[156:159]
    ds_read_b128 v[64:67], v27 offset:8192
    v_mfma_f32_16x16x32_bf16 v[136:139], v[68:71], v[44:47], v[136:139]
    ds_read_b128 v[36:39], v15 offset:2048
    v_mfma_f32_16x16x32_bf16 v[140:143], v[72:75], v[44:47], v[140:143]
    v_mfma_f32_16x16x32_bf16 v[144:147], v[76:79], v[44:47], v[144:147]
    v_mfma_f32_16x16x32_bf16 v[148:151], v[80:83], v[44:47], v[148:151]
    v_mfma_f32_16x16x32_bf16 v[152:155], v[84:87], v[44:47], v[152:155]
    v_mfma_f32_16x16x32_bf16 v[160:163], v[164:167], v[44:47], v[160:163]
    s_waitcnt lgkmcnt(0)
    v_mfma_f32_16x16x32_bf16 v[116:119], v[48:51], v[32:35], v[116:119]
    ds_read_b128 v[40:43], v16 offset:0
    v_mfma_f32_16x16x32_bf16 v[120:123], v[52:55], v[32:35], v[120:123]
    ds_read_b128 v[68:71], v28 offset:0
    v_mfma_f32_16x16x32_bf16 v[124:127], v[56:59], v[32:35], v[124:127]
    ds_read_b128 v[72:75], v28 offset:2048
    v_mfma_f32_16x16x32_bf16 v[128:131], v[60:63], v[32:35], v[128:131]
    ds_read_b128 v[76:79], v28 offset:4096
    v_mfma_f32_16x16x32_bf16 v[132:135], v[64:67], v[32:35], v[132:135]
    ds_read_b128 v[80:83], v28 offset:6144
    v_mfma_f32_16x16x32_bf16 v[156:159], v[164:167], v[32:35], v[156:159]
    ds_read_b128 v[84:87], v28 offset:8192
    v_mfma_f32_16x16x32_bf16 v[136:139], v[48:51], v[36:39], v[136:139]
    ds_read_b128 v[44:47], v16 offset:2048
    v_mfma_f32_16x16x32_bf16 v[140:143], v[52:55], v[36:39], v[140:143]
    v_mfma_f32_16x16x32_bf16 v[144:147], v[56:59], v[36:39], v[144:147]
    v_mfma_f32_16x16x32_bf16 v[148:151], v[60:63], v[36:39], v[148:151]
    v_mfma_f32_16x16x32_bf16 v[152:155], v[64:67], v[36:39], v[152:155]
    v_mfma_f32_16x16x32_bf16 v[160:163], v[164:167], v[36:39], v[160:163]
    s_waitcnt lgkmcnt(0)
    s_barrier
    v_mfma_f32_16x16x32_bf16 v[116:119], v[68:71], v[40:43], v[116:119]
    ds_read_b128 v[32:35], v17 offset:0
    v_mfma_f32_16x16x32_bf16 v[120:123], v[72:75], v[40:43], v[120:123]
    ds_read_b128 v[48:51], v29 offset:0
    v_mfma_f32_16x16x32_bf16 v[124:127], v[76:79], v[40:43], v[124:127]
    ds_read_b128 v[52:55], v29 offset:2048
    v_mfma_f32_16x16x32_bf16 v[128:131], v[80:83], v[40:43], v[128:131]
    ds_read_b128 v[56:59], v29 offset:4096
    v_mfma_f32_16x16x32_bf16 v[132:135], v[84:87], v[40:43], v[132:135]
    ds_read_b128 v[60:63], v29 offset:6144
    v_mfma_f32_16x16x32_bf16 v[156:159], v[164:167], v[40:43], v[156:159]
    ds_read_b128 v[64:67], v29 offset:8192
    v_mfma_f32_16x16x32_bf16 v[136:139], v[68:71], v[44:47], v[136:139]
    ds_read_b128 v[36:39], v17 offset:2048
    v_mfma_f32_16x16x32_bf16 v[140:143], v[72:75], v[44:47], v[140:143]
    v_mfma_f32_16x16x32_bf16 v[144:147], v[76:79], v[44:47], v[144:147]
    v_mfma_f32_16x16x32_bf16 v[148:151], v[80:83], v[44:47], v[148:151]
    v_mfma_f32_16x16x32_bf16 v[152:155], v[84:87], v[44:47], v[152:155]
    v_mfma_f32_16x16x32_bf16 v[160:163], v[164:167], v[44:47], v[160:163]
    s_waitcnt lgkmcnt(0)
    v_mfma_f32_16x16x32_bf16 v[116:119], v[48:51], v[32:35], v[116:119]
    ds_read_b128 v[40:43], v18 offset:0
    v_mfma_f32_16x16x32_bf16 v[120:123], v[52:55], v[32:35], v[120:123]
    ds_read_b128 v[68:71], v30 offset:0
    v_mfma_f32_16x16x32_bf16 v[124:127], v[56:59], v[32:35], v[124:127]
    ds_read_b128 v[72:75], v30 offset:2048
    v_mfma_f32_16x16x32_bf16 v[128:131], v[60:63], v[32:35], v[128:131]
    ds_read_b128 v[76:79], v30 offset:4096
    v_mfma_f32_16x16x32_bf16 v[132:135], v[64:67], v[32:35], v[132:135]
    ds_read_b128 v[80:83], v30 offset:6144
    v_mfma_f32_16x16x32_bf16 v[156:159], v[164:167], v[32:35], v[156:159]
    ds_read_b128 v[84:87], v30 offset:8192
    v_mfma_f32_16x16x32_bf16 v[136:139], v[48:51], v[36:39], v[136:139]
    ds_read_b128 v[44:47], v18 offset:2048
    v_mfma_f32_16x16x32_bf16 v[140:143], v[52:55], v[36:39], v[140:143]
    v_mfma_f32_16x16x32_bf16 v[144:147], v[56:59], v[36:39], v[144:147]
    v_mfma_f32_16x16x32_bf16 v[148:151], v[60:63], v[36:39], v[148:151]
    v_mfma_f32_16x16x32_bf16 v[152:155], v[64:67], v[36:39], v[152:155]
    v_mfma_f32_16x16x32_bf16 v[160:163], v[164:167], v[36:39], v[160:163]
    s_waitcnt lgkmcnt(0)
    s_barrier
    v_mfma_f32_16x16x32_bf16 v[116:119], v[68:71], v[40:43], v[116:119]
    ds_read_b128 v[32:35], v7 offset:0
    v_mfma_f32_16x16x32_bf16 v[120:123], v[72:75], v[40:43], v[120:123]
    ds_read_b128 v[48:51], v19 offset:0
    v_mfma_f32_16x16x32_bf16 v[124:127], v[76:79], v[40:43], v[124:127]
    ds_read_b128 v[52:55], v19 offset:2048
    v_mfma_f32_16x16x32_bf16 v[128:131], v[80:83], v[40:43], v[128:131]
    ds_read_b128 v[56:59], v19 offset:4096
    v_mfma_f32_16x16x32_bf16 v[132:135], v[84:87], v[40:43], v[132:135]
    ds_read_b128 v[60:63], v19 offset:6144
    v_mfma_f32_16x16x32_bf16 v[156:159], v[164:167], v[40:43], v[156:159]
    ds_read_b128 v[64:67], v19 offset:8192
    v_mfma_f32_16x16x32_bf16 v[136:139], v[68:71], v[44:47], v[136:139]
    ds_read_b128 v[36:39], v7 offset:2048
    v_mfma_f32_16x16x32_bf16 v[140:143], v[72:75], v[44:47], v[140:143]
    v_mfma_f32_16x16x32_bf16 v[144:147], v[76:79], v[44:47], v[144:147]
    v_mfma_f32_16x16x32_bf16 v[148:151], v[80:83], v[44:47], v[148:151]
    v_mfma_f32_16x16x32_bf16 v[152:155], v[84:87], v[44:47], v[152:155]
    v_mfma_f32_16x16x32_bf16 v[160:163], v[164:167], v[44:47], v[160:163]
    s_waitcnt lgkmcnt(0)
    v_mfma_f32_16x16x32_bf16 v[116:119], v[48:51], v[32:35], v[116:119]
    ds_read_b128 v[40:43], v8 offset:0
    v_mfma_f32_16x16x32_bf16 v[120:123], v[52:55], v[32:35], v[120:123]
    ds_read_b128 v[68:71], v20 offset:0
    v_mfma_f32_16x16x32_bf16 v[124:127], v[56:59], v[32:35], v[124:127]
    ds_read_b128 v[72:75], v20 offset:2048
    v_mfma_f32_16x16x32_bf16 v[128:131], v[60:63], v[32:35], v[128:131]
    ds_read_b128 v[76:79], v20 offset:4096
    v_mfma_f32_16x16x32_bf16 v[132:135], v[64:67], v[32:35], v[132:135]
    ds_read_b128 v[80:83], v20 offset:6144
    v_mfma_f32_16x16x32_bf16 v[156:159], v[164:167], v[32:35], v[156:159]
    ds_read_b128 v[84:87], v20 offset:8192
    v_mfma_f32_16x16x32_bf16 v[136:139], v[48:51], v[36:39], v[136:139]
    ds_read_b128 v[44:47], v8 offset:2048
    v_mfma_f32_16x16x32_bf16 v[140:143], v[52:55], v[36:39], v[140:143]
    v_mfma_f32_16x16x32_bf16 v[144:147], v[56:59], v[36:39], v[144:147]
    v_mfma_f32_16x16x32_bf16 v[148:151], v[60:63], v[36:39], v[148:151]
    v_mfma_f32_16x16x32_bf16 v[152:155], v[64:67], v[36:39], v[152:155]
    v_mfma_f32_16x16x32_bf16 v[160:163], v[164:167], v[36:39], v[160:163]
    s_waitcnt lgkmcnt(0)
    s_barrier
    v_mfma_f32_16x16x32_bf16 v[116:119], v[68:71], v[40:43], v[116:119]
    ds_read_b128 v[32:35], v9 offset:0
    v_mfma_f32_16x16x32_bf16 v[120:123], v[72:75], v[40:43], v[120:123]
    ds_read_b128 v[48:51], v21 offset:0
    v_mfma_f32_16x16x32_bf16 v[124:127], v[76:79], v[40:43], v[124:127]
    ds_read_b128 v[52:55], v21 offset:2048
    v_mfma_f32_16x16x32_bf16 v[128:131], v[80:83], v[40:43], v[128:131]
    ds_read_b128 v[56:59], v21 offset:4096
    v_mfma_f32_16x16x32_bf16 v[132:135], v[84:87], v[40:43], v[132:135]
    ds_read_b128 v[60:63], v21 offset:6144
    v_mfma_f32_16x16x32_bf16 v[156:159], v[164:167], v[40:43], v[156:159]
    ds_read_b128 v[64:67], v21 offset:8192
    v_mfma_f32_16x16x32_bf16 v[136:139], v[68:71], v[44:47], v[136:139]
    ds_read_b128 v[36:39], v9 offset:2048
    v_mfma_f32_16x16x32_bf16 v[140:143], v[72:75], v[44:47], v[140:143]
    v_mfma_f32_16x16x32_bf16 v[144:147], v[76:79], v[44:47], v[144:147]
    v_mfma_f32_16x16x32_bf16 v[148:151], v[80:83], v[44:47], v[148:151]
    v_mfma_f32_16x16x32_bf16 v[152:155], v[84:87], v[44:47], v[152:155]
    v_mfma_f32_16x16x32_bf16 v[160:163], v[164:167], v[44:47], v[160:163]
    s_waitcnt lgkmcnt(0)
    v_mfma_f32_16x16x32_bf16 v[116:119], v[48:51], v[32:35], v[116:119]
    ds_read_b128 v[40:43], v10 offset:0
    v_mfma_f32_16x16x32_bf16 v[120:123], v[52:55], v[32:35], v[120:123]
    ds_read_b128 v[68:71], v22 offset:0
    v_mfma_f32_16x16x32_bf16 v[124:127], v[56:59], v[32:35], v[124:127]
    ds_read_b128 v[72:75], v22 offset:2048
    v_mfma_f32_16x16x32_bf16 v[128:131], v[60:63], v[32:35], v[128:131]
    ds_read_b128 v[76:79], v22 offset:4096
    v_mfma_f32_16x16x32_bf16 v[132:135], v[64:67], v[32:35], v[132:135]
    ds_read_b128 v[80:83], v22 offset:6144
    v_mfma_f32_16x16x32_bf16 v[156:159], v[164:167], v[32:35], v[156:159]
    ds_read_b128 v[84:87], v22 offset:8192
    v_mfma_f32_16x16x32_bf16 v[136:139], v[48:51], v[36:39], v[136:139]
    ds_read_b128 v[44:47], v10 offset:2048
    v_mfma_f32_16x16x32_bf16 v[140:143], v[52:55], v[36:39], v[140:143]
    v_mfma_f32_16x16x32_bf16 v[144:147], v[56:59], v[36:39], v[144:147]
    v_mfma_f32_16x16x32_bf16 v[148:151], v[60:63], v[36:39], v[148:151]
    v_mfma_f32_16x16x32_bf16 v[152:155], v[64:67], v[36:39], v[152:155]
    v_mfma_f32_16x16x32_bf16 v[160:163], v[164:167], v[36:39], v[160:163]
    s_waitcnt lgkmcnt(0)
    s_barrier
    v_mfma_f32_16x16x32_bf16 v[116:119], v[68:71], v[40:43], v[116:119]
    ds_read_b128 v[32:35], v11 offset:0
    v_mfma_f32_16x16x32_bf16 v[120:123], v[72:75], v[40:43], v[120:123]
    ds_read_b128 v[48:51], v23 offset:0
    v_mfma_f32_16x16x32_bf16 v[124:127], v[76:79], v[40:43], v[124:127]
    ds_read_b128 v[52:55], v23 offset:2048
    v_mfma_f32_16x16x32_bf16 v[128:131], v[80:83], v[40:43], v[128:131]
    ds_read_b128 v[56:59], v23 offset:4096
    v_mfma_f32_16x16x32_bf16 v[132:135], v[84:87], v[40:43], v[132:135]
    ds_read_b128 v[60:63], v23 offset:6144
    v_mfma_f32_16x16x32_bf16 v[156:159], v[164:167], v[40:43], v[156:159]
    ds_read_b128 v[64:67], v23 offset:8192
    v_mfma_f32_16x16x32_bf16 v[136:139], v[68:71], v[44:47], v[136:139]
    ds_read_b128 v[36:39], v11 offset:2048
    v_mfma_f32_16x16x32_bf16 v[140:143], v[72:75], v[44:47], v[140:143]
    v_mfma_f32_16x16x32_bf16 v[144:147], v[76:79], v[44:47], v[144:147]
    v_mfma_f32_16x16x32_bf16 v[148:151], v[80:83], v[44:47], v[148:151]
    v_mfma_f32_16x16x32_bf16 v[152:155], v[84:87], v[44:47], v[152:155]
    v_mfma_f32_16x16x32_bf16 v[160:163], v[164:167], v[44:47], v[160:163]
    s_waitcnt lgkmcnt(0)
    v_mfma_f32_16x16x32_bf16 v[116:119], v[48:51], v[32:35], v[116:119]
    ds_read_b128 v[40:43], v12 offset:0
    v_mfma_f32_16x16x32_bf16 v[120:123], v[52:55], v[32:35], v[120:123]
    ds_read_b128 v[68:71], v24 offset:0
    v_mfma_f32_16x16x32_bf16 v[124:127], v[56:59], v[32:35], v[124:127]
    ds_read_b128 v[72:75], v24 offset:2048
    v_mfma_f32_16x16x32_bf16 v[128:131], v[60:63], v[32:35], v[128:131]
    ds_read_b128 v[76:79], v24 offset:4096
    v_mfma_f32_16x16x32_bf16 v[132:135], v[64:67], v[32:35], v[132:135]
    ds_read_b128 v[80:83], v24 offset:6144
    v_mfma_f32_16x16x32_bf16 v[156:159], v[164:167], v[32:35], v[156:159]
    ds_read_b128 v[84:87], v24 offset:8192
    v_mfma_f32_16x16x32_bf16 v[136:139], v[48:51], v[36:39], v[136:139]
    ds_read_b128 v[44:47], v12 offset:2048
    v_mfma_f32_16x16x32_bf16 v[140:143], v[52:55], v[36:39], v[140:143]
    v_mfma_f32_16x16x32_bf16 v[144:147], v[56:59], v[36:39], v[144:147]
    v_mfma_f32_16x16x32_bf16 v[148:151], v[60:63], v[36:39], v[148:151]
    v_mfma_f32_16x16x32_bf16 v[152:155], v[64:67], v[36:39], v[152:155]
    v_mfma_f32_16x16x32_bf16 v[160:163], v[164:167], v[36:39], v[160:163]
    s_waitcnt lgkmcnt(0)
    s_barrier
    v_mfma_f32_16x16x32_bf16 v[116:119], v[68:71], v[40:43], v[116:119]
    ds_read_b128 v[32:35], v13 offset:0
    v_mfma_f32_16x16x32_bf16 v[120:123], v[72:75], v[40:43], v[120:123]
    ds_read_b128 v[48:51], v25 offset:0
    v_mfma_f32_16x16x32_bf16 v[124:127], v[76:79], v[40:43], v[124:127]
    ds_read_b128 v[52:55], v25 offset:2048
    v_mfma_f32_16x16x32_bf16 v[128:131], v[80:83], v[40:43], v[128:131]
    ds_read_b128 v[56:59], v25 offset:4096
    v_mfma_f32_16x16x32_bf16 v[132:135], v[84:87], v[40:43], v[132:135]
    ds_read_b128 v[60:63], v25 offset:6144
    v_mfma_f32_16x16x32_bf16 v[156:159], v[164:167], v[40:43], v[156:159]
    ds_read_b128 v[64:67], v25 offset:8192
    v_mfma_f32_16x16x32_bf16 v[136:139], v[68:71], v[44:47], v[136:139]
    ds_read_b128 v[36:39], v13 offset:2048
    v_mfma_f32_16x16x32_bf16 v[140:143], v[72:75], v[44:47], v[140:143]
    v_mfma_f32_16x16x32_bf16 v[144:147], v[76:79], v[44:47], v[144:147]
    v_mfma_f32_16x16x32_bf16 v[148:151], v[80:83], v[44:47], v[148:151]
    v_mfma_f32_16x16x32_bf16 v[152:155], v[84:87], v[44:47], v[152:155]
    v_mfma_f32_16x16x32_bf16 v[160:163], v[164:167], v[44:47], v[160:163]
    s_waitcnt lgkmcnt(0)
    v_mfma_f32_16x16x32_bf16 v[116:119], v[48:51], v[32:35], v[116:119]
    ds_read_b128 v[40:43], v14 offset:0
    v_mfma_f32_16x16x32_bf16 v[120:123], v[52:55], v[32:35], v[120:123]
    ds_read_b128 v[68:71], v26 offset:0
    v_mfma_f32_16x16x32_bf16 v[124:127], v[56:59], v[32:35], v[124:127]
    ds_read_b128 v[72:75], v26 offset:2048
    v_mfma_f32_16x16x32_bf16 v[128:131], v[60:63], v[32:35], v[128:131]
    ds_read_b128 v[76:79], v26 offset:4096
    v_mfma_f32_16x16x32_bf16 v[132:135], v[64:67], v[32:35], v[132:135]
    ds_read_b128 v[80:83], v26 offset:6144
    v_mfma_f32_16x16x32_bf16 v[156:159], v[164:167], v[32:35], v[156:159]
    ds_read_b128 v[84:87], v26 offset:8192
    v_mfma_f32_16x16x32_bf16 v[136:139], v[48:51], v[36:39], v[136:139]
    ds_read_b128 v[44:47], v14 offset:2048
    v_mfma_f32_16x16x32_bf16 v[140:143], v[52:55], v[36:39], v[140:143]
    v_mfma_f32_16x16x32_bf16 v[144:147], v[56:59], v[36:39], v[144:147]
    v_mfma_f32_16x16x32_bf16 v[148:151], v[60:63], v[36:39], v[148:151]
    v_mfma_f32_16x16x32_bf16 v[152:155], v[64:67], v[36:39], v[152:155]
    v_mfma_f32_16x16x32_bf16 v[160:163], v[164:167], v[36:39], v[160:163]
    s_waitcnt lgkmcnt(0)
    s_barrier
    v_mfma_f32_16x16x32_bf16 v[116:119], v[68:71], v[40:43], v[116:119]
    ds_read_b128 v[32:35], v15 offset:0
    v_mfma_f32_16x16x32_bf16 v[120:123], v[72:75], v[40:43], v[120:123]
    ds_read_b128 v[48:51], v27 offset:0
    v_mfma_f32_16x16x32_bf16 v[124:127], v[76:79], v[40:43], v[124:127]
    ds_read_b128 v[52:55], v27 offset:2048
    v_mfma_f32_16x16x32_bf16 v[128:131], v[80:83], v[40:43], v[128:131]
    ds_read_b128 v[56:59], v27 offset:4096
    v_mfma_f32_16x16x32_bf16 v[132:135], v[84:87], v[40:43], v[132:135]
    ds_read_b128 v[60:63], v27 offset:6144
    v_mfma_f32_16x16x32_bf16 v[156:159], v[164:167], v[40:43], v[156:159]
    ds_read_b128 v[64:67], v27 offset:8192
    v_mfma_f32_16x16x32_bf16 v[136:139], v[68:71], v[44:47], v[136:139]
    ds_read_b128 v[36:39], v15 offset:2048
    v_mfma_f32_16x16x32_bf16 v[140:143], v[72:75], v[44:47], v[140:143]
    v_mfma_f32_16x16x32_bf16 v[144:147], v[76:79], v[44:47], v[144:147]
    v_mfma_f32_16x16x32_bf16 v[148:151], v[80:83], v[44:47], v[148:151]
    v_mfma_f32_16x16x32_bf16 v[152:155], v[84:87], v[44:47], v[152:155]
    v_mfma_f32_16x16x32_bf16 v[160:163], v[164:167], v[44:47], v[160:163]
    s_waitcnt lgkmcnt(0)
    v_mfma_f32_16x16x32_bf16 v[116:119], v[48:51], v[32:35], v[116:119]
    ds_read_b128 v[40:43], v16 offset:0
    v_mfma_f32_16x16x32_bf16 v[120:123], v[52:55], v[32:35], v[120:123]
    ds_read_b128 v[68:71], v28 offset:0
    v_mfma_f32_16x16x32_bf16 v[124:127], v[56:59], v[32:35], v[124:127]
    ds_read_b128 v[72:75], v28 offset:2048
    v_mfma_f32_16x16x32_bf16 v[128:131], v[60:63], v[32:35], v[128:131]
    ds_read_b128 v[76:79], v28 offset:4096
    v_mfma_f32_16x16x32_bf16 v[132:135], v[64:67], v[32:35], v[132:135]
    ds_read_b128 v[80:83], v28 offset:6144
    v_mfma_f32_16x16x32_bf16 v[156:159], v[164:167], v[32:35], v[156:159]
    ds_read_b128 v[84:87], v28 offset:8192
    v_mfma_f32_16x16x32_bf16 v[136:139], v[48:51], v[36:39], v[136:139]
    ds_read_b128 v[44:47], v16 offset:2048
    v_mfma_f32_16x16x32_bf16 v[140:143], v[52:55], v[36:39], v[140:143]
    v_mfma_f32_16x16x32_bf16 v[144:147], v[56:59], v[36:39], v[144:147]
    v_mfma_f32_16x16x32_bf16 v[148:151], v[60:63], v[36:39], v[148:151]
    v_mfma_f32_16x16x32_bf16 v[152:155], v[64:67], v[36:39], v[152:155]
    v_mfma_f32_16x16x32_bf16 v[160:163], v[164:167], v[36:39], v[160:163]
    s_waitcnt lgkmcnt(0)
    s_barrier
    v_mfma_f32_16x16x32_bf16 v[116:119], v[68:71], v[40:43], v[116:119]
    ds_read_b128 v[32:35], v17 offset:0
    v_mfma_f32_16x16x32_bf16 v[120:123], v[72:75], v[40:43], v[120:123]
    ds_read_b128 v[48:51], v29 offset:0
    v_mfma_f32_16x16x32_bf16 v[124:127], v[76:79], v[40:43], v[124:127]
    ds_read_b128 v[52:55], v29 offset:2048
    v_mfma_f32_16x16x32_bf16 v[128:131], v[80:83], v[40:43], v[128:131]
    ds_read_b128 v[56:59], v29 offset:4096
    v_mfma_f32_16x16x32_bf16 v[132:135], v[84:87], v[40:43], v[132:135]
    ds_read_b128 v[60:63], v29 offset:6144
    v_mfma_f32_16x16x32_bf16 v[156:159], v[164:167], v[40:43], v[156:159]
    ds_read_b128 v[64:67], v29 offset:8192
    v_mfma_f32_16x16x32_bf16 v[136:139], v[68:71], v[44:47], v[136:139]
    ds_read_b128 v[36:39], v17 offset:2048
    v_mfma_f32_16x16x32_bf16 v[140:143], v[72:75], v[44:47], v[140:143]
    v_mfma_f32_16x16x32_bf16 v[144:147], v[76:79], v[44:47], v[144:147]
    v_mfma_f32_16x16x32_bf16 v[148:151], v[80:83], v[44:47], v[148:151]
    v_mfma_f32_16x16x32_bf16 v[152:155], v[84:87], v[44:47], v[152:155]
    v_mfma_f32_16x16x32_bf16 v[160:163], v[164:167], v[44:47], v[160:163]
    s_waitcnt lgkmcnt(0)
    v_mfma_f32_16x16x32_bf16 v[116:119], v[48:51], v[32:35], v[116:119]
    ds_read_b128 v[40:43], v18 offset:0
    v_mfma_f32_16x16x32_bf16 v[120:123], v[52:55], v[32:35], v[120:123]
    ds_read_b128 v[68:71], v30 offset:0
    v_mfma_f32_16x16x32_bf16 v[124:127], v[56:59], v[32:35], v[124:127]
    ds_read_b128 v[72:75], v30 offset:2048
    v_mfma_f32_16x16x32_bf16 v[128:131], v[60:63], v[32:35], v[128:131]
    ds_read_b128 v[76:79], v30 offset:4096
    v_mfma_f32_16x16x32_bf16 v[132:135], v[64:67], v[32:35], v[132:135]
    ds_read_b128 v[80:83], v30 offset:6144
    v_mfma_f32_16x16x32_bf16 v[156:159], v[164:167], v[32:35], v[156:159]
    ds_read_b128 v[84:87], v30 offset:8192
    v_mfma_f32_16x16x32_bf16 v[136:139], v[48:51], v[36:39], v[136:139]
    ds_read_b128 v[44:47], v18 offset:2048
    v_mfma_f32_16x16x32_bf16 v[140:143], v[52:55], v[36:39], v[140:143]
    v_mfma_f32_16x16x32_bf16 v[144:147], v[56:59], v[36:39], v[144:147]
    v_mfma_f32_16x16x32_bf16 v[148:151], v[60:63], v[36:39], v[148:151]
    v_mfma_f32_16x16x32_bf16 v[152:155], v[64:67], v[36:39], v[152:155]
    v_mfma_f32_16x16x32_bf16 v[160:163], v[164:167], v[36:39], v[160:163]
    s_waitcnt lgkmcnt(0)
    s_barrier
    v_mfma_f32_16x16x32_bf16 v[116:119], v[68:71], v[40:43], v[116:119]
    ds_read_b128 v[32:35], v7 offset:0
    v_mfma_f32_16x16x32_bf16 v[120:123], v[72:75], v[40:43], v[120:123]
    ds_read_b128 v[48:51], v19 offset:0
    v_mfma_f32_16x16x32_bf16 v[124:127], v[76:79], v[40:43], v[124:127]
    ds_read_b128 v[52:55], v19 offset:2048
    v_mfma_f32_16x16x32_bf16 v[128:131], v[80:83], v[40:43], v[128:131]
    ds_read_b128 v[56:59], v19 offset:4096
    v_mfma_f32_16x16x32_bf16 v[132:135], v[84:87], v[40:43], v[132:135]
    ds_read_b128 v[60:63], v19 offset:6144
    v_mfma_f32_16x16x32_bf16 v[156:159], v[164:167], v[40:43], v[156:159]
    ds_read_b128 v[64:67], v19 offset:8192
    v_mfma_f32_16x16x32_bf16 v[136:139], v[68:71], v[44:47], v[136:139]
    ds_read_b128 v[36:39], v7 offset:2048
    v_mfma_f32_16x16x32_bf16 v[140:143], v[72:75], v[44:47], v[140:143]
    v_mfma_f32_16x16x32_bf16 v[144:147], v[76:79], v[44:47], v[144:147]
    v_mfma_f32_16x16x32_bf16 v[148:151], v[80:83], v[44:47], v[148:151]
    v_mfma_f32_16x16x32_bf16 v[152:155], v[84:87], v[44:47], v[152:155]
    v_mfma_f32_16x16x32_bf16 v[160:163], v[164:167], v[44:47], v[160:163]
    s_waitcnt lgkmcnt(0)
    v_mfma_f32_16x16x32_bf16 v[116:119], v[48:51], v[32:35], v[116:119]
    ds_read_b128 v[40:43], v8 offset:0
    v_mfma_f32_16x16x32_bf16 v[120:123], v[52:55], v[32:35], v[120:123]
    ds_read_b128 v[68:71], v20 offset:0
    v_mfma_f32_16x16x32_bf16 v[124:127], v[56:59], v[32:35], v[124:127]
    ds_read_b128 v[72:75], v20 offset:2048
    v_mfma_f32_16x16x32_bf16 v[128:131], v[60:63], v[32:35], v[128:131]
    ds_read_b128 v[76:79], v20 offset:4096
    v_mfma_f32_16x16x32_bf16 v[132:135], v[64:67], v[32:35], v[132:135]
    ds_read_b128 v[80:83], v20 offset:6144
    v_mfma_f32_16x16x32_bf16 v[156:159], v[164:167], v[32:35], v[156:159]
    ds_read_b128 v[84:87], v20 offset:8192
    v_mfma_f32_16x16x32_bf16 v[136:139], v[48:51], v[36:39], v[136:139]
    ds_read_b128 v[44:47], v8 offset:2048
    v_mfma_f32_16x16x32_bf16 v[140:143], v[52:55], v[36:39], v[140:143]
    v_mfma_f32_16x16x32_bf16 v[144:147], v[56:59], v[36:39], v[144:147]
    v_mfma_f32_16x16x32_bf16 v[148:151], v[60:63], v[36:39], v[148:151]
    v_mfma_f32_16x16x32_bf16 v[152:155], v[64:67], v[36:39], v[152:155]
    v_mfma_f32_16x16x32_bf16 v[160:163], v[164:167], v[36:39], v[160:163]
    s_waitcnt lgkmcnt(0)
    s_barrier
    v_mfma_f32_16x16x32_bf16 v[116:119], v[68:71], v[40:43], v[116:119]
    ds_read_b128 v[32:35], v9 offset:0
    v_mfma_f32_16x16x32_bf16 v[120:123], v[72:75], v[40:43], v[120:123]
    ds_read_b128 v[48:51], v21 offset:0
    v_mfma_f32_16x16x32_bf16 v[124:127], v[76:79], v[40:43], v[124:127]
    ds_read_b128 v[52:55], v21 offset:2048
    v_mfma_f32_16x16x32_bf16 v[128:131], v[80:83], v[40:43], v[128:131]
    ds_read_b128 v[56:59], v21 offset:4096
    v_mfma_f32_16x16x32_bf16 v[132:135], v[84:87], v[40:43], v[132:135]
    ds_read_b128 v[60:63], v21 offset:6144
    v_mfma_f32_16x16x32_bf16 v[156:159], v[164:167], v[40:43], v[156:159]
    ds_read_b128 v[64:67], v21 offset:8192
    v_mfma_f32_16x16x32_bf16 v[136:139], v[68:71], v[44:47], v[136:139]
    ds_read_b128 v[36:39], v9 offset:2048
    v_mfma_f32_16x16x32_bf16 v[140:143], v[72:75], v[44:47], v[140:143]
    v_mfma_f32_16x16x32_bf16 v[144:147], v[76:79], v[44:47], v[144:147]
    v_mfma_f32_16x16x32_bf16 v[148:151], v[80:83], v[44:47], v[148:151]
    v_mfma_f32_16x16x32_bf16 v[152:155], v[84:87], v[44:47], v[152:155]
    v_mfma_f32_16x16x32_bf16 v[160:163], v[164:167], v[44:47], v[160:163]
    s_waitcnt lgkmcnt(0)
    v_mfma_f32_16x16x32_bf16 v[116:119], v[48:51], v[32:35], v[116:119]
    ds_read_b128 v[40:43], v10 offset:0
    v_mfma_f32_16x16x32_bf16 v[120:123], v[52:55], v[32:35], v[120:123]
    ds_read_b128 v[68:71], v22 offset:0
    v_mfma_f32_16x16x32_bf16 v[124:127], v[56:59], v[32:35], v[124:127]
    ds_read_b128 v[72:75], v22 offset:2048
    v_mfma_f32_16x16x32_bf16 v[128:131], v[60:63], v[32:35], v[128:131]
    ds_read_b128 v[76:79], v22 offset:4096
    v_mfma_f32_16x16x32_bf16 v[132:135], v[64:67], v[32:35], v[132:135]
    ds_read_b128 v[80:83], v22 offset:6144
    v_mfma_f32_16x16x32_bf16 v[156:159], v[164:167], v[32:35], v[156:159]
    ds_read_b128 v[84:87], v22 offset:8192
    v_mfma_f32_16x16x32_bf16 v[136:139], v[48:51], v[36:39], v[136:139]
    ds_read_b128 v[44:47], v10 offset:2048
    v_mfma_f32_16x16x32_bf16 v[140:143], v[52:55], v[36:39], v[140:143]
    v_mfma_f32_16x16x32_bf16 v[144:147], v[56:59], v[36:39], v[144:147]
    v_mfma_f32_16x16x32_bf16 v[148:151], v[60:63], v[36:39], v[148:151]
    v_mfma_f32_16x16x32_bf16 v[152:155], v[64:67], v[36:39], v[152:155]
    v_mfma_f32_16x16x32_bf16 v[160:163], v[164:167], v[36:39], v[160:163]
    s_waitcnt lgkmcnt(0)
    s_barrier
    v_mfma_f32_16x16x32_bf16 v[116:119], v[68:71], v[40:43], v[116:119]
    ds_read_b128 v[32:35], v11 offset:0
    v_mfma_f32_16x16x32_bf16 v[120:123], v[72:75], v[40:43], v[120:123]
    ds_read_b128 v[48:51], v23 offset:0
    v_mfma_f32_16x16x32_bf16 v[124:127], v[76:79], v[40:43], v[124:127]
    ds_read_b128 v[52:55], v23 offset:2048
    v_mfma_f32_16x16x32_bf16 v[128:131], v[80:83], v[40:43], v[128:131]
    ds_read_b128 v[56:59], v23 offset:4096
    v_mfma_f32_16x16x32_bf16 v[132:135], v[84:87], v[40:43], v[132:135]
    ds_read_b128 v[60:63], v23 offset:6144
    v_mfma_f32_16x16x32_bf16 v[156:159], v[164:167], v[40:43], v[156:159]
    ds_read_b128 v[64:67], v23 offset:8192
    v_mfma_f32_16x16x32_bf16 v[136:139], v[68:71], v[44:47], v[136:139]
    ds_read_b128 v[36:39], v11 offset:2048
    v_mfma_f32_16x16x32_bf16 v[140:143], v[72:75], v[44:47], v[140:143]
    v_mfma_f32_16x16x32_bf16 v[144:147], v[76:79], v[44:47], v[144:147]
    v_mfma_f32_16x16x32_bf16 v[148:151], v[80:83], v[44:47], v[148:151]
    v_mfma_f32_16x16x32_bf16 v[152:155], v[84:87], v[44:47], v[152:155]
    v_mfma_f32_16x16x32_bf16 v[160:163], v[164:167], v[44:47], v[160:163]
    s_waitcnt lgkmcnt(0)
    v_mfma_f32_16x16x32_bf16 v[116:119], v[48:51], v[32:35], v[116:119]
    ds_read_b128 v[40:43], v12 offset:0
    v_mfma_f32_16x16x32_bf16 v[120:123], v[52:55], v[32:35], v[120:123]
    ds_read_b128 v[68:71], v24 offset:0
    v_mfma_f32_16x16x32_bf16 v[124:127], v[56:59], v[32:35], v[124:127]
    ds_read_b128 v[72:75], v24 offset:2048
    v_mfma_f32_16x16x32_bf16 v[128:131], v[60:63], v[32:35], v[128:131]
    ds_read_b128 v[76:79], v24 offset:4096
    v_mfma_f32_16x16x32_bf16 v[132:135], v[64:67], v[32:35], v[132:135]
    ds_read_b128 v[80:83], v24 offset:6144
    v_mfma_f32_16x16x32_bf16 v[156:159], v[164:167], v[32:35], v[156:159]
    ds_read_b128 v[84:87], v24 offset:8192
    v_mfma_f32_16x16x32_bf16 v[136:139], v[48:51], v[36:39], v[136:139]
    ds_read_b128 v[44:47], v12 offset:2048
    v_mfma_f32_16x16x32_bf16 v[140:143], v[52:55], v[36:39], v[140:143]
    v_mfma_f32_16x16x32_bf16 v[144:147], v[56:59], v[36:39], v[144:147]
    v_mfma_f32_16x16x32_bf16 v[148:151], v[60:63], v[36:39], v[148:151]
    v_mfma_f32_16x16x32_bf16 v[152:155], v[64:67], v[36:39], v[152:155]
    v_mfma_f32_16x16x32_bf16 v[160:163], v[164:167], v[36:39], v[160:163]
    s_waitcnt lgkmcnt(0)
    s_barrier
    v_mfma_f32_16x16x32_bf16 v[116:119], v[68:71], v[40:43], v[116:119]
    ds_read_b128 v[32:35], v13 offset:0
    v_mfma_f32_16x16x32_bf16 v[120:123], v[72:75], v[40:43], v[120:123]
    ds_read_b128 v[48:51], v25 offset:0
    v_mfma_f32_16x16x32_bf16 v[124:127], v[76:79], v[40:43], v[124:127]
    ds_read_b128 v[52:55], v25 offset:2048
    v_mfma_f32_16x16x32_bf16 v[128:131], v[80:83], v[40:43], v[128:131]
    ds_read_b128 v[56:59], v25 offset:4096
    v_mfma_f32_16x16x32_bf16 v[132:135], v[84:87], v[40:43], v[132:135]
    ds_read_b128 v[60:63], v25 offset:6144
    v_mfma_f32_16x16x32_bf16 v[156:159], v[164:167], v[40:43], v[156:159]
    ds_read_b128 v[64:67], v25 offset:8192
    v_mfma_f32_16x16x32_bf16 v[136:139], v[68:71], v[44:47], v[136:139]
    ds_read_b128 v[36:39], v13 offset:2048
    v_mfma_f32_16x16x32_bf16 v[140:143], v[72:75], v[44:47], v[140:143]
    v_mfma_f32_16x16x32_bf16 v[144:147], v[76:79], v[44:47], v[144:147]
    v_mfma_f32_16x16x32_bf16 v[148:151], v[80:83], v[44:47], v[148:151]
    v_mfma_f32_16x16x32_bf16 v[152:155], v[84:87], v[44:47], v[152:155]
    v_mfma_f32_16x16x32_bf16 v[160:163], v[164:167], v[44:47], v[160:163]
    s_waitcnt lgkmcnt(0)
    v_mfma_f32_16x16x32_bf16 v[116:119], v[48:51], v[32:35], v[116:119]
    ds_read_b128 v[40:43], v14 offset:0
    v_mfma_f32_16x16x32_bf16 v[120:123], v[52:55], v[32:35], v[120:123]
    ds_read_b128 v[68:71], v26 offset:0
    v_mfma_f32_16x16x32_bf16 v[124:127], v[56:59], v[32:35], v[124:127]
    ds_read_b128 v[72:75], v26 offset:2048
    v_mfma_f32_16x16x32_bf16 v[128:131], v[60:63], v[32:35], v[128:131]
    ds_read_b128 v[76:79], v26 offset:4096
    v_mfma_f32_16x16x32_bf16 v[132:135], v[64:67], v[32:35], v[132:135]
    ds_read_b128 v[80:83], v26 offset:6144
    v_mfma_f32_16x16x32_bf16 v[156:159], v[164:167], v[32:35], v[156:159]
    ds_read_b128 v[84:87], v26 offset:8192
    v_mfma_f32_16x16x32_bf16 v[136:139], v[48:51], v[36:39], v[136:139]
    ds_read_b128 v[44:47], v14 offset:2048
    v_mfma_f32_16x16x32_bf16 v[140:143], v[52:55], v[36:39], v[140:143]
    v_mfma_f32_16x16x32_bf16 v[144:147], v[56:59], v[36:39], v[144:147]
    v_mfma_f32_16x16x32_bf16 v[148:151], v[60:63], v[36:39], v[148:151]
    v_mfma_f32_16x16x32_bf16 v[152:155], v[64:67], v[36:39], v[152:155]
    v_mfma_f32_16x16x32_bf16 v[160:163], v[164:167], v[36:39], v[160:163]
    s_waitcnt lgkmcnt(0)
    s_barrier
    v_mfma_f32_16x16x32_bf16 v[116:119], v[68:71], v[40:43], v[116:119]
    ds_read_b128 v[32:35], v15 offset:0
    v_mfma_f32_16x16x32_bf16 v[120:123], v[72:75], v[40:43], v[120:123]
    ds_read_b128 v[48:51], v27 offset:0
    v_mfma_f32_16x16x32_bf16 v[124:127], v[76:79], v[40:43], v[124:127]
    ds_read_b128 v[52:55], v27 offset:2048
    v_mfma_f32_16x16x32_bf16 v[128:131], v[80:83], v[40:43], v[128:131]
    ds_read_b128 v[56:59], v27 offset:4096
    v_mfma_f32_16x16x32_bf16 v[132:135], v[84:87], v[40:43], v[132:135]
    ds_read_b128 v[60:63], v27 offset:6144
    v_mfma_f32_16x16x32_bf16 v[156:159], v[164:167], v[40:43], v[156:159]
    ds_read_b128 v[64:67], v27 offset:8192
    v_mfma_f32_16x16x32_bf16 v[136:139], v[68:71], v[44:47], v[136:139]
    ds_read_b128 v[36:39], v15 offset:2048
    v_mfma_f32_16x16x32_bf16 v[140:143], v[72:75], v[44:47], v[140:143]
    v_mfma_f32_16x16x32_bf16 v[144:147], v[76:79], v[44:47], v[144:147]
    v_mfma_f32_16x16x32_bf16 v[148:151], v[80:83], v[44:47], v[148:151]
    v_mfma_f32_16x16x32_bf16 v[152:155], v[84:87], v[44:47], v[152:155]
    v_mfma_f32_16x16x32_bf16 v[160:163], v[164:167], v[44:47], v[160:163]
    s_waitcnt lgkmcnt(0)
    v_mfma_f32_16x16x32_bf16 v[116:119], v[48:51], v[32:35], v[116:119]
    ds_read_b128 v[40:43], v16 offset:0
    v_mfma_f32_16x16x32_bf16 v[120:123], v[52:55], v[32:35], v[120:123]
    ds_read_b128 v[68:71], v28 offset:0
    v_mfma_f32_16x16x32_bf16 v[124:127], v[56:59], v[32:35], v[124:127]
    ds_read_b128 v[72:75], v28 offset:2048
    v_mfma_f32_16x16x32_bf16 v[128:131], v[60:63], v[32:35], v[128:131]
    ds_read_b128 v[76:79], v28 offset:4096
    v_mfma_f32_16x16x32_bf16 v[132:135], v[64:67], v[32:35], v[132:135]
    ds_read_b128 v[80:83], v28 offset:6144
    v_mfma_f32_16x16x32_bf16 v[156:159], v[164:167], v[32:35], v[156:159]
    ds_read_b128 v[84:87], v28 offset:8192
    v_mfma_f32_16x16x32_bf16 v[136:139], v[48:51], v[36:39], v[136:139]
    ds_read_b128 v[44:47], v16 offset:2048
    v_mfma_f32_16x16x32_bf16 v[140:143], v[52:55], v[36:39], v[140:143]
    v_mfma_f32_16x16x32_bf16 v[144:147], v[56:59], v[36:39], v[144:147]
    v_mfma_f32_16x16x32_bf16 v[148:151], v[60:63], v[36:39], v[148:151]
    v_mfma_f32_16x16x32_bf16 v[152:155], v[64:67], v[36:39], v[152:155]
    v_mfma_f32_16x16x32_bf16 v[160:163], v[164:167], v[36:39], v[160:163]
    s_waitcnt lgkmcnt(0)
    s_barrier
    v_mfma_f32_16x16x32_bf16 v[116:119], v[68:71], v[40:43], v[116:119]
    ds_read_b128 v[32:35], v17 offset:0
    v_mfma_f32_16x16x32_bf16 v[120:123], v[72:75], v[40:43], v[120:123]
    ds_read_b128 v[48:51], v29 offset:0
    v_mfma_f32_16x16x32_bf16 v[124:127], v[76:79], v[40:43], v[124:127]
    ds_read_b128 v[52:55], v29 offset:2048
    v_mfma_f32_16x16x32_bf16 v[128:131], v[80:83], v[40:43], v[128:131]
    ds_read_b128 v[56:59], v29 offset:4096
    v_mfma_f32_16x16x32_bf16 v[132:135], v[84:87], v[40:43], v[132:135]
    ds_read_b128 v[60:63], v29 offset:6144
    v_mfma_f32_16x16x32_bf16 v[156:159], v[164:167], v[40:43], v[156:159]
    ds_read_b128 v[64:67], v29 offset:8192
    v_mfma_f32_16x16x32_bf16 v[136:139], v[68:71], v[44:47], v[136:139]
    ds_read_b128 v[36:39], v17 offset:2048
    v_mfma_f32_16x16x32_bf16 v[140:143], v[72:75], v[44:47], v[140:143]
    v_mfma_f32_16x16x32_bf16 v[144:147], v[76:79], v[44:47], v[144:147]
    v_mfma_f32_16x16x32_bf16 v[148:151], v[80:83], v[44:47], v[148:151]
    v_mfma_f32_16x16x32_bf16 v[152:155], v[84:87], v[44:47], v[152:155]
    v_mfma_f32_16x16x32_bf16 v[160:163], v[164:167], v[44:47], v[160:163]
    s_waitcnt lgkmcnt(0)
    v_mfma_f32_16x16x32_bf16 v[116:119], v[48:51], v[32:35], v[116:119]
    ds_read_b128 v[40:43], v18 offset:0
    v_mfma_f32_16x16x32_bf16 v[120:123], v[52:55], v[32:35], v[120:123]
    ds_read_b128 v[68:71], v30 offset:0
    v_mfma_f32_16x16x32_bf16 v[124:127], v[56:59], v[32:35], v[124:127]
    ds_read_b128 v[72:75], v30 offset:2048
    v_mfma_f32_16x16x32_bf16 v[128:131], v[60:63], v[32:35], v[128:131]
    ds_read_b128 v[76:79], v30 offset:4096
    v_mfma_f32_16x16x32_bf16 v[132:135], v[64:67], v[32:35], v[132:135]
    ds_read_b128 v[80:83], v30 offset:6144
    v_mfma_f32_16x16x32_bf16 v[156:159], v[164:167], v[32:35], v[156:159]
    ds_read_b128 v[84:87], v30 offset:8192
    v_mfma_f32_16x16x32_bf16 v[136:139], v[48:51], v[36:39], v[136:139]
    ds_read_b128 v[44:47], v18 offset:2048
    v_mfma_f32_16x16x32_bf16 v[140:143], v[52:55], v[36:39], v[140:143]
    v_mfma_f32_16x16x32_bf16 v[144:147], v[56:59], v[36:39], v[144:147]
    v_mfma_f32_16x16x32_bf16 v[148:151], v[60:63], v[36:39], v[148:151]
    v_mfma_f32_16x16x32_bf16 v[152:155], v[64:67], v[36:39], v[152:155]
    v_mfma_f32_16x16x32_bf16 v[160:163], v[164:167], v[36:39], v[160:163]
    s_waitcnt lgkmcnt(0)
    s_barrier
    v_mfma_f32_16x16x32_bf16 v[116:119], v[68:71], v[40:43], v[116:119]
    ds_read_b128 v[32:35], v7 offset:0
    v_mfma_f32_16x16x32_bf16 v[120:123], v[72:75], v[40:43], v[120:123]
    ds_read_b128 v[48:51], v19 offset:0
    v_mfma_f32_16x16x32_bf16 v[124:127], v[76:79], v[40:43], v[124:127]
    ds_read_b128 v[52:55], v19 offset:2048
    v_mfma_f32_16x16x32_bf16 v[128:131], v[80:83], v[40:43], v[128:131]
    ds_read_b128 v[56:59], v19 offset:4096
    v_mfma_f32_16x16x32_bf16 v[132:135], v[84:87], v[40:43], v[132:135]
    ds_read_b128 v[60:63], v19 offset:6144
    v_mfma_f32_16x16x32_bf16 v[156:159], v[164:167], v[40:43], v[156:159]
    ds_read_b128 v[64:67], v19 offset:8192
    v_mfma_f32_16x16x32_bf16 v[136:139], v[68:71], v[44:47], v[136:139]
    ds_read_b128 v[36:39], v7 offset:2048
    v_mfma_f32_16x16x32_bf16 v[140:143], v[72:75], v[44:47], v[140:143]
    v_mfma_f32_16x16x32_bf16 v[144:147], v[76:79], v[44:47], v[144:147]
    v_mfma_f32_16x16x32_bf16 v[148:151], v[80:83], v[44:47], v[148:151]
    v_mfma_f32_16x16x32_bf16 v[152:155], v[84:87], v[44:47], v[152:155]
    v_mfma_f32_16x16x32_bf16 v[160:163], v[164:167], v[44:47], v[160:163]
    s_waitcnt lgkmcnt(0)
    v_mfma_f32_16x16x32_bf16 v[116:119], v[48:51], v[32:35], v[116:119]
    ds_read_b128 v[40:43], v8 offset:0
    v_mfma_f32_16x16x32_bf16 v[120:123], v[52:55], v[32:35], v[120:123]
    ds_read_b128 v[68:71], v20 offset:0
    v_mfma_f32_16x16x32_bf16 v[124:127], v[56:59], v[32:35], v[124:127]
    ds_read_b128 v[72:75], v20 offset:2048
    v_mfma_f32_16x16x32_bf16 v[128:131], v[60:63], v[32:35], v[128:131]
    ds_read_b128 v[76:79], v20 offset:4096
    v_mfma_f32_16x16x32_bf16 v[132:135], v[64:67], v[32:35], v[132:135]
    ds_read_b128 v[80:83], v20 offset:6144
    v_mfma_f32_16x16x32_bf16 v[156:159], v[164:167], v[32:35], v[156:159]
    ds_read_b128 v[84:87], v20 offset:8192
    v_mfma_f32_16x16x32_bf16 v[136:139], v[48:51], v[36:39], v[136:139]
    ds_read_b128 v[44:47], v8 offset:2048
    v_mfma_f32_16x16x32_bf16 v[140:143], v[52:55], v[36:39], v[140:143]
    v_mfma_f32_16x16x32_bf16 v[144:147], v[56:59], v[36:39], v[144:147]
    v_mfma_f32_16x16x32_bf16 v[148:151], v[60:63], v[36:39], v[148:151]
    v_mfma_f32_16x16x32_bf16 v[152:155], v[64:67], v[36:39], v[152:155]
    v_mfma_f32_16x16x32_bf16 v[160:163], v[164:167], v[36:39], v[160:163]
    s_waitcnt lgkmcnt(0)
    s_barrier
    v_mfma_f32_16x16x32_bf16 v[116:119], v[68:71], v[40:43], v[116:119]
    ds_read_b128 v[32:35], v9 offset:0
    v_mfma_f32_16x16x32_bf16 v[120:123], v[72:75], v[40:43], v[120:123]
    ds_read_b128 v[48:51], v21 offset:0
    v_mfma_f32_16x16x32_bf16 v[124:127], v[76:79], v[40:43], v[124:127]
    ds_read_b128 v[52:55], v21 offset:2048
    v_mfma_f32_16x16x32_bf16 v[128:131], v[80:83], v[40:43], v[128:131]
    ds_read_b128 v[56:59], v21 offset:4096
    v_mfma_f32_16x16x32_bf16 v[132:135], v[84:87], v[40:43], v[132:135]
    ds_read_b128 v[60:63], v21 offset:6144
    v_mfma_f32_16x16x32_bf16 v[156:159], v[164:167], v[40:43], v[156:159]
    ds_read_b128 v[64:67], v21 offset:8192
    v_mfma_f32_16x16x32_bf16 v[136:139], v[68:71], v[44:47], v[136:139]
    ds_read_b128 v[36:39], v9 offset:2048
    v_mfma_f32_16x16x32_bf16 v[140:143], v[72:75], v[44:47], v[140:143]
    v_mfma_f32_16x16x32_bf16 v[144:147], v[76:79], v[44:47], v[144:147]
    v_mfma_f32_16x16x32_bf16 v[148:151], v[80:83], v[44:47], v[148:151]
    v_mfma_f32_16x16x32_bf16 v[152:155], v[84:87], v[44:47], v[152:155]
    v_mfma_f32_16x16x32_bf16 v[160:163], v[164:167], v[44:47], v[160:163]
    s_waitcnt lgkmcnt(0)
    v_mfma_f32_16x16x32_bf16 v[116:119], v[48:51], v[32:35], v[116:119]
    ds_read_b128 v[40:43], v10 offset:0
    v_mfma_f32_16x16x32_bf16 v[120:123], v[52:55], v[32:35], v[120:123]
    ds_read_b128 v[68:71], v22 offset:0
    v_mfma_f32_16x16x32_bf16 v[124:127], v[56:59], v[32:35], v[124:127]
    ds_read_b128 v[72:75], v22 offset:2048
    v_mfma_f32_16x16x32_bf16 v[128:131], v[60:63], v[32:35], v[128:131]
    ds_read_b128 v[76:79], v22 offset:4096
    v_mfma_f32_16x16x32_bf16 v[132:135], v[64:67], v[32:35], v[132:135]
    ds_read_b128 v[80:83], v22 offset:6144
    v_mfma_f32_16x16x32_bf16 v[156:159], v[164:167], v[32:35], v[156:159]
    ds_read_b128 v[84:87], v22 offset:8192
    v_mfma_f32_16x16x32_bf16 v[136:139], v[48:51], v[36:39], v[136:139]
    ds_read_b128 v[44:47], v10 offset:2048
    v_mfma_f32_16x16x32_bf16 v[140:143], v[52:55], v[36:39], v[140:143]
    v_mfma_f32_16x16x32_bf16 v[144:147], v[56:59], v[36:39], v[144:147]
    v_mfma_f32_16x16x32_bf16 v[148:151], v[60:63], v[36:39], v[148:151]
    v_mfma_f32_16x16x32_bf16 v[152:155], v[64:67], v[36:39], v[152:155]
    v_mfma_f32_16x16x32_bf16 v[160:163], v[164:167], v[36:39], v[160:163]
    s_waitcnt lgkmcnt(0)
    v_mfma_f32_16x16x32_bf16 v[116:119], v[68:71], v[40:43], v[116:119]
    v_mfma_f32_16x16x32_bf16 v[120:123], v[72:75], v[40:43], v[120:123]
    v_mfma_f32_16x16x32_bf16 v[124:127], v[76:79], v[40:43], v[124:127]
    v_mfma_f32_16x16x32_bf16 v[128:131], v[80:83], v[40:43], v[128:131]
    v_mfma_f32_16x16x32_bf16 v[132:135], v[84:87], v[40:43], v[132:135]
    v_mfma_f32_16x16x32_bf16 v[156:159], v[164:167], v[40:43], v[156:159]
    v_mfma_f32_16x16x32_bf16 v[136:139], v[68:71], v[44:47], v[136:139]
    v_mfma_f32_16x16x32_bf16 v[140:143], v[72:75], v[44:47], v[140:143]
    v_mfma_f32_16x16x32_bf16 v[144:147], v[76:79], v[44:47], v[144:147]
    v_mfma_f32_16x16x32_bf16 v[148:151], v[80:83], v[44:47], v[148:151]
    v_mfma_f32_16x16x32_bf16 v[152:155], v[84:87], v[44:47], v[152:155]
    v_mfma_f32_16x16x32_bf16 v[160:163], v[164:167], v[44:47], v[160:163]
    s_nop 7
    s_nop 7
    s_barrier
    v_mul_f32 v72, v116, v190
    v_fmac_f32 v72, v156, v170
    v_mul_f32 v73, v117, v191
    v_fmac_f32 v73, v156, v171
    v_mul_f32 v74, v118, v192
    v_fmac_f32 v74, v156, v172
    v_mul_f32 v75, v119, v193
    v_fmac_f32 v75, v156, v173
    v_mul_f32 v76, v120, v194
    v_fmac_f32 v76, v156, v174
    v_mul_f32 v77, v121, v195
    v_fmac_f32 v77, v156, v175
    v_mul_f32 v78, v122, v196
    v_fmac_f32 v78, v156, v176
    v_mul_f32 v79, v123, v197
    v_fmac_f32 v79, v156, v177
    v_mul_f32 v80, v124, v198
    v_fmac_f32 v80, v156, v178
    v_mul_f32 v81, v125, v199
    v_fmac_f32 v81, v156, v179
    v_mul_f32 v82, v126, v200
    v_fmac_f32 v82, v156, v180
    v_mul_f32 v83, v127, v201
    v_fmac_f32 v83, v156, v181
    v_mul_f32 v84, v128, v202
    v_fmac_f32 v84, v156, v182
    v_mul_f32 v85, v129, v203
    v_fmac_f32 v85, v156, v183
    v_mul_f32 v86, v130, v204
    v_fmac_f32 v86, v156, v184
    v_mul_f32 v87, v131, v205
    v_fmac_f32 v87, v156, v185
    v_mul_f32 v88, v132, v206
    v_fmac_f32 v88, v156, v186
    v_mul_f32 v89, v133, v207
    v_fmac_f32 v89, v156, v187
    v_mul_f32 v90, v134, v208
    v_fmac_f32 v90, v156, v188
    v_mul_f32 v91, v135, v209
    v_fmac_f32 v91, v156, v189
    v_cvt_pk_bf16_f32 v92, v72, v73
    v_cvt_pk_bf16_f32 v93, v74, v75
    v_cvt_pk_bf16_f32 v94, v76, v77
    v_cvt_pk_bf16_f32 v95, v78, v79
    v_cvt_pk_bf16_f32 v96, v80, v81
    v_cvt_pk_bf16_f32 v97, v82, v83
    v_cvt_pk_bf16_f32 v98, v84, v85
    v_cvt_pk_bf16_f32 v99, v86, v87
    v_cvt_pk_bf16_f32 v100, v88, v89
    v_cvt_pk_bf16_f32 v101, v90, v91
    ds_write_b64 v226, v[92:93] offset:0
    ds_write_b64 v226, v[94:95] offset:32
    ds_write_b64 v226, v[96:97] offset:64
    ds_write_b64 v226, v[98:99] offset:96
    ds_write_b64 v226, v[100:101] offset:128
    v_mul_f32 v72, v136, v190
    v_fmac_f32 v72, v160, v170
    v_mul_f32 v73, v137, v191
    v_fmac_f32 v73, v160, v171
    v_mul_f32 v74, v138, v192
    v_fmac_f32 v74, v160, v172
    v_mul_f32 v75, v139, v193
    v_fmac_f32 v75, v160, v173
    v_mul_f32 v76, v140, v194
    v_fmac_f32 v76, v160, v174
    v_mul_f32 v77, v141, v195
    v_fmac_f32 v77, v160, v175
    v_mul_f32 v78, v142, v196
    v_fmac_f32 v78, v160, v176
    v_mul_f32 v79, v143, v197
    v_fmac_f32 v79, v160, v177
    v_mul_f32 v80, v144, v198
    v_fmac_f32 v80, v160, v178
    v_mul_f32 v81, v145, v199
    v_fmac_f32 v81, v160, v179
    v_mul_f32 v82, v146, v200
    v_fmac_f32 v82, v160, v180
    v_mul_f32 v83, v147, v201
    v_fmac_f32 v83, v160, v181
    v_mul_f32 v84, v148, v202
    v_fmac_f32 v84, v160, v182
    v_mul_f32 v85, v149, v203
    v_fmac_f32 v85, v160, v183
    v_mul_f32 v86, v150, v204
    v_fmac_f32 v86, v160, v184
    v_mul_f32 v87, v151, v205
    v_fmac_f32 v87, v160, v185
    v_mul_f32 v88, v152, v206
    v_fmac_f32 v88, v160, v186
    v_mul_f32 v89, v153, v207
    v_fmac_f32 v89, v160, v187
    v_mul_f32 v90, v154, v208
    v_fmac_f32 v90, v160, v188
    v_mul_f32 v91, v155, v209
    v_fmac_f32 v91, v160, v189
    v_cvt_pk_bf16_f32 v102, v72, v73
    v_cvt_pk_bf16_f32 v103, v74, v75
    v_cvt_pk_bf16_f32 v104, v76, v77
    v_cvt_pk_bf16_f32 v105, v78, v79
    v_cvt_pk_bf16_f32 v106, v80, v81
    v_cvt_pk_bf16_f32 v107, v82, v83
    v_cvt_pk_bf16_f32 v108, v84, v85
    v_cvt_pk_bf16_f32 v109, v86, v87
    v_cvt_pk_bf16_f32 v110, v88, v89
    v_cvt_pk_bf16_f32 v111, v90, v91
    ds_write_b64 v226, v[102:103] offset:2816
    ds_write_b64 v226, v[104:105] offset:2848
    ds_write_b64 v226, v[106:107] offset:2880
    ds_write_b64 v226, v[108:109] offset:2912
    ds_write_b64 v226, v[110:111] offset:2944
    s_waitcnt lgkmcnt(0)
    ds_read_b128 v[32:35], v211
    ds_read_b128 v[36:39], v212
    ds_read_b128 v[40:43], v213
    ds_read_b128 v[44:47], v214
    ds_read_b128 v[48:51], v215
    s_waitcnt lgkmcnt(4)
    buffer_store_dwordx4 v[32:35], v216, s[24:27], s36 offen
    s_waitcnt lgkmcnt(3)
    buffer_store_dwordx4 v[36:39], v217, s[24:27], s36 offen
    s_waitcnt lgkmcnt(2)
    buffer_store_dwordx4 v[40:43], v218, s[24:27], s36 offen
    s_waitcnt lgkmcnt(1)
    buffer_store_dwordx4 v[44:47], v219, s[24:27], s36 offen
    s_waitcnt lgkmcnt(0)
    buffer_store_dwordx4 v[48:51], v220, s[24:27], s36 offen
l1_kernel_end:
    s_endpgm
l1_kernel_prod:
    s_sub_u32 s50, s40, 4
    v_lshrrev_b32 v10, 3, v1
    v_and_b32 v11, 7, v1
    s_and_b32 s51, s50, 1
    s_lshl_b32 s51, s51, 2
    v_lshrrev_b32 v12, 1, v10
    v_add_u32 v12, s51, v12
    v_xor_b32 v12, v11, v12
    v_lshlrev_b32 v12, 4, v12
    v_mul_u32_u24 v14, 4096, v10
    v_add_u32 v14, v14, v12
    v_mul_u32_u24 v15, 4096, v10
    v_add_u32 v15, v15, v12
    s_lshl_b32 s54, s50, 10
    s_mul_i32 s52, s50, 8
    s_add_u32 s53, s52, s47
    s_mul_i32 s53, s53, 4096
    s_add_u32 s56, s52, s44
    s_mul_i32 s56, s56, 4096
    s_cmp_ge_u32 s50, 2
    s_cselect_b32 s66, 4294901760, 0
    s_cselect_b32 s67, 2048, 0
    s_add_u32 s66, s66, s56
    s_sub_u32 s67, s54, s67
    s_waitcnt lgkmcnt(0)
    s_cmp_ge_u32 s41, 16
    s_cselect_b32 s30, s32, s30
    s_cselect_b32 s31, s33, s31
    s_mov_b32 s8, s30
    s_mov_b32 s9, s31
    s_mov_b32 s10, 0x800000
    s_mov_b32 s11, 0x00020000
    s_add_u32 s12, s4, 0x100000
    s_addc_u32 s13, s5, 0
    s_mov_b32 s14, 0x280000
    s_mov_b32 s15, 0x00020000
    s_add_u32 m0, s54, 0
    s_add_u32 s55, s53, 0
    buffer_load_dwordx4 v14, s[8:11], s55 offen lds
    s_add_u32 m0, s54, 4096
    s_add_u32 s55, s53, 131072
    buffer_load_dwordx4 v14, s[8:11], s55 offen lds
    s_add_u32 m0, s54, 8192
    s_add_u32 s55, s53, 262144
    buffer_load_dwordx4 v14, s[8:11], s55 offen lds
    s_add_u32 m0, s54, 12288
    s_add_u32 s55, s53, 393216
    buffer_load_dwordx4 v14, s[8:11], s55 offen lds
    s_add_u32 m0, s54, 16384
    s_add_u32 s55, s56, 0
    buffer_load_dwordx4 v15, s[12:15], s55 offen lds
    s_add_u32 m0, s54, 20480
    s_add_u32 s55, s56, 131072
    buffer_load_dwordx4 v15, s[12:15], s55 offen lds
    s_add_u32 m0, s67, 24576
    s_add_u32 s55, s66, 262144
    buffer_load_dwordx4 v15, s[12:15], s55 offen lds
    s_add_u32 m0, s54, 26624
    s_add_u32 s55, s53, 128
    buffer_load_dwordx4 v14, s[8:11], s55 offen lds
    s_add_u32 m0, s54, 30720
    s_add_u32 s55, s53, 131200
    buffer_load_dwordx4 v14, s[8:11], s55 offen lds
    s_add_u32 m0, s54, 34816
    s_add_u32 s55, s53, 262272
    buffer_load_dwordx4 v14, s[8:11], s55 offen lds
    s_add_u32 m0, s54, 38912
    s_add_u32 s55, s53, 393344
    buffer_load_dwordx4 v14, s[8:11], s55 offen lds
    s_add_u32 m0, s54, 43008
    s_add_u32 s55, s56, 128
    buffer_load_dwordx4 v15, s[12:15], s55 offen lds
    s_add_u32 m0, s54, 47104
    s_add_u32 s55, s56, 131200
    buffer_load_dwordx4 v15, s[12:15], s55 offen lds
    s_add_u32 m0, s67, 51200
    s_add_u32 s55, s66, 262272
    buffer_load_dwordx4 v15, s[12:15], s55 offen lds
    s_add_u32 m0, s54, 53248
    s_add_u32 s55, s53, 256
    buffer_load_dwordx4 v14, s[8:11], s55 offen lds
    s_add_u32 m0, s54, 57344
    s_add_u32 s55, s53, 131328
    buffer_load_dwordx4 v14, s[8:11], s55 offen lds
    s_add_u32 m0, s54, 61440
    s_add_u32 s55, s53, 262400
    buffer_load_dwordx4 v14, s[8:11], s55 offen lds
    s_add_u32 m0, s54, 65536
    s_add_u32 s55, s53, 393472
    buffer_load_dwordx4 v14, s[8:11], s55 offen lds
    s_add_u32 m0, s54, 69632
    s_add_u32 s55, s56, 256
    buffer_load_dwordx4 v15, s[12:15], s55 offen lds
    s_add_u32 m0, s54, 73728
    s_add_u32 s55, s56, 131328
    buffer_load_dwordx4 v15, s[12:15], s55 offen lds
    s_add_u32 m0, s67, 77824
    s_add_u32 s55, s66, 262400
    buffer_load_dwordx4 v15, s[12:15], s55 offen lds
    s_waitcnt vmcnt(14)
    s_barrier
    s_add_u32 m0, s54, 79872
    s_add_u32 s55, s53, 384
    buffer_load_dwordx4 v14, s[8:11], s55 offen lds
    s_add_u32 m0, s54, 83968
    s_add_u32 s55, s53, 131456
    buffer_load_dwordx4 v14, s[8:11], s55 offen lds
    s_add_u32 m0, s54, 88064
    s_add_u32 s55, s53, 262528
    buffer_load_dwordx4 v14, s[8:11], s55 offen lds
    s_add_u32 m0, s54, 92160
    s_add_u32 s55, s53, 393600
    buffer_load_dwordx4 v14, s[8:11], s55 offen lds
    s_add_u32 m0, s54, 96256
    s_add_u32 s55, s56, 384
    buffer_load_dwordx4 v15, s[12:15], s55 offen lds
    s_add_u32 m0, s54, 100352
    s_add_u32 s55, s56, 131456
    buffer_load_dwordx4 v15, s[12:15], s55 offen lds
    s_add_u32 m0, s67, 104448
    s_add_u32 s55, s66, 262528
    buffer_load_dwordx4 v15, s[12:15], s55 offen lds
    s_add_u32 m0, s54, 106496
    s_add_u32 s55, s53, 512
    buffer_load_dwordx4 v14, s[8:11], s55 offen lds
    s_add_u32 m0, s54, 110592
    s_add_u32 s55, s53, 131584
    buffer_load_dwordx4 v14, s[8:11], s55 offen lds
    s_add_u32 m0, s54, 114688
    s_add_u32 s55, s53, 262656
    buffer_load_dwordx4 v14, s[8:11], s55 offen lds
    s_add_u32 m0, s54, 118784
    s_add_u32 s55, s53, 393728
    buffer_load_dwordx4 v14, s[8:11], s55 offen lds
    s_add_u32 m0, s54, 122880
    s_add_u32 s55, s56, 512
    buffer_load_dwordx4 v15, s[12:15], s55 offen lds
    s_add_u32 m0, s54, 126976
    s_add_u32 s55, s56, 131584
    buffer_load_dwordx4 v15, s[12:15], s55 offen lds
    s_add_u32 m0, s67, 131072
    s_add_u32 s55, s66, 262656
    buffer_load_dwordx4 v15, s[12:15], s55 offen lds
    s_cmp_ge_u32 s41, 16
    s_cselect_b32 s35, 0x80000000, 0
    s_cselect_b32 s36, 1280, 0
    s_mov_b32 s20, s4
    s_mov_b32 s21, s5
    s_mov_b32 s22, 0x1e00
    s_mov_b32 s23, 0x00020000
    s_add_u32 s24, s4, 0x800000
    s_addc_u32 s25, s5, 0
    s_mov_b32 s26, 0x500000
    s_mov_b32 s27, 0x00020000
    s_add_u32 s72, s4, 0x400000
    s_addc_u32 s73, s5, 0
    s_mov_b32 s74, 0x1e0000
    s_mov_b32 s75, 0x00020000
    s_add_u32 s76, s4, 0x1f00000
    s_addc_u32 s77, s5, 0
    s_mov_b32 s78, 0x3000
    s_mov_b32 s79, 0x00020000
    v_lshlrev_b32 v20, 4, v1
    v_add_u32 v21, 1024, v20
    v_cmp_gt_u32 vcc, 16, v1
    v_mov_b32 v22, 0x7ffffff0
    s_nop 1
    v_cndmask_b32 v21, v22, v21, vcc
    s_mov_b32 s80, 5120
    s_mov_b32 s81, 3840
    buffer_load_dwordx4 v[24:27], v20, s[20:23], s80 offen
    buffer_load_dwordx4 v[28:31], v21, s[20:23], s80 offen
    buffer_load_dwordx4 v[32:35], v20, s[20:23], s81 offen
    buffer_load_dwordx4 v[36:39], v21, s[20:23], s81 offen
    s_cmp_lt_u32 s50, 2
    s_cselect_b32 s85, 4, 2
    s_mul_i32 s82, s2, 6
    s_add_u32 s82, s82, s50
    s_mul_i32 s83, s82, 1280
    buffer_load_dwordx4 v[40:43], v20, s[72:75], s83 offen
    buffer_load_dwordx4 v[44:47], v21, s[72:75], s83 offen
    s_add_u32 s83, s83, 5120
    buffer_load_dwordx4 v[48:51], v20, s[72:75], s83 offen
    buffer_load_dwordx4 v[52:55], v21, s[72:75], s83 offen
    s_waitcnt vmcnt(29)
    s_barrier
    s_add_u32 m0, s54, 133120
    s_add_u32 s55, s53, 640
    buffer_load_dwordx4 v14, s[8:11], s55 offen lds
    s_add_u32 m0, s54, 137216
    s_add_u32 s55, s53, 131712
    buffer_load_dwordx4 v14, s[8:11], s55 offen lds
    s_add_u32 m0, s54, 141312
    s_add_u32 s55, s53, 262784
    buffer_load_dwordx4 v14, s[8:11], s55 offen lds
    s_add_u32 m0, s54, 145408
    s_add_u32 s55, s53, 393856
    buffer_load_dwordx4 v14, s[8:11], s55 offen lds
    s_add_u32 m0, s54, 149504
    s_add_u32 s55, s56, 640
    buffer_load_dwordx4 v15, s[12:15], s55 offen lds
    s_add_u32 m0, s54, 153600
    s_add_u32 s55, s56, 131712
    buffer_load_dwordx4 v15, s[12:15], s55 offen lds
    s_add_u32 m0, s67, 157696
    s_add_u32 s55, s66, 262784
    buffer_load_dwordx4 v15, s[12:15], s55 offen lds
    s_add_u32 m0, s54, 0
    s_add_u32 s55, s53, 768
    buffer_load_dwordx4 v14, s[8:11], s55 offen lds
    s_add_u32 m0, s54, 4096
    s_add_u32 s55, s53, 131840
    buffer_load_dwordx4 v14, s[8:11], s55 offen lds
    s_add_u32 m0, s54, 8192
    s_add_u32 s55, s53, 262912
    buffer_load_dwordx4 v14, s[8:11], s55 offen lds
    s_add_u32 m0, s54, 12288
    s_add_u32 s55, s53, 393984
    buffer_load_dwordx4 v14, s[8:11], s55 offen lds
    s_add_u32 m0, s54, 16384
    s_add_u32 s55, s56, 768
    buffer_load_dwordx4 v15, s[12:15], s55 offen lds
    s_add_u32 m0, s54, 20480
    s_add_u32 s55, s56, 131840
    buffer_load_dwordx4 v15, s[12:15], s55 offen lds
    s_add_u32 m0, s67, 24576
    s_add_u32 s55, s66, 262912
    buffer_load_dwordx4 v15, s[12:15], s55 offen lds
    s_waitcnt vmcnt(36)
    s_barrier
    s_add_u32 m0, s54, 26624
    s_add_u32 s55, s53, 896
    buffer_load_dwordx4 v14, s[8:11], s55 offen lds
    s_add_u32 m0, s54, 30720
    s_add_u32 s55, s53, 131968
    buffer_load_dwordx4 v14, s[8:11], s55 offen lds
    s_add_u32 m0, s54, 34816
    s_add_u32 s55, s53, 263040
    buffer_load_dwordx4 v14, s[8:11], s55 offen lds
    s_add_u32 m0, s54, 38912
    s_add_u32 s55, s53, 394112
    buffer_load_dwordx4 v14, s[8:11], s55 offen lds
    s_add_u32 m0, s54, 43008
    s_add_u32 s55, s56, 896
    buffer_load_dwordx4 v15, s[12:15], s55 offen lds
    s_add_u32 m0, s54, 47104
    s_add_u32 s55, s56, 131968
    buffer_load_dwordx4 v15, s[12:15], s55 offen lds
    s_add_u32 m0, s67, 51200
    s_add_u32 s55, s66, 263040
    buffer_load_dwordx4 v15, s[12:15], s55 offen lds
    s_waitcnt vmcnt(36)
    s_barrier
    s_add_u32 m0, s54, 53248
    s_add_u32 s55, s53, 1024
    buffer_load_dwordx4 v14, s[8:11], s55 offen lds
    s_add_u32 m0, s54, 57344
    s_add_u32 s55, s53, 132096
    buffer_load_dwordx4 v14, s[8:11], s55 offen lds
    s_add_u32 m0, s54, 61440
    s_add_u32 s55, s53, 263168
    buffer_load_dwordx4 v14, s[8:11], s55 offen lds
    s_add_u32 m0, s54, 65536
    s_add_u32 s55, s53, 394240
    buffer_load_dwordx4 v14, s[8:11], s55 offen lds
    s_add_u32 m0, s54, 69632
    s_add_u32 s55, s56, 1024
    buffer_load_dwordx4 v15, s[12:15], s55 offen lds
    s_add_u32 m0, s54, 73728
    s_add_u32 s55, s56, 132096
    buffer_load_dwordx4 v15, s[12:15], s55 offen lds
    s_add_u32 m0, s67, 77824
    s_add_u32 s55, s66, 263168
    buffer_load_dwordx4 v15, s[12:15], s55 offen lds
    s_waitcnt vmcnt(36)
    s_barrier
    s_add_u32 m0, s54, 79872
    s_add_u32 s55, s53, 1152
    buffer_load_dwordx4 v14, s[8:11], s55 offen lds
    s_add_u32 m0, s54, 83968
    s_add_u32 s55, s53, 132224
    buffer_load_dwordx4 v14, s[8:11], s55 offen lds
    s_add_u32 m0, s54, 88064
    s_add_u32 s55, s53, 263296
    buffer_load_dwordx4 v14, s[8:11], s55 offen lds
    s_add_u32 m0, s54, 92160
    s_add_u32 s55, s53, 394368
    buffer_load_dwordx4 v14, s[8:11], s55 offen lds
    s_add_u32 m0, s54, 96256
    s_add_u32 s55, s56, 1152
    buffer_load_dwordx4 v15, s[12:15], s55 offen lds
    s_add_u32 m0, s54, 100352
    s_add_u32 s55, s56, 132224
    buffer_load_dwordx4 v15, s[12:15], s55 offen lds
    s_add_u32 m0, s67, 104448
    s_add_u32 s55, s66, 263296
    buffer_load_dwordx4 v15, s[12:15], s55 offen lds
    s_waitcnt vmcnt(28)
    s_barrier
    s_add_u32 m0, s54, 106496
    s_add_u32 s55, s53, 1280
    buffer_load_dwordx4 v14, s[8:11], s55 offen lds
    s_add_u32 m0, s54, 110592
    s_add_u32 s55, s53, 132352
    buffer_load_dwordx4 v14, s[8:11], s55 offen lds
    s_add_u32 m0, s54, 114688
    s_add_u32 s55, s53, 263424
    buffer_load_dwordx4 v14, s[8:11], s55 offen lds
    s_add_u32 m0, s54, 118784
    s_add_u32 s55, s53, 394496
    buffer_load_dwordx4 v14, s[8:11], s55 offen lds
    s_add_u32 m0, s54, 122880
    s_add_u32 s55, s56, 1280
    buffer_load_dwordx4 v15, s[12:15], s55 offen lds
    s_add_u32 m0, s54, 126976
    s_add_u32 s55, s56, 132352
    buffer_load_dwordx4 v15, s[12:15], s55 offen lds
    s_add_u32 m0, s67, 131072
    s_add_u32 s55, s66, 263424
    buffer_load_dwordx4 v15, s[12:15], s55 offen lds
    s_waitcnt vmcnt(28)
    s_barrier
    s_add_u32 m0, s54, 133120
    s_add_u32 s55, s53, 1408
    buffer_load_dwordx4 v14, s[8:11], s55 offen lds
    s_add_u32 m0, s54, 137216
    s_add_u32 s55, s53, 132480
    buffer_load_dwordx4 v14, s[8:11], s55 offen lds
    s_add_u32 m0, s54, 141312
    s_add_u32 s55, s53, 263552
    buffer_load_dwordx4 v14, s[8:11], s55 offen lds
    s_add_u32 m0, s54, 145408
    s_add_u32 s55, s53, 394624
    buffer_load_dwordx4 v14, s[8:11], s55 offen lds
    s_add_u32 m0, s54, 149504
    s_add_u32 s55, s56, 1408
    buffer_load_dwordx4 v15, s[12:15], s55 offen lds
    s_add_u32 m0, s54, 153600
    s_add_u32 s55, s56, 132480
    buffer_load_dwordx4 v15, s[12:15], s55 offen lds
    s_add_u32 m0, s67, 157696
    s_add_u32 s55, s66, 263552
    buffer_load_dwordx4 v15, s[12:15], s55 offen lds
    s_waitcnt vmcnt(28)
    s_barrier
    s_add_u32 m0, s54, 0
    s_add_u32 s55, s53, 1536
    buffer_load_dwordx4 v14, s[8:11], s55 offen lds
    s_add_u32 m0, s54, 4096
    s_add_u32 s55, s53, 132608
    buffer_load_dwordx4 v14, s[8:11], s55 offen lds
    s_add_u32 m0, s54, 8192
    s_add_u32 s55, s53, 263680
    buffer_load_dwordx4 v14, s[8:11], s55 offen lds
    s_add_u32 m0, s54, 12288
    s_add_u32 s55, s53, 394752
    buffer_load_dwordx4 v14, s[8:11], s55 offen lds
    s_add_u32 m0, s54, 16384
    s_add_u32 s55, s56, 1536
    buffer_load_dwordx4 v15, s[12:15], s55 offen lds
    s_add_u32 m0, s54, 20480
    s_add_u32 s55, s56, 132608
    buffer_load_dwordx4 v15, s[12:15], s55 offen lds
    s_add_u32 m0, s67, 24576
    s_add_u32 s55, s66, 263680
    buffer_load_dwordx4 v15, s[12:15], s55 offen lds
    s_waitcnt vmcnt(28)
    s_barrier
    s_add_u32 m0, s54, 26624
    s_add_u32 s55, s53, 1664
    buffer_load_dwordx4 v14, s[8:11], s55 offen lds
    s_add_u32 m0, s54, 30720
    s_add_u32 s55, s53, 132736
    buffer_load_dwordx4 v14, s[8:11], s55 offen lds
    s_add_u32 m0, s54, 34816
    s_add_u32 s55, s53, 263808
    buffer_load_dwordx4 v14, s[8:11], s55 offen lds
    s_add_u32 m0, s54, 38912
    s_add_u32 s55, s53, 394880
    buffer_load_dwordx4 v14, s[8:11], s55 offen lds
    s_add_u32 m0, s54, 43008
    s_add_u32 s55, s56, 1664
    buffer_load_dwordx4 v15, s[12:15], s55 offen lds
    s_add_u32 m0, s54, 47104
    s_add_u32 s55, s56, 132736
    buffer_load_dwordx4 v15, s[12:15], s55 offen lds
    s_add_u32 m0, s67, 51200
    s_add_u32 s55, s66, 263808
    buffer_load_dwordx4 v15, s[12:15], s55 offen lds
    v_lshlrev_b32 v60, 16, v24
    v_and_b32 v61, 0xffff0000, v24
    v_lshlrev_b32 v62, 16, v25
    v_and_b32 v63, 0xffff0000, v25
    v_lshlrev_b32 v64, 16, v26
    v_and_b32 v65, 0xffff0000, v26
    v_lshlrev_b32 v66, 16, v27
    v_and_b32 v67, 0xffff0000, v27
    v_lshlrev_b32 v68, 16, v28
    v_and_b32 v69, 0xffff0000, v28
    v_lshlrev_b32 v70, 16, v29
    v_and_b32 v71, 0xffff0000, v29
    v_lshlrev_b32 v72, 16, v30
    v_and_b32 v73, 0xffff0000, v30
    v_lshlrev_b32 v74, 16, v31
    v_and_b32 v75, 0xffff0000, v31
    v_add_f32 v60, 1.0, v60
    v_add_f32 v61, 1.0, v61
    v_cvt_pk_bf16_f32 v23, v60, v61
    v_lshlrev_b32 v60, 16, v23
    s_waitcnt vmcnt(28)
    s_barrier
    s_add_u32 m0, s54, 53248
    s_add_u32 s55, s53, 1792
    buffer_load_dwordx4 v14, s[8:11], s55 offen lds
    s_add_u32 m0, s54, 57344
    s_add_u32 s55, s53, 132864
    buffer_load_dwordx4 v14, s[8:11], s55 offen lds
    s_add_u32 m0, s54, 61440
    s_add_u32 s55, s53, 263936
    buffer_load_dwordx4 v14, s[8:11], s55 offen lds
    s_add_u32 m0, s54, 65536
    s_add_u32 s55, s53, 395008
    buffer_load_dwordx4 v14, s[8:11], s55 offen lds
    s_add_u32 m0, s54, 69632
    s_add_u32 s55, s56, 1792
    buffer_load_dwordx4 v15, s[12:15], s55 offen lds
    s_add_u32 m0, s54, 73728
    s_add_u32 s55, s56, 132864
    buffer_load_dwordx4 v15, s[12:15], s55 offen lds
    s_add_u32 m0, s67, 77824
    s_add_u32 s55, s66, 263936
    buffer_load_dwordx4 v15, s[12:15], s55 offen lds
    v_and_b32 v61, 0xffff0000, v23
    v_add_f32 v62, 1.0, v62
    v_add_f32 v63, 1.0, v63
    v_cvt_pk_bf16_f32 v23, v62, v63
    v_lshlrev_b32 v62, 16, v23
    v_and_b32 v63, 0xffff0000, v23
    v_add_f32 v64, 1.0, v64
    v_add_f32 v65, 1.0, v65
    v_cvt_pk_bf16_f32 v23, v64, v65
    v_lshlrev_b32 v64, 16, v23
    v_and_b32 v65, 0xffff0000, v23
    v_add_f32 v66, 1.0, v66
    v_add_f32 v67, 1.0, v67
    v_cvt_pk_bf16_f32 v23, v66, v67
    v_lshlrev_b32 v66, 16, v23
    v_and_b32 v67, 0xffff0000, v23
    v_add_f32 v68, 1.0, v68
    v_add_f32 v69, 1.0, v69
    v_cvt_pk_bf16_f32 v23, v68, v69
    v_lshlrev_b32 v68, 16, v23
    s_waitcnt vmcnt(28)
    s_barrier
    s_add_u32 m0, s54, 79872
    s_add_u32 s55, s53, 1920
    buffer_load_dwordx4 v14, s[8:11], s55 offen lds
    s_add_u32 m0, s54, 83968
    s_add_u32 s55, s53, 132992
    buffer_load_dwordx4 v14, s[8:11], s55 offen lds
    s_add_u32 m0, s54, 88064
    s_add_u32 s55, s53, 264064
    buffer_load_dwordx4 v14, s[8:11], s55 offen lds
    s_add_u32 m0, s54, 92160
    s_add_u32 s55, s53, 395136
    buffer_load_dwordx4 v14, s[8:11], s55 offen lds
    s_add_u32 m0, s54, 96256
    s_add_u32 s55, s56, 1920
    buffer_load_dwordx4 v15, s[12:15], s55 offen lds
    s_add_u32 m0, s54, 100352
    s_add_u32 s55, s56, 132992
    buffer_load_dwordx4 v15, s[12:15], s55 offen lds
    s_add_u32 m0, s67, 104448
    s_add_u32 s55, s66, 264064
    buffer_load_dwordx4 v15, s[12:15], s55 offen lds
    v_and_b32 v69, 0xffff0000, v23
    v_add_f32 v70, 1.0, v70
    v_add_f32 v71, 1.0, v71
    v_cvt_pk_bf16_f32 v23, v70, v71
    v_lshlrev_b32 v70, 16, v23
    v_and_b32 v71, 0xffff0000, v23
    v_add_f32 v72, 1.0, v72
    v_add_f32 v73, 1.0, v73
    v_cvt_pk_bf16_f32 v23, v72, v73
    v_lshlrev_b32 v72, 16, v23
    v_and_b32 v73, 0xffff0000, v23
    v_add_f32 v74, 1.0, v74
    v_add_f32 v75, 1.0, v75
    v_cvt_pk_bf16_f32 v23, v74, v75
    v_lshlrev_b32 v74, 16, v23
    v_and_b32 v75, 0xffff0000, v23
    v_lshlrev_b32 v76, 16, v32
    v_and_b32 v77, 0xffff0000, v32
    v_lshlrev_b32 v78, 16, v33
    v_and_b32 v79, 0xffff0000, v33
    s_waitcnt vmcnt(28)
    s_barrier
    s_add_u32 m0, s54, 106496
    s_add_u32 s55, s53, 2048
    buffer_load_dwordx4 v14, s[8:11], s55 offen lds
    s_add_u32 m0, s54, 110592
    s_add_u32 s55, s53, 133120
    buffer_load_dwordx4 v14, s[8:11], s55 offen lds
    s_add_u32 m0, s54, 114688
    s_add_u32 s55, s53, 264192
    buffer_load_dwordx4 v14, s[8:11], s55 offen lds
    s_add_u32 m0, s54, 118784
    s_add_u32 s55, s53, 395264
    buffer_load_dwordx4 v14, s[8:11], s55 offen lds
    s_add_u32 m0, s54, 122880
    s_add_u32 s55, s56, 2048
    buffer_load_dwordx4 v15, s[12:15], s55 offen lds
    s_add_u32 m0, s54, 126976
    s_add_u32 s55, s56, 133120
    buffer_load_dwordx4 v15, s[12:15], s55 offen lds
    s_add_u32 m0, s67, 131072
    s_add_u32 s55, s66, 264192
    buffer_load_dwordx4 v15, s[12:15], s55 offen lds
    v_lshlrev_b32 v80, 16, v34
    v_and_b32 v81, 0xffff0000, v34
    v_lshlrev_b32 v82, 16, v35
    v_and_b32 v83, 0xffff0000, v35
    v_lshlrev_b32 v84, 16, v36
    v_and_b32 v85, 0xffff0000, v36
    v_lshlrev_b32 v86, 16, v37
    v_and_b32 v87, 0xffff0000, v37
    v_lshlrev_b32 v88, 16, v38
    v_and_b32 v89, 0xffff0000, v38
    v_lshlrev_b32 v90, 16, v39
    v_and_b32 v91, 0xffff0000, v39
    v_lshlrev_b32 v92, 16, v40
    v_and_b32 v93, 0xffff0000, v40
    v_lshlrev_b32 v94, 16, v41
    v_and_b32 v95, 0xffff0000, v41
    v_lshlrev_b32 v96, 16, v42
    v_and_b32 v97, 0xffff0000, v42
    v_lshlrev_b32 v98, 16, v43
    v_and_b32 v99, 0xffff0000, v43
    s_waitcnt vmcnt(28)
    s_barrier
    s_add_u32 m0, s54, 133120
    s_add_u32 s55, s53, 2176
    buffer_load_dwordx4 v14, s[8:11], s55 offen lds
    s_add_u32 m0, s54, 137216
    s_add_u32 s55, s53, 133248
    buffer_load_dwordx4 v14, s[8:11], s55 offen lds
    s_add_u32 m0, s54, 141312
    s_add_u32 s55, s53, 264320
    buffer_load_dwordx4 v14, s[8:11], s55 offen lds
    s_add_u32 m0, s54, 145408
    s_add_u32 s55, s53, 395392
    buffer_load_dwordx4 v14, s[8:11], s55 offen lds
    s_add_u32 m0, s54, 149504
    s_add_u32 s55, s56, 2176
    buffer_load_dwordx4 v15, s[12:15], s55 offen lds
    s_add_u32 m0, s54, 153600
    s_add_u32 s55, s56, 133248
    buffer_load_dwordx4 v15, s[12:15], s55 offen lds
    s_add_u32 m0, s67, 157696
    s_add_u32 s55, s66, 264320
    buffer_load_dwordx4 v15, s[12:15], s55 offen lds
    v_lshlrev_b32 v100, 16, v44
    v_and_b32 v101, 0xffff0000, v44
    v_lshlrev_b32 v102, 16, v45
    v_and_b32 v103, 0xffff0000, v45
    v_lshlrev_b32 v104, 16, v46
    v_and_b32 v105, 0xffff0000, v46
    v_lshlrev_b32 v106, 16, v47
    v_and_b32 v107, 0xffff0000, v47
    v_mul_f32 v108, v60, v92
    v_mul_f32 v109, v76, v92
    v_fmac_f32 v108, v61, v93
    v_fmac_f32 v109, v77, v93
    v_fmac_f32 v108, v62, v94
    v_fmac_f32 v109, v78, v94
    v_fmac_f32 v108, v63, v95
    v_fmac_f32 v109, v79, v95
    v_fmac_f32 v108, v64, v96
    v_fmac_f32 v109, v80, v96
    v_fmac_f32 v108, v65, v97
    v_fmac_f32 v109, v81, v97
    s_waitcnt vmcnt(28)
    s_barrier
    s_add_u32 m0, s54, 0
    s_add_u32 s55, s53, 2304
    buffer_load_dwordx4 v14, s[8:11], s55 offen lds
    s_add_u32 m0, s54, 4096
    s_add_u32 s55, s53, 133376
    buffer_load_dwordx4 v14, s[8:11], s55 offen lds
    s_add_u32 m0, s54, 8192
    s_add_u32 s55, s53, 264448
    buffer_load_dwordx4 v14, s[8:11], s55 offen lds
    s_add_u32 m0, s54, 12288
    s_add_u32 s55, s53, 395520
    buffer_load_dwordx4 v14, s[8:11], s55 offen lds
    s_add_u32 m0, s54, 16384
    s_add_u32 s55, s56, 2304
    buffer_load_dwordx4 v15, s[12:15], s55 offen lds
    s_add_u32 m0, s54, 20480
    s_add_u32 s55, s56, 133376
    buffer_load_dwordx4 v15, s[12:15], s55 offen lds
    s_add_u32 m0, s67, 24576
    s_add_u32 s55, s66, 264448
    buffer_load_dwordx4 v15, s[12:15], s55 offen lds
    v_fmac_f32 v108, v66, v98
    v_fmac_f32 v109, v82, v98
    v_fmac_f32 v108, v67, v99
    v_fmac_f32 v109, v83, v99
    v_fmac_f32 v108, v68, v100
    v_fmac_f32 v109, v84, v100
    v_fmac_f32 v108, v69, v101
    v_fmac_f32 v109, v85, v101
    v_fmac_f32 v108, v70, v102
    v_fmac_f32 v109, v86, v102
    v_fmac_f32 v108, v71, v103
    v_fmac_f32 v109, v87, v103
    v_fmac_f32 v108, v72, v104
    v_fmac_f32 v109, v88, v104
    v_fmac_f32 v108, v73, v105
    v_fmac_f32 v109, v89, v105
    v_fmac_f32 v108, v74, v106
    v_fmac_f32 v109, v90, v106
    v_fmac_f32 v108, v75, v107
    v_fmac_f32 v109, v91, v107
    s_waitcnt vmcnt(28)
    s_barrier
    s_add_u32 m0, s54, 26624
    s_add_u32 s55, s53, 2432
    buffer_load_dwordx4 v14, s[8:11], s55 offen lds
    s_add_u32 m0, s54, 30720
    s_add_u32 s55, s53, 133504
    buffer_load_dwordx4 v14, s[8:11], s55 offen lds
    s_add_u32 m0, s54, 34816
    s_add_u32 s55, s53, 264576
    buffer_load_dwordx4 v14, s[8:11], s55 offen lds
    s_add_u32 m0, s54, 38912
    s_add_u32 s55, s53, 395648
    buffer_load_dwordx4 v14, s[8:11], s55 offen lds
    s_add_u32 m0, s54, 43008
    s_add_u32 s55, s56, 2432
    buffer_load_dwordx4 v15, s[12:15], s55 offen lds
    s_add_u32 m0, s54, 47104
    s_add_u32 s55, s56, 133504
    buffer_load_dwordx4 v15, s[12:15], s55 offen lds
    s_add_u32 m0, s67, 51200
    s_add_u32 s55, s66, 264576
    buffer_load_dwordx4 v15, s[12:15], s55 offen lds
    v_lshlrev_b32 v92, 16, v48
    v_and_b32 v93, 0xffff0000, v48
    v_lshlrev_b32 v94, 16, v49
    v_and_b32 v95, 0xffff0000, v49
    v_lshlrev_b32 v96, 16, v50
    v_and_b32 v97, 0xffff0000, v50
    v_lshlrev_b32 v98, 16, v51
    v_and_b32 v99, 0xffff0000, v51
    v_lshlrev_b32 v100, 16, v52
    v_and_b32 v101, 0xffff0000, v52
    v_lshlrev_b32 v102, 16, v53
    v_and_b32 v103, 0xffff0000, v53
    v_lshlrev_b32 v104, 16, v54
    v_and_b32 v105, 0xffff0000, v54
    v_lshlrev_b32 v106, 16, v55
    v_and_b32 v107, 0xffff0000, v55
    v_mul_f32 v110, v60, v92
    v_mul_f32 v111, v76, v92
    v_fmac_f32 v110, v61, v93
    v_fmac_f32 v111, v77, v93
    s_waitcnt vmcnt(28)
    s_barrier
    s_add_u32 m0, s54, 53248
    s_add_u32 s55, s53, 2560
    buffer_load_dwordx4 v14, s[8:11], s55 offen lds
    s_add_u32 m0, s54, 57344
    s_add_u32 s55, s53, 133632
    buffer_load_dwordx4 v14, s[8:11], s55 offen lds
    s_add_u32 m0, s54, 61440
    s_add_u32 s55, s53, 264704
    buffer_load_dwordx4 v14, s[8:11], s55 offen lds
    s_add_u32 m0, s54, 65536
    s_add_u32 s55, s53, 395776
    buffer_load_dwordx4 v14, s[8:11], s55 offen lds
    s_add_u32 m0, s54, 69632
    s_add_u32 s55, s56, 2560
    buffer_load_dwordx4 v15, s[12:15], s55 offen lds
    s_add_u32 m0, s54, 73728
    s_add_u32 s55, s56, 133632
    buffer_load_dwordx4 v15, s[12:15], s55 offen lds
    s_add_u32 m0, s67, 77824
    s_add_u32 s55, s66, 264704
    buffer_load_dwordx4 v15, s[12:15], s55 offen lds
    v_fmac_f32 v110, v62, v94
    v_fmac_f32 v111, v78, v94
    v_fmac_f32 v110, v63, v95
    v_fmac_f32 v111, v79, v95
    v_fmac_f32 v110, v64, v96
    v_fmac_f32 v111, v80, v96
    v_fmac_f32 v110, v65, v97
    v_fmac_f32 v111, v81, v97
    v_fmac_f32 v110, v66, v98
    v_fmac_f32 v111, v82, v98
    v_fmac_f32 v110, v67, v99
    v_fmac_f32 v111, v83, v99
    v_fmac_f32 v110, v68, v100
    v_fmac_f32 v111, v84, v100
    v_fmac_f32 v110, v69, v101
    v_fmac_f32 v111, v85, v101
    v_fmac_f32 v110, v70, v102
    v_fmac_f32 v111, v86, v102
    v_fmac_f32 v110, v71, v103
    v_fmac_f32 v111, v87, v103
    s_waitcnt vmcnt(28)
    s_barrier
    s_add_u32 m0, s54, 79872
    s_add_u32 s55, s53, 2688
    buffer_load_dwordx4 v14, s[8:11], s55 offen lds
    s_add_u32 m0, s54, 83968
    s_add_u32 s55, s53, 133760
    buffer_load_dwordx4 v14, s[8:11], s55 offen lds
    s_add_u32 m0, s54, 88064
    s_add_u32 s55, s53, 264832
    buffer_load_dwordx4 v14, s[8:11], s55 offen lds
    s_add_u32 m0, s54, 92160
    s_add_u32 s55, s53, 395904
    buffer_load_dwordx4 v14, s[8:11], s55 offen lds
    s_add_u32 m0, s54, 96256
    s_add_u32 s55, s56, 2688
    buffer_load_dwordx4 v15, s[12:15], s55 offen lds
    s_add_u32 m0, s54, 100352
    s_add_u32 s55, s56, 133760
    buffer_load_dwordx4 v15, s[12:15], s55 offen lds
    s_add_u32 m0, s67, 104448
    s_add_u32 s55, s66, 264832
    buffer_load_dwordx4 v15, s[12:15], s55 offen lds
    v_fmac_f32 v110, v72, v104
    v_fmac_f32 v111, v88, v104
    v_fmac_f32 v110, v73, v105
    v_fmac_f32 v111, v89, v105
    v_fmac_f32 v110, v74, v106
    v_fmac_f32 v111, v90, v106
    v_fmac_f32 v110, v75, v107
    v_fmac_f32 v111, v91, v107
    s_lshl_b32 s84, s50, 10
    s_add_u32 s84, s84, 159744
    v_lshl_add_u32 v20, v1, 2, s84
    ds_write_b32 v20, v108 offset:0
    ds_write_b32 v20, v109 offset:256
    ds_write_b32 v20, v110 offset:512
    ds_write_b32 v20, v111 offset:768
    s_waitcnt lgkmcnt(0)
    v_and_b32 v21, 3, v1
    v_lshlrev_b32 v22, 8, v21
    v_add_u32 v22, s84, v22
    ds_read_b128 v[24:27], v22 offset:0
    s_waitcnt vmcnt(28)
    s_barrier
    s_add_u32 m0, s54, 106496
    s_add_u32 s55, s53, 2816
    buffer_load_dwordx4 v14, s[8:11], s55 offen lds
    s_add_u32 m0, s54, 110592
    s_add_u32 s55, s53, 133888
    buffer_load_dwordx4 v14, s[8:11], s55 offen lds
    s_add_u32 m0, s54, 114688
    s_add_u32 s55, s53, 264960
    buffer_load_dwordx4 v14, s[8:11], s55 offen lds
    s_add_u32 m0, s54, 118784
    s_add_u32 s55, s53, 396032
    buffer_load_dwordx4 v14, s[8:11], s55 offen lds
    s_add_u32 m0, s54, 122880
    s_add_u32 s55, s56, 2816
    buffer_load_dwordx4 v15, s[12:15], s55 offen lds
    s_add_u32 m0, s54, 126976
    s_add_u32 s55, s56, 133888
    buffer_load_dwordx4 v15, s[12:15], s55 offen lds
    s_add_u32 m0, s67, 131072
    s_add_u32 s55, s66, 264960
    buffer_load_dwordx4 v15, s[12:15], s55 offen lds
    ds_read_b128 v[28:31], v22 offset:16
    ds_read_b128 v[32:35], v22 offset:32
    ds_read_b128 v[36:39], v22 offset:48
    ds_read_b128 v[40:43], v22 offset:64
    ds_read_b128 v[44:47], v22 offset:80
    ds_read_b128 v[48:51], v22 offset:96
    ds_read_b128 v[52:55], v22 offset:112
    ds_read_b128 v[56:59], v22 offset:128
    ds_read_b128 v[60:63], v22 offset:144
    ds_read_b128 v[64:67], v22 offset:160
    ds_read_b128 v[68:71], v22 offset:176
    ds_read_b128 v[72:75], v22 offset:192
    ds_read_b128 v[76:79], v22 offset:208
    ds_read_b128 v[80:83], v22 offset:224
    ds_read_b128 v[84:87], v22 offset:240
    s_waitcnt lgkmcnt(0)
    v_add_f32 v24, v24, v25
    v_add_f32 v24, v24, v26
    v_add_f32 v24, v24, v27
    v_add_f32 v24, v24, v28
    s_waitcnt vmcnt(28)
    s_barrier
    s_add_u32 m0, s54, 133120
    s_add_u32 s55, s53, 2944
    buffer_load_dwordx4 v14, s[8:11], s55 offen lds
    s_add_u32 m0, s54, 137216
    s_add_u32 s55, s53, 134016
    buffer_load_dwordx4 v14, s[8:11], s55 offen lds
    s_add_u32 m0, s54, 141312
    s_add_u32 s55, s53, 265088
    buffer_load_dwordx4 v14, s[8:11], s55 offen lds
    s_add_u32 m0, s54, 145408
    s_add_u32 s55, s53, 396160
    buffer_load_dwordx4 v14, s[8:11], s55 offen lds
    s_add_u32 m0, s54, 149504
    s_add_u32 s55, s56, 2944
    buffer_load_dwordx4 v15, s[12:15], s55 offen lds
    s_add_u32 m0, s54, 153600
    s_add_u32 s55, s56, 134016
    buffer_load_dwordx4 v15, s[12:15], s55 offen lds
    s_add_u32 m0, s67, 157696
    s_add_u32 s55, s66, 265088
    buffer_load_dwordx4 v15, s[12:15], s55 offen lds
    v_add_f32 v24, v24, v29
    v_add_f32 v24, v24, v30
    v_add_f32 v24, v24, v31
    v_add_f32 v24, v24, v32
    v_add_f32 v24, v24, v33
    v_add_f32 v24, v24, v34
    v_add_f32 v24, v24, v35
    v_add_f32 v24, v24, v36
    v_add_f32 v24, v24, v37
    v_add_f32 v24, v24, v38
    v_add_f32 v24, v24, v39
    v_add_f32 v24, v24, v40
    v_add_f32 v24, v24, v41
    v_add_f32 v24, v24, v42
    v_add_f32 v24, v24, v43
    v_add_f32 v24, v24, v44
    v_add_f32 v24, v24, v45
    v_add_f32 v24, v24, v46
    v_add_f32 v24, v24, v47
    v_add_f32 v24, v24, v48
    s_waitcnt vmcnt(28)
    s_barrier
    s_add_u32 m0, s54, 0
    s_add_u32 s55, s53, 3072
    buffer_load_dwordx4 v14, s[8:11], s55 offen lds
    s_add_u32 m0, s54, 4096
    s_add_u32 s55, s53, 134144
    buffer_load_dwordx4 v14, s[8:11], s55 offen lds
    s_add_u32 m0, s54, 8192
    s_add_u32 s55, s53, 265216
    buffer_load_dwordx4 v14, s[8:11], s55 offen lds
    s_add_u32 m0, s54, 12288
    s_add_u32 s55, s53, 396288
    buffer_load_dwordx4 v14, s[8:11], s55 offen lds
    s_add_u32 m0, s54, 16384
    s_add_u32 s55, s56, 3072
    buffer_load_dwordx4 v15, s[12:15], s55 offen lds
    s_add_u32 m0, s54, 20480
    s_add_u32 s55, s56, 134144
    buffer_load_dwordx4 v15, s[12:15], s55 offen lds
    s_add_u32 m0, s67, 24576
    s_add_u32 s55, s66, 265216
    buffer_load_dwordx4 v15, s[12:15], s55 offen lds
    v_add_f32 v24, v24, v49
    v_add_f32 v24, v24, v50
    v_add_f32 v24, v24, v51
    v_add_f32 v24, v24, v52
    v_add_f32 v24, v24, v53
    v_add_f32 v24, v24, v54
    v_add_f32 v24, v24, v55
    v_add_f32 v24, v24, v56
    v_add_f32 v24, v24, v57
    v_add_f32 v24, v24, v58
    v_add_f32 v24, v24, v59
    v_add_f32 v24, v24, v60
    v_add_f32 v24, v24, v61
    v_add_f32 v24, v24, v62
    v_add_f32 v24, v24, v63
    v_add_f32 v24, v24, v64
    v_add_f32 v24, v24, v65
    v_add_f32 v24, v24, v66
    v_add_f32 v24, v24, v67
    v_add_f32 v24, v24, v68
    s_waitcnt vmcnt(28)
    s_barrier
    s_add_u32 m0, s54, 26624
    s_add_u32 s55, s53, 3200
    buffer_load_dwordx4 v14, s[8:11], s55 offen lds
    s_add_u32 m0, s54, 30720
    s_add_u32 s55, s53, 134272
    buffer_load_dwordx4 v14, s[8:11], s55 offen lds
    s_add_u32 m0, s54, 34816
    s_add_u32 s55, s53, 265344
    buffer_load_dwordx4 v14, s[8:11], s55 offen lds
    s_add_u32 m0, s54, 38912
    s_add_u32 s55, s53, 396416
    buffer_load_dwordx4 v14, s[8:11], s55 offen lds
    s_add_u32 m0, s54, 43008
    s_add_u32 s55, s56, 3200
    buffer_load_dwordx4 v15, s[12:15], s55 offen lds
    s_add_u32 m0, s54, 47104
    s_add_u32 s55, s56, 134272
    buffer_load_dwordx4 v15, s[12:15], s55 offen lds
    s_add_u32 m0, s67, 51200
    s_add_u32 s55, s66, 265344
    buffer_load_dwordx4 v15, s[12:15], s55 offen lds
    v_add_f32 v24, v24, v69
    v_add_f32 v24, v24, v70
    v_add_f32 v24, v24, v71
    v_add_f32 v24, v24, v72
    v_add_f32 v24, v24, v73
    v_add_f32 v24, v24, v74
    v_add_f32 v24, v24, v75
    v_add_f32 v24, v24, v76
    v_add_f32 v24, v24, v77
    v_add_f32 v24, v24, v78
    v_add_f32 v24, v24, v79
    v_add_f32 v24, v24, v80
    v_add_f32 v24, v24, v81
    v_add_f32 v24, v24, v82
    v_add_f32 v24, v24, v83
    v_add_f32 v24, v24, v84
    v_add_f32 v24, v24, v85
    v_add_f32 v24, v24, v86
    v_add_f32 v24, v24, v87
    v_and_b32 v20, 1, v1
    s_waitcnt vmcnt(28)
    s_barrier
    s_add_u32 m0, s54, 53248
    s_add_u32 s55, s53, 3328
    buffer_load_dwordx4 v14, s[8:11], s55 offen lds
    s_add_u32 m0, s54, 57344
    s_add_u32 s55, s53, 134400
    buffer_load_dwordx4 v14, s[8:11], s55 offen lds
    s_add_u32 m0, s54, 61440
    s_add_u32 s55, s53, 265472
    buffer_load_dwordx4 v14, s[8:11], s55 offen lds
    s_add_u32 m0, s54, 65536
    s_add_u32 s55, s53, 396544
    buffer_load_dwordx4 v14, s[8:11], s55 offen lds
    s_add_u32 m0, s54, 69632
    s_add_u32 s55, s56, 3328
    buffer_load_dwordx4 v15, s[12:15], s55 offen lds
    s_add_u32 m0, s54, 73728
    s_add_u32 s55, s56, 134400
    buffer_load_dwordx4 v15, s[12:15], s55 offen lds
    s_add_u32 m0, s67, 77824
    s_add_u32 s55, s66, 265472
    buffer_load_dwordx4 v15, s[12:15], s55 offen lds
    v_mul_u32_u24 v20, 6144, v20
    v_lshrrev_b32 v21, 1, v1
    v_lshlrev_b32 v21, 2, v21
    v_add_u32 v21, s82, v21
    v_lshl_add_u32 v20, v21, 2, v20
    v_cmp_gt_u32 vcc, s85, v1
    v_mov_b32 v22, 0x7ffffff0
    s_nop 1
    v_cndmask_b32 v20, v22, v20, vcc
    buffer_store_dword v24, v20, s[76:79], 0 offen
    s_waitcnt vmcnt(28)
    s_barrier
    s_add_u32 m0, s54, 79872
    s_add_u32 s55, s53, 3456
    buffer_load_dwordx4 v14, s[8:11], s55 offen lds
    s_add_u32 m0, s54, 83968
    s_add_u32 s55, s53, 134528
    buffer_load_dwordx4 v14, s[8:11], s55 offen lds
    s_add_u32 m0, s54, 88064
    s_add_u32 s55, s53, 265600
    buffer_load_dwordx4 v14, s[8:11], s55 offen lds
    s_add_u32 m0, s54, 92160
    s_add_u32 s55, s53, 396672
    buffer_load_dwordx4 v14, s[8:11], s55 offen lds
    s_add_u32 m0, s54, 96256
    s_add_u32 s55, s56, 3456
    buffer_load_dwordx4 v15, s[12:15], s55 offen lds
    s_add_u32 m0, s54, 100352
    s_add_u32 s55, s56, 134528
    buffer_load_dwordx4 v15, s[12:15], s55 offen lds
    s_add_u32 m0, s67, 104448
    s_add_u32 s55, s66, 265600
    buffer_load_dwordx4 v15, s[12:15], s55 offen lds
    s_waitcnt vmcnt(28)
    s_barrier
    s_add_u32 m0, s54, 106496
    s_add_u32 s55, s53, 3584
    buffer_load_dwordx4 v14, s[8:11], s55 offen lds
    s_add_u32 m0, s54, 110592
    s_add_u32 s55, s53, 134656
    buffer_load_dwordx4 v14, s[8:11], s55 offen lds
    s_add_u32 m0, s54, 114688
    s_add_u32 s55, s53, 265728
    buffer_load_dwordx4 v14, s[8:11], s55 offen lds
    s_add_u32 m0, s54, 118784
    s_add_u32 s55, s53, 396800
    buffer_load_dwordx4 v14, s[8:11], s55 offen lds
    s_add_u32 m0, s54, 122880
    s_add_u32 s55, s56, 3584
    buffer_load_dwordx4 v15, s[12:15], s55 offen lds
    s_add_u32 m0, s54, 126976
    s_add_u32 s55, s56, 134656
    buffer_load_dwordx4 v15, s[12:15], s55 offen lds
    s_add_u32 m0, s67, 131072
    s_add_u32 s55, s66, 265728
    buffer_load_dwordx4 v15, s[12:15], s55 offen lds
    s_waitcnt vmcnt(28)
    s_barrier
    s_add_u32 m0, s54, 133120
    s_add_u32 s55, s53, 3712
    buffer_load_dwordx4 v14, s[8:11], s55 offen lds
    s_add_u32 m0, s54, 137216
    s_add_u32 s55, s53, 134784
    buffer_load_dwordx4 v14, s[8:11], s55 offen lds
    s_add_u32 m0, s54, 141312
    s_add_u32 s55, s53, 265856
    buffer_load_dwordx4 v14, s[8:11], s55 offen lds
    s_add_u32 m0, s54, 145408
    s_add_u32 s55, s53, 396928
    buffer_load_dwordx4 v14, s[8:11], s55 offen lds
    s_add_u32 m0, s54, 149504
    s_add_u32 s55, s56, 3712
    buffer_load_dwordx4 v15, s[12:15], s55 offen lds
    s_add_u32 m0, s54, 153600
    s_add_u32 s55, s56, 134784
    buffer_load_dwordx4 v15, s[12:15], s55 offen lds
    s_add_u32 m0, s67, 157696
    s_add_u32 s55, s66, 265856
    buffer_load_dwordx4 v15, s[12:15], s55 offen lds
    s_waitcnt vmcnt(28)
    s_barrier
    s_add_u32 m0, s54, 0
    s_add_u32 s55, s53, 3840
    buffer_load_dwordx4 v14, s[8:11], s55 offen lds
    s_add_u32 m0, s54, 4096
    s_add_u32 s55, s53, 134912
    buffer_load_dwordx4 v14, s[8:11], s55 offen lds
    s_add_u32 m0, s54, 8192
    s_add_u32 s55, s53, 265984
    buffer_load_dwordx4 v14, s[8:11], s55 offen lds
    s_add_u32 m0, s54, 12288
    s_add_u32 s55, s53, 397056
    buffer_load_dwordx4 v14, s[8:11], s55 offen lds
    s_add_u32 m0, s54, 16384
    s_add_u32 s55, s56, 3840
    buffer_load_dwordx4 v15, s[12:15], s55 offen lds
    s_add_u32 m0, s54, 20480
    s_add_u32 s55, s56, 134912
    buffer_load_dwordx4 v15, s[12:15], s55 offen lds
    s_add_u32 m0, s67, 24576
    s_add_u32 s55, s66, 265984
    buffer_load_dwordx4 v15, s[12:15], s55 offen lds
    s_waitcnt vmcnt(28)
    s_barrier
    s_add_u32 m0, s54, 26624
    s_add_u32 s55, s53, 3968
    buffer_load_dwordx4 v14, s[8:11], s55 offen lds
    s_add_u32 m0, s54, 30720
    s_add_u32 s55, s53, 135040
    buffer_load_dwordx4 v14, s[8:11], s55 offen lds
    s_add_u32 m0, s54, 34816
    s_add_u32 s55, s53, 266112
    buffer_load_dwordx4 v14, s[8:11], s55 offen lds
    s_add_u32 m0, s54, 38912
    s_add_u32 s55, s53, 397184
    buffer_load_dwordx4 v14, s[8:11], s55 offen lds
    s_add_u32 m0, s54, 43008
    s_add_u32 s55, s56, 3968
    buffer_load_dwordx4 v15, s[12:15], s55 offen lds
    s_add_u32 m0, s54, 47104
    s_add_u32 s55, s56, 135040
    buffer_load_dwordx4 v15, s[12:15], s55 offen lds
    s_add_u32 m0, s67, 51200
    s_add_u32 s55, s66, 266112
    buffer_load_dwordx4 v15, s[12:15], s55 offen lds
    s_waitcnt vmcnt(28)
    s_barrier
    s_waitcnt vmcnt(21)
    s_barrier
    s_waitcnt vmcnt(14)
    s_barrier
    s_waitcnt vmcnt(7)
    s_barrier
    s_waitcnt vmcnt(0)
    s_barrier
    s_endpgm
.globl l2_kernel
.p2align 8
.type l2_kernel,@function
l2_kernel:
    s_cmp_ge_u32 s2, 256
    s_cbranch_scc1 l2_kernel_end
    s_load_dwordx2 s[4:5], s[0:1], 96
    s_load_dwordx2 s[30:31], s[0:1], 0
    v_lshrrev_b32 v4, 6, v0
    v_and_b32 v1, 63, v0
    v_and_b32 v2, 15, v0
    v_readfirstlane_b32 s40, v4
    v_lshrrev_b32 v3, 4, v1
    s_and_b32 s41, s2, 7
    s_lshr_b32 s42, s2, 3
    s_lshr_b32 s43, s42, 3
    s_mul_i32 s41, s41, 4
    s_add_u32 s41, s41, s43
    s_and_b32 s42, s42, 7
    s_mul_i32 s44, s42, 80
    s_and_b32 s45, s40, 1
    s_lshr_b32 s46, s40, 1
    s_lshl_b32 s47, s41, 6
    s_mov_b32 s39, s47
    s_cmp_ge_u32 s40, 4
    s_cbranch_scc1 l2_kernel_prod
    s_waitcnt lgkmcnt(0)
    s_add_u32 s8, s4, 0x800000
    s_addc_u32 s9, s5, 0
    s_mov_b32 s10, 0x500000
    s_mov_b32 s11, 0x00020000
    s_add_u32 s12, s4, 0x1b00000
    s_addc_u32 s13, s5, 0
    s_mov_b32 s14, 0x190000
    s_mov_b32 s15, 0x00020000
    s_mov_b32 s20, s4
    s_mov_b32 s21, s5
    s_mov_b32 s22, 0x1e00
    s_mov_b32 s23, 0x00020000
    s_add_u32 s24, s4, 0xe00000
    s_addc_u32 s25, s5, 0
    s_mov_b32 s26, 0x280000
    s_mov_b32 s27, 0x00020000
    s_mov_b32 s16, s30
    s_mov_b32 s17, s31
    s_mov_b32 s18, 0x280000
    s_mov_b32 s19, 0x00020000
    s_add_u32 s28, s4, 0x1100000
    s_addc_u32 s29, s5, 0
    s_mov_b32 s30, 0x280000
    s_mov_b32 s31, 0x00020000
    v_lshrrev_b32 v4, 1, v2
    v_xor_b32 v4, v3, v4
    s_mul_i32 s53, s46, 8192
    s_mul_i32 s56, s45, 4096
    s_add_u32 s53, s53, s56
    s_mul_i32 s56, s46, 10240
    s_add_u32 s56, s56, 16384
    v_xor_b32 v5, 0, v4
    v_lshlrev_b32 v5, 4, v5
    v_lshl_add_u32 v5, v2, 7, v5
    v_add_u32 v7, s53, v5
    v_add_u32 v15, s56, v5
    v_add_u32 v9, 36864, v7
    v_add_u32 v17, 36864, v15
    v_add_u32 v11, 73728, v7
    v_add_u32 v19, 73728, v15
    v_add_u32 v13, 110592, v7
    v_add_u32 v21, 110592, v15
    v_xor_b32 v5, 4, v4
    v_lshlrev_b32 v5, 4, v5
    v_lshl_add_u32 v5, v2, 7, v5
    v_add_u32 v8, s53, v5
    v_add_u32 v16, s56, v5
    v_add_u32 v10, 36864, v8
    v_add_u32 v18, 36864, v16
    v_add_u32 v12, 73728, v8
    v_add_u32 v20, 73728, v16
    v_add_u32 v14, 110592, v8
    v_add_u32 v22, 110592, v16
    v_mov_b32 v108, 0
    v_mov_b32 v109, 0
    v_mov_b32 v110, 0
    v_mov_b32 v111, 0
    v_mov_b32 v112, 0
    v_mov_b32 v113, 0
    v_mov_b32 v114, 0
    v_mov_b32 v115, 0
    v_mov_b32 v116, 0
    v_mov_b32 v117, 0
    v_mov_b32 v118, 0
    v_mov_b32 v119, 0
    v_mov_b32 v120, 0
    v_mov_b32 v121, 0
    v_mov_b32 v122, 0
    v_mov_b32 v123, 0
    v_mov_b32 v124, 0
    v_mov_b32 v125, 0
    v_mov_b32 v126, 0
    v_mov_b32 v127, 0
    v_mov_b32 v128, 0
    v_mov_b32 v129, 0
    v_mov_b32 v130, 0
    v_mov_b32 v131, 0
    v_mov_b32 v132, 0
    v_mov_b32 v133, 0
    v_mov_b32 v134, 0
    v_mov_b32 v135, 0
    v_mov_b32 v136, 0
    v_mov_b32 v137, 0
    v_mov_b32 v138, 0
    v_mov_b32 v139, 0
    v_mov_b32 v140, 0
    v_mov_b32 v141, 0
    v_mov_b32 v142, 0
    v_mov_b32 v143, 0
    v_mov_b32 v144, 0
    v_mov_b32 v145, 0
    v_mov_b32 v146, 0
    v_mov_b32 v147, 0
    s_lshl_b32 s38, s45, 5
    s_add_u32 s38, s38, s39
    s_lshl_b32 s37, s46, 4
    s_add_u32 s38, s38, s37
    s_mul_i32 s57, s40, 2816
    s_add_u32 s57, s57, 32768
    s_lshl_b32 s58, s44, 1
    s_mov_b32 s59, 1280
    v_add_u32 v4, 0, v1
    v_mul_u32_u24 v5, 6554, v4
    v_lshrrev_b32 v5, 16, v5
    v_mul_u32_u24 v6, 10, v5
    v_sub_u32 v6, v4, v6
    v_lshlrev_b32 v6, 4, v6
    v_mul_u32_u24 v148, 176, v5
    v_add3_u32 v148, v148, v6, s57
    v_add_u32 v154, s58, v6
    v_add_u32 v5, s38, v5
    v_mul_lo_u32 v151, v5, s59
    v_add_u32 v151, v151, v154
    v_add_u32 v4, 64, v1
    v_mul_u32_u24 v5, 6554, v4
    v_lshrrev_b32 v5, 16, v5
    v_mul_u32_u24 v6, 10, v5
    v_sub_u32 v6, v4, v6
    v_lshlrev_b32 v6, 4, v6
    v_mul_u32_u24 v149, 176, v5
    v_add3_u32 v149, v149, v6, s57
    v_add_u32 v155, s58, v6
    v_add_u32 v5, s38, v5
    v_mul_lo_u32 v152, v5, s59
    v_add_u32 v152, v152, v155
    v_add_u32 v4, 128, v1
    v_mul_u32_u24 v5, 6554, v4
    v_lshrrev_b32 v5, 16, v5
    v_mul_u32_u24 v6, 10, v5
    v_sub_u32 v6, v4, v6
    v_lshlrev_b32 v6, 4, v6
    v_mul_u32_u24 v150, 176, v5
    v_add3_u32 v150, v150, v6, s57
    v_add_u32 v156, s58, v6
    v_add_u32 v5, s38, v5
    v_mul_lo_u32 v153, v5, s59
    v_add_u32 v153, v153, v156
    v_cmp_gt_u32 vcc, 160, v4
    v_mov_b32 v5, 0x7ffffff0
    s_nop 1
    v_cndmask_b32 v153, v5, v153, vcc
    v_cndmask_b32 v150, 0, v150, vcc
    v_mul_u32_u24 v157, 176, v2
    v_lshl_add_u32 v157, v3, 3, v157
    v_add_u32 v157, s57, v157
    s_mov_b32 s61, 2560
    buffer_load_dwordx4 v[172:175], v154, s[20:23], s61 offen
    buffer_load_dwordx4 v[176:179], v155, s[20:23], s61 offen
    buffer_load_dwordx4 v[180:183], v156, s[20:23], s61 offen
    buffer_load_dwordx4 v[196:199], v151, s[16:19], 0 offen
    buffer_load_dwordx4 v[200:203], v152, s[16:19], 0 offen
    buffer_load_dwordx4 v[204:207], v153, s[16:19], 0 offen
    s_mov_b32 s61, 5120
    buffer_load_dwordx4 v[220:223], v154, s[20:23], s61 offen
    buffer_load_dwordx4 v[224:227], v155, s[20:23], s61 offen
    buffer_load_dwordx4 v[228:231], v156, s[20:23], s61 offen
    s_barrier
    ds_read_b128 v[24:27], v7 offset:0
    ds_read_b128 v[40:43], v15 offset:0
    ds_read_b128 v[44:47], v15 offset:2048
    ds_read_b128 v[48:51], v15 offset:4096
    ds_read_b128 v[52:55], v15 offset:6144
    ds_read_b128 v[56:59], v15 offset:8192
    ds_read_b128 v[28:31], v7 offset:2048
    s_waitcnt lgkmcnt(0)
    v_mfma_f32_16x16x32_bf16 v[108:111], v[40:43], v[24:27], v[108:111]
    ds_read_b128 v[32:35], v8 offset:0
    v_mfma_f32_16x16x32_bf16 v[112:115], v[44:47], v[24:27], v[112:115]
    ds_read_b128 v[60:63], v16 offset:0
    v_mfma_f32_16x16x32_bf16 v[116:119], v[48:51], v[24:27], v[116:119]
    ds_read_b128 v[64:67], v16 offset:2048
    v_mfma_f32_16x16x32_bf16 v[120:123], v[52:55], v[24:27], v[120:123]
    ds_read_b128 v[68:71], v16 offset:4096
    v_mfma_f32_16x16x32_bf16 v[124:127], v[56:59], v[24:27], v[124:127]
    ds_read_b128 v[72:75], v16 offset:6144
    v_mfma_f32_16x16x32_bf16 v[128:131], v[40:43], v[28:31], v[128:131]
    ds_read_b128 v[76:79], v16 offset:8192
    v_mfma_f32_16x16x32_bf16 v[132:135], v[44:47], v[28:31], v[132:135]
    ds_read_b128 v[36:39], v8 offset:2048
    v_mfma_f32_16x16x32_bf16 v[136:139], v[48:51], v[28:31], v[136:139]
    v_mfma_f32_16x16x32_bf16 v[140:143], v[52:55], v[28:31], v[140:143]
    v_mfma_f32_16x16x32_bf16 v[144:147], v[56:59], v[28:31], v[144:147]
    s_waitcnt lgkmcnt(0)
    s_barrier
    v_mfma_f32_16x16x32_bf16 v[108:111], v[60:63], v[32:35], v[108:111]
    ds_read_b128 v[24:27], v9 offset:0
    v_mfma_f32_16x16x32_bf16 v[112:115], v[64:67], v[32:35], v[112:115]
    ds_read_b128 v[40:43], v17 offset:0
    v_mfma_f32_16x16x32_bf16 v[116:119], v[68:71], v[32:35], v[116:119]
    ds_read_b128 v[44:47], v17 offset:2048
    v_mfma_f32_16x16x32_bf16 v[120:123], v[72:75], v[32:35], v[120:123]
    ds_read_b128 v[48:51], v17 offset:4096
    v_mfma_f32_16x16x32_bf16 v[124:127], v[76:79], v[32:35], v[124:127]
    ds_read_b128 v[52:55], v17 offset:6144
    v_mfma_f32_16x16x32_bf16 v[128:131], v[60:63], v[36:39], v[128:131]
    ds_read_b128 v[56:59], v17 offset:8192
    v_mfma_f32_16x16x32_bf16 v[132:135], v[64:67], v[36:39], v[132:135]
    ds_read_b128 v[28:31], v9 offset:2048
    v_mfma_f32_16x16x32_bf16 v[136:139], v[68:71], v[36:39], v[136:139]
    v_mfma_f32_16x16x32_bf16 v[140:143], v[72:75], v[36:39], v[140:143]
    v_mfma_f32_16x16x32_bf16 v[144:147], v[76:79], v[36:39], v[144:147]
    s_waitcnt lgkmcnt(0)
    v_mfma_f32_16x16x32_bf16 v[108:111], v[40:43], v[24:27], v[108:111]
    ds_read_b128 v[32:35], v10 offset:0
    v_mfma_f32_16x16x32_bf16 v[112:115], v[44:47], v[24:27], v[112:115]
    ds_read_b128 v[60:63], v18 offset:0
    v_mfma_f32_16x16x32_bf16 v[116:119], v[48:51], v[24:27], v[116:119]
    ds_read_b128 v[64:67], v18 offset:2048
    v_mfma_f32_16x16x32_bf16 v[120:123], v[52:55], v[24:27], v[120:123]
    ds_read_b128 v[68:71], v18 offset:4096
    v_mfma_f32_16x16x32_bf16 v[124:127], v[56:59], v[24:27], v[124:127]
    ds_read_b128 v[72:75], v18 offset:6144
    v_mfma_f32_16x16x32_bf16 v[128:131], v[40:43], v[28:31], v[128:131]
    ds_read_b128 v[76:79], v18 offset:8192
    v_mfma_f32_16x16x32_bf16 v[132:135], v[44:47], v[28:31], v[132:135]
    ds_read_b128 v[36:39], v10 offset:2048
    v_mfma_f32_16x16x32_bf16 v[136:139], v[48:51], v[28:31], v[136:139]
    v_mfma_f32_16x16x32_bf16 v[140:143], v[52:55], v[28:31], v[140:143]
    v_mfma_f32_16x16x32_bf16 v[144:147], v[56:59], v[28:31], v[144:147]
    s_waitcnt lgkmcnt(0)
    s_barrier
    s_waitcnt vmcnt(0)
    v_mfma_f32_16x16x32_bf16 v[108:111], v[60:63], v[32:35], v[108:111]
    ds_read_b128 v[24:27], v11 offset:0
    v_mfma_f32_16x16x32_bf16 v[112:115], v[64:67], v[32:35], v[112:115]
    ds_read_b128 v[40:43], v19 offset:0
    v_mfma_f32_16x16x32_bf16 v[116:119], v[68:71], v[32:35], v[116:119]
    ds_read_b128 v[44:47], v19 offset:2048
    v_mfma_f32_16x16x32_bf16 v[120:123], v[72:75], v[32:35], v[120:123]
    ds_read_b128 v[48:51], v19 offset:4096
    v_mfma_f32_16x16x32_bf16 v[124:127], v[76:79], v[32:35], v[124:127]
    ds_read_b128 v[52:55], v19 offset:6144
    v_mfma_f32_16x16x32_bf16 v[128:131], v[60:63], v[36:39], v[128:131]
    ds_read_b128 v[56:59], v19 offset:8192
    v_mfma_f32_16x16x32_bf16 v[132:135], v[64:67], v[36:39], v[132:135]
    ds_read_b128 v[28:31], v11 offset:2048
    v_mfma_f32_16x16x32_bf16 v[136:139], v[68:71], v[36:39], v[136:139]
    v_lshlrev_b32 v160, 16, v172
    v_and_b32 v161, 0xffff0000, v172
    v_lshlrev_b32 v162, 16, v173
    v_and_b32 v163, 0xffff0000, v173
    v_lshlrev_b32 v164, 16, v174
    v_mfma_f32_16x16x32_bf16 v[140:143], v[72:75], v[36:39], v[140:143]
    v_and_b32 v165, 0xffff0000, v174
    v_lshlrev_b32 v166, 16, v175
    v_and_b32 v167, 0xffff0000, v175
    v_lshlrev_b32 v168, 16, v176
    v_and_b32 v169, 0xffff0000, v176
    v_mfma_f32_16x16x32_bf16 v[144:147], v[76:79], v[36:39], v[144:147]
    v_lshlrev_b32 v170, 16, v177
    v_and_b32 v171, 0xffff0000, v177
    v_lshlrev_b32 v172, 16, v178
    v_and_b32 v173, 0xffff0000, v178
    v_lshlrev_b32 v174, 16, v179
    s_waitcnt lgkmcnt(0)
    v_mfma_f32_16x16x32_bf16 v[108:111], v[40:43], v[24:27], v[108:111]
    ds_read_b128 v[32:35], v12 offset:0
    v_mfma_f32_16x16x32_bf16 v[112:115], v[44:47], v[24:27], v[112:115]
    ds_read_b128 v[60:63], v20 offset:0
    v_mfma_f32_16x16x32_bf16 v[116:119], v[48:51], v[24:27], v[116:119]
    ds_read_b128 v[64:67], v20 offset:2048
    v_mfma_f32_16x16x32_bf16 v[120:123], v[52:55], v[24:27], v[120:123]
    ds_read_b128 v[68:71], v20 offset:4096
    v_mfma_f32_16x16x32_bf16 v[124:127], v[56:59], v[24:27], v[124:127]
    ds_read_b128 v[72:75], v20 offset:6144
    v_mfma_f32_16x16x32_bf16 v[128:131], v[40:43], v[28:31], v[128:131]
    ds_read_b128 v[76:79], v20 offset:8192
    v_mfma_f32_16x16x32_bf16 v[132:135], v[44:47], v[28:31], v[132:135]
    ds_read_b128 v[36:39], v12 offset:2048
    v_mfma_f32_16x16x32_bf16 v[136:139], v[48:51], v[28:31], v[136:139]
    v_and_b32 v175, 0xffff0000, v179
    v_lshlrev_b32 v176, 16, v180
    v_and_b32 v177, 0xffff0000, v180
    v_lshlrev_b32 v178, 16, v181
    v_and_b32 v179, 0xffff0000, v181
    v_mfma_f32_16x16x32_bf16 v[140:143], v[52:55], v[28:31], v[140:143]
    v_lshlrev_b32 v180, 16, v182
    v_and_b32 v181, 0xffff0000, v182
    v_lshlrev_b32 v182, 16, v183
    v_and_b32 v183, 0xffff0000, v183
    v_lshlrev_b32 v184, 16, v196
    v_mfma_f32_16x16x32_bf16 v[144:147], v[56:59], v[28:31], v[144:147]
    v_and_b32 v185, 0xffff0000, v196
    v_lshlrev_b32 v186, 16, v197
    v_and_b32 v187, 0xffff0000, v197
    v_lshlrev_b32 v188, 16, v198
    v_and_b32 v189, 0xffff0000, v198
    s_waitcnt lgkmcnt(0)
    s_barrier
    v_mfma_f32_16x16x32_bf16 v[108:111], v[60:63], v[32:35], v[108:111]
    ds_read_b128 v[24:27], v13 offset:0
    v_mfma_f32_16x16x32_bf16 v[112:115], v[64:67], v[32:35], v[112:115]
    ds_read_b128 v[40:43], v21 offset:0
    v_mfma_f32_16x16x32_bf16 v[116:119], v[68:71], v[32:35], v[116:119]
    ds_read_b128 v[44:47], v21 offset:2048
    v_mfma_f32_16x16x32_bf16 v[120:123], v[72:75], v[32:35], v[120:123]
    ds_read_b128 v[48:51], v21 offset:4096
    v_mfma_f32_16x16x32_bf16 v[124:127], v[76:79], v[32:35], v[124:127]
    ds_read_b128 v[52:55], v21 offset:6144
    v_mfma_f32_16x16x32_bf16 v[128:131], v[60:63], v[36:39], v[128:131]
    ds_read_b128 v[56:59], v21 offset:8192
    v_mfma_f32_16x16x32_bf16 v[132:135], v[64:67], v[36:39], v[132:135]
    ds_read_b128 v[28:31], v13 offset:2048
    v_mfma_f32_16x16x32_bf16 v[136:139], v[68:71], v[36:39], v[136:139]
    v_lshlrev_b32 v190, 16, v199
    v_and_b32 v191, 0xffff0000, v199
    v_lshlrev_b32 v192, 16, v200
    v_and_b32 v193, 0xffff0000, v200
    v_lshlrev_b32 v194, 16, v201
    v_mfma_f32_16x16x32_bf16 v[140:143], v[72:75], v[36:39], v[140:143]
    v_and_b32 v195, 0xffff0000, v201
    v_lshlrev_b32 v196, 16, v202
    v_and_b32 v197, 0xffff0000, v202
    v_lshlrev_b32 v198, 16, v203
    v_and_b32 v199, 0xffff0000, v203
    v_mfma_f32_16x16x32_bf16 v[144:147], v[76:79], v[36:39], v[144:147]
    v_lshlrev_b32 v200, 16, v204
    v_and_b32 v201, 0xffff0000, v204
    v_lshlrev_b32 v202, 16, v205
    v_and_b32 v203, 0xffff0000, v205
    v_lshlrev_b32 v204, 16, v206
    s_waitcnt lgkmcnt(0)
    v_mfma_f32_16x16x32_bf16 v[108:111], v[40:43], v[24:27], v[108:111]
    ds_read_b128 v[32:35], v14 offset:0
    v_mfma_f32_16x16x32_bf16 v[112:115], v[44:47], v[24:27], v[112:115]
    ds_read_b128 v[60:63], v22 offset:0
    v_mfma_f32_16x16x32_bf16 v[116:119], v[48:51], v[24:27], v[116:119]
    ds_read_b128 v[64:67], v22 offset:2048
    v_mfma_f32_16x16x32_bf16 v[120:123], v[52:55], v[24:27], v[120:123]
    ds_read_b128 v[68:71], v22 offset:4096
    v_mfma_f32_16x16x32_bf16 v[124:127], v[56:59], v[24:27], v[124:127]
    ds_read_b128 v[72:75], v22 offset:6144
    v_mfma_f32_16x16x32_bf16 v[128:131], v[40:43], v[28:31], v[128:131]
    ds_read_b128 v[76:79], v22 offset:8192
    v_mfma_f32_16x16x32_bf16 v[132:135], v[44:47], v[28:31], v[132:135]
    ds_read_b128 v[36:39], v14 offset:2048
    v_mfma_f32_16x16x32_bf16 v[136:139], v[48:51], v[28:31], v[136:139]
    v_and_b32 v205, 0xffff0000, v206
    v_lshlrev_b32 v206, 16, v207
    v_and_b32 v207, 0xffff0000, v207
    v_lshlrev_b32 v208, 16, v220
    v_and_b32 v209, 0xffff0000, v220
    v_mfma_f32_16x16x32_bf16 v[140:143], v[52:55], v[28:31], v[140:143]
    v_lshlrev_b32 v210, 16, v221
    v_and_b32 v211, 0xffff0000, v221
    v_lshlrev_b32 v212, 16, v222
    v_and_b32 v213, 0xffff0000, v222
    v_lshlrev_b32 v214, 16, v223
    v_mfma_f32_16x16x32_bf16 v[144:147], v[56:59], v[28:31], v[144:147]
    v_and_b32 v215, 0xffff0000, v223
    v_lshlrev_b32 v216, 16, v224
    v_and_b32 v217, 0xffff0000, v224
    v_lshlrev_b32 v218, 16, v225
    v_and_b32 v219, 0xffff0000, v225
    s_waitcnt lgkmcnt(0)
    s_barrier
    v_mfma_f32_16x16x32_bf16 v[108:111], v[60:63], v[32:35], v[108:111]
    ds_read_b128 v[24:27], v7 offset:0
    v_mfma_f32_16x16x32_bf16 v[112:115], v[64:67], v[32:35], v[112:115]
    ds_read_b128 v[40:43], v15 offset:0
    v_mfma_f32_16x16x32_bf16 v[116:119], v[68:71], v[32:35], v[116:119]
    ds_read_b128 v[44:47], v15 offset:2048
    v_mfma_f32_16x16x32_bf16 v[120:123], v[72:75], v[32:35], v[120:123]
    ds_read_b128 v[48:51], v15 offset:4096
    v_mfma_f32_16x16x32_bf16 v[124:127], v[76:79], v[32:35], v[124:127]
    ds_read_b128 v[52:55], v15 offset:6144
    v_mfma_f32_16x16x32_bf16 v[128:131], v[60:63], v[36:39], v[128:131]
    ds_read_b128 v[56:59], v15 offset:8192
    v_mfma_f32_16x16x32_bf16 v[132:135], v[64:67], v[36:39], v[132:135]
    ds_read_b128 v[28:31], v7 offset:2048
    v_mfma_f32_16x16x32_bf16 v[136:139], v[68:71], v[36:39], v[136:139]
    v_lshlrev_b32 v220, 16, v226
    v_and_b32 v221, 0xffff0000, v226
    v_lshlrev_b32 v222, 16, v227
    v_and_b32 v223, 0xffff0000, v227
    v_lshlrev_b32 v224, 16, v228
    v_mfma_f32_16x16x32_bf16 v[140:143], v[72:75], v[36:39], v[140:143]
    v_and_b32 v225, 0xffff0000, v228
    v_lshlrev_b32 v226, 16, v229
    v_and_b32 v227, 0xffff0000, v229
    v_lshlrev_b32 v228, 16, v230
    v_and_b32 v229, 0xffff0000, v230
    v_mfma_f32_16x16x32_bf16 v[144:147], v[76:79], v[36:39], v[144:147]
    v_lshlrev_b32 v230, 16, v231
    v_and_b32 v231, 0xffff0000, v231
    v_add_f32 v208, 1.0, v208
    v_add_f32 v209, 1.0, v209
    v_cvt_pk_bf16_f32 v232, v208, v209
    s_waitcnt lgkmcnt(0)
    v_mfma_f32_16x16x32_bf16 v[108:111], v[40:43], v[24:27], v[108:111]
    ds_read_b128 v[32:35], v8 offset:0
    v_mfma_f32_16x16x32_bf16 v[112:115], v[44:47], v[24:27], v[112:115]
    ds_read_b128 v[60:63], v16 offset:0
    v_mfma_f32_16x16x32_bf16 v[116:119], v[48:51], v[24:27], v[116:119]
    ds_read_b128 v[64:67], v16 offset:2048
    v_mfma_f32_16x16x32_bf16 v[120:123], v[52:55], v[24:27], v[120:123]
    ds_read_b128 v[68:71], v16 offset:4096
    v_mfma_f32_16x16x32_bf16 v[124:127], v[56:59], v[24:27], v[124:127]
    ds_read_b128 v[72:75], v16 offset:6144
    v_mfma_f32_16x16x32_bf16 v[128:131], v[40:43], v[28:31], v[128:131]
    ds_read_b128 v[76:79], v16 offset:8192
    v_mfma_f32_16x16x32_bf16 v[132:135], v[44:47], v[28:31], v[132:135]
    ds_read_b128 v[36:39], v8 offset:2048
    v_mfma_f32_16x16x32_bf16 v[136:139], v[48:51], v[28:31], v[136:139]
    v_lshlrev_b32 v208, 16, v232
    v_and_b32 v209, 0xffff0000, v232
    v_add_f32 v210, 1.0, v210
    v_add_f32 v211, 1.0, v211
    v_cvt_pk_bf16_f32 v232, v210, v211
    v_mfma_f32_16x16x32_bf16 v[140:143], v[52:55], v[28:31], v[140:143]
    v_lshlrev_b32 v210, 16, v232
    v_and_b32 v211, 0xffff0000, v232
    v_add_f32 v212, 1.0, v212
    v_add_f32 v213, 1.0, v213
    v_cvt_pk_bf16_f32 v232, v212, v213
    v_mfma_f32_16x16x32_bf16 v[144:147], v[56:59], v[28:31], v[144:147]
    v_lshlrev_b32 v212, 16, v232
    v_and_b32 v213, 0xffff0000, v232
    v_add_f32 v214, 1.0, v214
    v_add_f32 v215, 1.0, v215
    v_cvt_pk_bf16_f32 v232, v214, v215
    s_waitcnt lgkmcnt(0)
    s_barrier
    v_mfma_f32_16x16x32_bf16 v[108:111], v[60:63], v[32:35], v[108:111]
    ds_read_b128 v[24:27], v9 offset:0
    v_mfma_f32_16x16x32_bf16 v[112:115], v[64:67], v[32:35], v[112:115]
    ds_read_b128 v[40:43], v17 offset:0
    v_mfma_f32_16x16x32_bf16 v[116:119], v[68:71], v[32:35], v[116:119]
    ds_read_b128 v[44:47], v17 offset:2048
    v_mfma_f32_16x16x32_bf16 v[120:123], v[72:75], v[32:35], v[120:123]
    ds_read_b128 v[48:51], v17 offset:4096
    v_mfma_f32_16x16x32_bf16 v[124:127], v[76:79], v[32:35], v[124:127]
    ds_read_b128 v[52:55], v17 offset:6144
    v_mfma_f32_16x16x32_bf16 v[128:131], v[60:63], v[36:39], v[128:131]
    ds_read_b128 v[56:59], v17 offset:8192
    v_mfma_f32_16x16x32_bf16 v[132:135], v[64:67], v[36:39], v[132:135]
    ds_read_b128 v[28:31], v9 offset:2048
    v_mfma_f32_16x16x32_bf16 v[136:139], v[68:71], v[36:39], v[136:139]
    v_lshlrev_b32 v214, 16, v232
    v_and_b32 v215, 0xffff0000, v232
    v_add_f32 v216, 1.0, v216
    v_add_f32 v217, 1.0, v217
    v_cvt_pk_bf16_f32 v232, v216, v217
    v_mfma_f32_16x16x32_bf16 v[140:143], v[72:75], v[36:39], v[140:143]
    v_lshlrev_b32 v216, 16, v232
    v_and_b32 v217, 0xffff0000, v232
    v_add_f32 v218, 1.0, v218
    v_add_f32 v219, 1.0, v219
    v_cvt_pk_bf16_f32 v232, v218, v219
    v_mfma_f32_16x16x32_bf16 v[144:147], v[76:79], v[36:39], v[144:147]
    v_lshlrev_b32 v218, 16, v232
    v_and_b32 v219, 0xffff0000, v232
    v_add_f32 v220, 1.0, v220
    v_add_f32 v221, 1.0, v221
    v_cvt_pk_bf16_f32 v232, v220, v221
    s_waitcnt lgkmcnt(0)
    v_mfma_f32_16x16x32_bf16 v[108:111], v[40:43], v[24:27], v[108:111]
    ds_read_b128 v[32:35], v10 offset:0
    v_mfma_f32_16x16x32_bf16 v[112:115], v[44:47], v[24:27], v[112:115]
    ds_read_b128 v[60:63], v18 offset:0
    v_mfma_f32_16x16x32_bf16 v[116:119], v[48:51], v[24:27], v[116:119]
    ds_read_b128 v[64:67], v18 offset:2048
    v_mfma_f32_16x16x32_bf16 v[120:123], v[52:55], v[24:27], v[120:123]
    ds_read_b128 v[68:71], v18 offset:4096
    v_mfma_f32_16x16x32_bf16 v[124:127], v[56:59], v[24:27], v[124:127]
    ds_read_b128 v[72:75], v18 offset:6144
    v_mfma_f32_16x16x32_bf16 v[128:131], v[40:43], v[28:31], v[128:131]
    ds_read_b128 v[76:79], v18 offset:8192
    v_mfma_f32_16x16x32_bf16 v[132:135], v[44:47], v[28:31], v[132:135]
    ds_read_b128 v[36:39], v10 offset:2048
    v_mfma_f32_16x16x32_bf16 v[136:139], v[48:51], v[28:31], v[136:139]
    v_lshlrev_b32 v220, 16, v232
    v_and_b32 v221, 0xffff0000, v232
    v_add_f32 v222, 1.0, v222
    v_add_f32 v223, 1.0, v223
    v_cvt_pk_bf16_f32 v232, v222, v223
    v_mfma_f32_16x16x32_bf16 v[140:143], v[52:55], v[28:31], v[140:143]
    v_lshlrev_b32 v222, 16, v232
    v_and_b32 v223, 0xffff0000, v232
    v_add_f32 v224, 1.0, v224
    v_add_f32 v225, 1.0, v225
    v_cvt_pk_bf16_f32 v232, v224, v225
    v_mfma_f32_16x16x32_bf16 v[144:147], v[56:59], v[28:31], v[144:147]
    v_lshlrev_b32 v224, 16, v232
    v_and_b32 v225, 0xffff0000, v232
    v_add_f32 v226, 1.0, v226
    v_add_f32 v227, 1.0, v227
    v_cvt_pk_bf16_f32 v232, v226, v227
    s_waitcnt lgkmcnt(0)
    s_barrier
    v_mfma_f32_16x16x32_bf16 v[108:111], v[60:63], v[32:35], v[108:111]
    ds_read_b128 v[24:27], v11 offset:0
    v_mfma_f32_16x16x32_bf16 v[112:115], v[64:67], v[32:35], v[112:115]
    ds_read_b128 v[40:43], v19 offset:0
    v_mfma_f32_16x16x32_bf16 v[116:119], v[68:71], v[32:35], v[116:119]
    ds_read_b128 v[44:47], v19 offset:2048
    v_mfma_f32_16x16x32_bf16 v[120:123], v[72:75], v[32:35], v[120:123]
    ds_read_b128 v[48:51], v19 offset:4096
    v_mfma_f32_16x16x32_bf16 v[124:127], v[76:79], v[32:35], v[124:127]
    ds_read_b128 v[52:55], v19 offset:6144
    v_mfma_f32_16x16x32_bf16 v[128:131], v[60:63], v[36:39], v[128:131]
    ds_read_b128 v[56:59], v19 offset:8192
    v_mfma_f32_16x16x32_bf16 v[132:135], v[64:67], v[36:39], v[132:135]
    ds_read_b128 v[28:31], v11 offset:2048
    v_mfma_f32_16x16x32_bf16 v[136:139], v[68:71], v[36:39], v[136:139]
    v_lshlrev_b32 v226, 16, v232
    v_and_b32 v227, 0xffff0000, v232
    v_add_f32 v228, 1.0, v228
    v_add_f32 v229, 1.0, v229
    v_cvt_pk_bf16_f32 v232, v228, v229
    v_mfma_f32_16x16x32_bf16 v[140:143], v[72:75], v[36:39], v[140:143]
    v_lshlrev_b32 v228, 16, v232
    v_and_b32 v229, 0xffff0000, v232
    v_add_f32 v230, 1.0, v230
    v_add_f32 v231, 1.0, v231
    v_cvt_pk_bf16_f32 v232, v230, v231
    v_mfma_f32_16x16x32_bf16 v[144:147], v[76:79], v[36:39], v[144:147]
    v_lshlrev_b32 v230, 16, v232
    v_and_b32 v231, 0xffff0000, v232
    s_waitcnt lgkmcnt(0)
    v_mfma_f32_16x16x32_bf16 v[108:111], v[40:43], v[24:27], v[108:111]
    ds_read_b128 v[32:35], v12 offset:0
    v_mfma_f32_16x16x32_bf16 v[112:115], v[44:47], v[24:27], v[112:115]
    ds_read_b128 v[60:63], v20 offset:0
    v_mfma_f32_16x16x32_bf16 v[116:119], v[48:51], v[24:27], v[116:119]
    ds_read_b128 v[64:67], v20 offset:2048
    v_mfma_f32_16x16x32_bf16 v[120:123], v[52:55], v[24:27], v[120:123]
    ds_read_b128 v[68:71], v20 offset:4096
    v_mfma_f32_16x16x32_bf16 v[124:127], v[56:59], v[24:27], v[124:127]
    ds_read_b128 v[72:75], v20 offset:6144
    v_mfma_f32_16x16x32_bf16 v[128:131], v[40:43], v[28:31], v[128:131]
    ds_read_b128 v[76:79], v20 offset:8192
    v_mfma_f32_16x16x32_bf16 v[132:135], v[44:47], v[28:31], v[132:135]
    ds_read_b128 v[36:39], v12 offset:2048
    v_mfma_f32_16x16x32_bf16 v[136:139], v[48:51], v[28:31], v[136:139]
    v_mfma_f32_16x16x32_bf16 v[140:143], v[52:55], v[28:31], v[140:143]
    v_mfma_f32_16x16x32_bf16 v[144:147], v[56:59], v[28:31], v[144:147]
    s_waitcnt lgkmcnt(0)
    s_barrier
    v_mfma_f32_16x16x32_bf16 v[108:111], v[60:63], v[32:35], v[108:111]
    ds_read_b128 v[24:27], v13 offset:0
    v_mfma_f32_16x16x32_bf16 v[112:115], v[64:67], v[32:35], v[112:115]
    ds_read_b128 v[40:43], v21 offset:0
    v_mfma_f32_16x16x32_bf16 v[116:119], v[68:71], v[32:35], v[116:119]
    ds_read_b128 v[44:47], v21 offset:2048
    v_mfma_f32_16x16x32_bf16 v[120:123], v[72:75], v[32:35], v[120:123]
    ds_read_b128 v[48:51], v21 offset:4096
    v_mfma_f32_16x16x32_bf16 v[124:127], v[76:79], v[32:35], v[124:127]
    ds_read_b128 v[52:55], v21 offset:6144
    v_mfma_f32_16x16x32_bf16 v[128:131], v[60:63], v[36:39], v[128:131]
    ds_read_b128 v[56:59], v21 offset:8192
    v_mfma_f32_16x16x32_bf16 v[132:135], v[64:67], v[36:39], v[132:135]
    ds_read_b128 v[28:31], v13 offset:2048
    v_mfma_f32_16x16x32_bf16 v[136:139], v[68:71], v[36:39], v[136:139]
    v_mfma_f32_16x16x32_bf16 v[140:143], v[72:75], v[36:39], v[140:143]
    v_mfma_f32_16x16x32_bf16 v[144:147], v[76:79], v[36:39], v[144:147]
    s_waitcnt lgkmcnt(0)
    v_mfma_f32_16x16x32_bf16 v[108:111], v[40:43], v[24:27], v[108:111]
    ds_read_b128 v[32:35], v14 offset:0
    v_mfma_f32_16x16x32_bf16 v[112:115], v[44:47], v[24:27], v[112:115]
    ds_read_b128 v[60:63], v22 offset:0
    v_mfma_f32_16x16x32_bf16 v[116:119], v[48:51], v[24:27], v[116:119]
    ds_read_b128 v[64:67], v22 offset:2048
    v_mfma_f32_16x16x32_bf16 v[120:123], v[52:55], v[24:27], v[120:123]
    ds_read_b128 v[68:71], v22 offset:4096
    v_mfma_f32_16x16x32_bf16 v[124:127], v[56:59], v[24:27], v[124:127]
    ds_read_b128 v[72:75], v22 offset:6144
    v_mfma_f32_16x16x32_bf16 v[128:131], v[40:43], v[28:31], v[128:131]
    ds_read_b128 v[76:79], v22 offset:8192
    v_mfma_f32_16x16x32_bf16 v[132:135], v[44:47], v[28:31], v[132:135]
    ds_read_b128 v[36:39], v14 offset:2048
    v_mfma_f32_16x16x32_bf16 v[136:139], v[48:51], v[28:31], v[136:139]
    v_mfma_f32_16x16x32_bf16 v[140:143], v[52:55], v[28:31], v[140:143]
    v_mfma_f32_16x16x32_bf16 v[144:147], v[56:59], v[28:31], v[144:147]
    s_waitcnt lgkmcnt(0)
    s_barrier
    v_mfma_f32_16x16x32_bf16 v[108:111], v[60:63], v[32:35], v[108:111]
    ds_read_b128 v[24:27], v7 offset:0
    v_mfma_f32_16x16x32_bf16 v[112:115], v[64:67], v[32:35], v[112:115]
    ds_read_b128 v[40:43], v15 offset:0
    v_mfma_f32_16x16x32_bf16 v[116:119], v[68:71], v[32:35], v[116:119]
    ds_read_b128 v[44:47], v15 offset:2048
    v_mfma_f32_16x16x32_bf16 v[120:123], v[72:75], v[32:35], v[120:123]
    ds_read_b128 v[48:51], v15 offset:4096
    v_mfma_f32_16x16x32_bf16 v[124:127], v[76:79], v[32:35], v[124:127]
    ds_read_b128 v[52:55], v15 offset:6144
    v_mfma_f32_16x16x32_bf16 v[128:131], v[60:63], v[36:39], v[128:131]
    ds_read_b128 v[56:59], v15 offset:8192
    v_mfma_f32_16x16x32_bf16 v[132:135], v[64:67], v[36:39], v[132:135]
    ds_read_b128 v[28:31], v7 offset:2048
    v_mfma_f32_16x16x32_bf16 v[136:139], v[68:71], v[36:39], v[136:139]
    v_mfma_f32_16x16x32_bf16 v[140:143], v[72:75], v[36:39], v[140:143]
    v_mfma_f32_16x16x32_bf16 v[144:147], v[76:79], v[36:39], v[144:147]
    s_waitcnt lgkmcnt(0)
    v_mfma_f32_16x16x32_bf16 v[108:111], v[40:43], v[24:27], v[108:111]
    ds_read_b128 v[32:35], v8 offset:0
    v_mfma_f32_16x16x32_bf16 v[112:115], v[44:47], v[24:27], v[112:115]
    ds_read_b128 v[60:63], v16 offset:0
    v_mfma_f32_16x16x32_bf16 v[116:119], v[48:51], v[24:27], v[116:119]
    ds_read_b128 v[64:67], v16 offset:2048
    v_mfma_f32_16x16x32_bf16 v[120:123], v[52:55], v[24:27], v[120:123]
    ds_read_b128 v[68:71], v16 offset:4096
    v_mfma_f32_16x16x32_bf16 v[124:127], v[56:59], v[24:27], v[124:127]
    ds_read_b128 v[72:75], v16 offset:6144
    v_mfma_f32_16x16x32_bf16 v[128:131], v[40:43], v[28:31], v[128:131]
    ds_read_b128 v[76:79], v16 offset:8192
    v_mfma_f32_16x16x32_bf16 v[132:135], v[44:47], v[28:31], v[132:135]
    ds_read_b128 v[36:39], v8 offset:2048
    v_mfma_f32_16x16x32_bf16 v[136:139], v[48:51], v[28:31], v[136:139]
    v_mfma_f32_16x16x32_bf16 v[140:143], v[52:55], v[28:31], v[140:143]
    v_mfma_f32_16x16x32_bf16 v[144:147], v[56:59], v[28:31], v[144:147]
    s_waitcnt lgkmcnt(0)
    s_barrier
    v_mfma_f32_16x16x32_bf16 v[108:111], v[60:63], v[32:35], v[108:111]
    ds_read_b128 v[24:27], v9 offset:0
    v_mfma_f32_16x16x32_bf16 v[112:115], v[64:67], v[32:35], v[112:115]
    ds_read_b128 v[40:43], v17 offset:0
    v_mfma_f32_16x16x32_bf16 v[116:119], v[68:71], v[32:35], v[116:119]
    ds_read_b128 v[44:47], v17 offset:2048
    v_mfma_f32_16x16x32_bf16 v[120:123], v[72:75], v[32:35], v[120:123]
    ds_read_b128 v[48:51], v17 offset:4096
    v_mfma_f32_16x16x32_bf16 v[124:127], v[76:79], v[32:35], v[124:127]
    ds_read_b128 v[52:55], v17 offset:6144
    v_mfma_f32_16x16x32_bf16 v[128:131], v[60:63], v[36:39], v[128:131]
    ds_read_b128 v[56:59], v17 offset:8192
    v_mfma_f32_16x16x32_bf16 v[132:135], v[64:67], v[36:39], v[132:135]
    ds_read_b128 v[28:31], v9 offset:2048
    v_mfma_f32_16x16x32_bf16 v[136:139], v[68:71], v[36:39], v[136:139]
    v_mfma_f32_16x16x32_bf16 v[140:143], v[72:75], v[36:39], v[140:143]
    v_mfma_f32_16x16x32_bf16 v[144:147], v[76:79], v[36:39], v[144:147]
    s_waitcnt lgkmcnt(0)
    v_mfma_f32_16x16x32_bf16 v[108:111], v[40:43], v[24:27], v[108:111]
    ds_read_b128 v[32:35], v10 offset:0
    v_mfma_f32_16x16x32_bf16 v[112:115], v[44:47], v[24:27], v[112:115]
    ds_read_b128 v[60:63], v18 offset:0
    v_mfma_f32_16x16x32_bf16 v[116:119], v[48:51], v[24:27], v[116:119]
    ds_read_b128 v[64:67], v18 offset:2048
    v_mfma_f32_16x16x32_bf16 v[120:123], v[52:55], v[24:27], v[120:123]
    ds_read_b128 v[68:71], v18 offset:4096
    v_mfma_f32_16x16x32_bf16 v[124:127], v[56:59], v[24:27], v[124:127]
    ds_read_b128 v[72:75], v18 offset:6144
    v_mfma_f32_16x16x32_bf16 v[128:131], v[40:43], v[28:31], v[128:131]
    ds_read_b128 v[76:79], v18 offset:8192
    v_mfma_f32_16x16x32_bf16 v[132:135], v[44:47], v[28:31], v[132:135]
    ds_read_b128 v[36:39], v10 offset:2048
    v_mfma_f32_16x16x32_bf16 v[136:139], v[48:51], v[28:31], v[136:139]
    v_mfma_f32_16x16x32_bf16 v[140:143], v[52:55], v[28:31], v[140:143]
    v_mfma_f32_16x16x32_bf16 v[144:147], v[56:59], v[28:31], v[144:147]
    s_waitcnt lgkmcnt(0)
    v_mfma_f32_16x16x32_bf16 v[108:111], v[60:63], v[32:35], v[108:111]
    v_mfma_f32_16x16x32_bf16 v[112:115], v[64:67], v[32:35], v[112:115]
    v_mfma_f32_16x16x32_bf16 v[116:119], v[68:71], v[32:35], v[116:119]
    v_mfma_f32_16x16x32_bf16 v[120:123], v[72:75], v[32:35], v[120:123]
    v_mfma_f32_16x16x32_bf16 v[124:127], v[76:79], v[32:35], v[124:127]
    v_mfma_f32_16x16x32_bf16 v[128:131], v[60:63], v[36:39], v[128:131]
    v_mfma_f32_16x16x32_bf16 v[132:135], v[64:67], v[36:39], v[132:135]
    v_mfma_f32_16x16x32_bf16 v[136:139], v[68:71], v[36:39], v[136:139]
    v_mfma_f32_16x16x32_bf16 v[140:143], v[72:75], v[36:39], v[140:143]
    v_mfma_f32_16x16x32_bf16 v[144:147], v[76:79], v[36:39], v[144:147]
    s_nop 7
    s_nop 7
    s_barrier
    v_lshlrev_b32 v4, 4, v1
    s_mul_i32 s57, s40, 5120
    s_add_u32 s57, s57, 0
    v_add_u32 v5, s57, v4
    s_xor_b32 s57, s40, 2
    s_mul_i32 s57, s57, 5120
    s_add_u32 s57, s57, 0
    v_add_u32 v6, s57, v4
    s_cmp_eq_u32 s46, 0
    s_cbranch_scc0 l2_kernel_2
    ds_write_b128 v5, v[128:131] offset:0
    ds_write_b128 v5, v[132:135] offset:1024
    ds_write_b128 v5, v[136:139] offset:2048
    ds_write_b128 v5, v[140:143] offset:3072
    ds_write_b128 v5, v[144:147] offset:4096
    s_waitcnt lgkmcnt(0)
    s_barrier
    ds_read_b128 v[40:43], v6 offset:0
    ds_read_b128 v[44:47], v6 offset:1024
    ds_read_b128 v[48:51], v6 offset:2048
    ds_read_b128 v[52:55], v6 offset:3072
    ds_read_b128 v[56:59], v6 offset:4096
    s_waitcnt lgkmcnt(0)
    v_add_f32 v108, v108, v40
    v_add_f32 v109, v109, v41
    v_add_f32 v110, v110, v42
    v_add_f32 v111, v111, v43
    v_add_f32 v112, v112, v44
    v_add_f32 v113, v113, v45
    v_add_f32 v114, v114, v46
    v_add_f32 v115, v115, v47
    v_add_f32 v116, v116, v48
    v_add_f32 v117, v117, v49
    v_add_f32 v118, v118, v50
    v_add_f32 v119, v119, v51
    v_add_f32 v120, v120, v52
    v_add_f32 v121, v121, v53
    v_add_f32 v122, v122, v54
    v_add_f32 v123, v123, v55
    v_add_f32 v124, v124, v56
    v_add_f32 v125, v125, v57
    v_add_f32 v126, v126, v58
    v_add_f32 v127, v127, v59
    s_branch l2_kernel_1
l2_kernel_2:
    ds_write_b128 v5, v[108:111] offset:0
    ds_write_b128 v5, v[112:115] offset:1024
    ds_write_b128 v5, v[116:119] offset:2048
    ds_write_b128 v5, v[120:123] offset:3072
    ds_write_b128 v5, v[124:127] offset:4096
    s_waitcnt lgkmcnt(0)
    s_barrier
    ds_read_b128 v[40:43], v6 offset:0
    ds_read_b128 v[44:47], v6 offset:1024
    ds_read_b128 v[48:51], v6 offset:2048
    ds_read_b128 v[52:55], v6 offset:3072
    ds_read_b128 v[56:59], v6 offset:4096
    s_waitcnt lgkmcnt(0)
    v_add_f32 v108, v128, v40
    v_add_f32 v109, v129, v41
    v_add_f32 v110, v130, v42
    v_add_f32 v111, v131, v43
    v_add_f32 v112, v132, v44
    v_add_f32 v113, v133, v45
    v_add_f32 v114, v134, v46
    v_add_f32 v115, v135, v47
    v_add_f32 v116, v136, v48
    v_add_f32 v117, v137, v49
    v_add_f32 v118, v138, v50
    v_add_f32 v119, v139, v51
    v_add_f32 v120, v140, v52
    v_add_f32 v121, v141, v53
    v_add_f32 v122, v142, v54
    v_add_f32 v123, v143, v55
    v_add_f32 v124, v144, v56
    v_add_f32 v125, v145, v57
    v_add_f32 v126, v146, v58
    v_add_f32 v127, v147, v59
l2_kernel_1:
    v_cvt_pk_bf16_f32 v24, v108, v109
    v_cvt_pk_bf16_f32 v25, v110, v111
    v_cvt_pk_bf16_f32 v26, v112, v113
    v_cvt_pk_bf16_f32 v27, v114, v115
    v_cvt_pk_bf16_f32 v28, v116, v117
    v_cvt_pk_bf16_f32 v29, v118, v119
    v_cvt_pk_bf16_f32 v30, v120, v121
    v_cvt_pk_bf16_f32 v31, v122, v123
    v_cvt_pk_bf16_f32 v32, v124, v125
    v_cvt_pk_bf16_f32 v33, v126, v127
    ds_write_b64 v157, v[24:25] offset:0
    ds_write_b64 v157, v[26:27] offset:32
    ds_write_b64 v157, v[28:29] offset:64
    ds_write_b64 v157, v[30:31] offset:96
    ds_write_b64 v157, v[32:33] offset:128
    s_waitcnt lgkmcnt(0)
    ds_read_b128 v[36:39], v148
    ds_read_b128 v[40:43], v149
    ds_read_b128 v[44:47], v150
    s_lshl_b32 s57, s40, 11
    s_add_u32 s57, s57, 49152
    v_lshl_add_u32 v4, v1, 3, s57
    s_waitcnt lgkmcnt(2)
    v_lshlrev_b32 v48, 16, v36
    v_and_b32 v49, 0xffff0000, v36
    v_lshlrev_b32 v50, 16, v37
    v_and_b32 v51, 0xffff0000, v37
    v_lshlrev_b32 v52, 16, v38
    v_and_b32 v53, 0xffff0000, v38
    v_lshlrev_b32 v54, 16, v39
    v_and_b32 v55, 0xffff0000, v39
    v_pk_mul_f32 v[48:49], v[48:49], v[160:161]
    v_pk_mul_f32 v[50:51], v[50:51], v[162:163]
    v_pk_mul_f32 v[52:53], v[52:53], v[164:165]
    v_pk_mul_f32 v[54:55], v[54:55], v[166:167]
    v_cvt_pk_bf16_f32 v64, v48, v49
    v_cvt_pk_bf16_f32 v65, v50, v51
    v_cvt_pk_bf16_f32 v66, v52, v53
    v_cvt_pk_bf16_f32 v67, v54, v55
    v_lshlrev_b32 v48, 16, v64
    v_and_b32 v49, 0xffff0000, v64
    v_lshlrev_b32 v50, 16, v65
    v_and_b32 v51, 0xffff0000, v65
    v_lshlrev_b32 v52, 16, v66
    v_and_b32 v53, 0xffff0000, v66
    v_lshlrev_b32 v54, 16, v67
    v_and_b32 v55, 0xffff0000, v67
    v_pk_add_f32 v[48:49], v[48:49], v[184:185]
    v_pk_add_f32 v[50:51], v[50:51], v[186:187]
    v_pk_add_f32 v[52:53], v[52:53], v[188:189]
    v_pk_add_f32 v[54:55], v[54:55], v[190:191]
    v_cvt_pk_bf16_f32 v68, v48, v49
    v_cvt_pk_bf16_f32 v69, v50, v51
    v_cvt_pk_bf16_f32 v70, v52, v53
    v_cvt_pk_bf16_f32 v71, v54, v55
    buffer_store_dwordx4 v[68:71], v151, s[24:27], 0 offen
    v_lshlrev_b32 v48, 16, v68
    v_and_b32 v49, 0xffff0000, v68
    v_lshlrev_b32 v50, 16, v69
    v_and_b32 v51, 0xffff0000, v69
    v_lshlrev_b32 v52, 16, v70
    v_and_b32 v53, 0xffff0000, v70
    v_lshlrev_b32 v54, 16, v71
    v_and_b32 v55, 0xffff0000, v71
    v_pk_mul_f32 v[56:57], v[48:49], v[208:209]
    v_pk_mul_f32 v[58:59], v[50:51], v[210:211]
    v_pk_mul_f32 v[60:61], v[52:53], v[212:213]
    v_pk_mul_f32 v[62:63], v[54:55], v[214:215]
    v_cvt_pk_bf16_f32 v72, v56, v57
    v_cvt_pk_bf16_f32 v73, v58, v59
    v_cvt_pk_bf16_f32 v74, v60, v61
    v_cvt_pk_bf16_f32 v75, v62, v63
    buffer_store_dwordx4 v[72:75], v151, s[28:31], 0 offen
    v_pk_add_f32 v[56:57], v[48:49], v[50:51]
    v_pk_add_f32 v[58:59], v[52:53], v[54:55]
    v_pk_add_f32 v[56:57], v[56:57], v[58:59]
    v_add_f32 v64, v56, v57
    v_mul_f32 v66, 0x3e000000, v64
    v_mov_b32 v67, v66
    v_pk_add_f32 v[48:49], v[48:49], v[66:67] neg_lo:[0,1] neg_hi:[0,1]
    v_pk_add_f32 v[50:51], v[50:51], v[66:67] neg_lo:[0,1] neg_hi:[0,1]
    v_pk_add_f32 v[52:53], v[52:53], v[66:67] neg_lo:[0,1] neg_hi:[0,1]
    v_pk_add_f32 v[54:55], v[54:55], v[66:67] neg_lo:[0,1] neg_hi:[0,1]
    v_pk_mul_f32 v[56:57], v[48:49], v[48:49]
    v_pk_fma_f32 v[56:57], v[50:51], v[50:51], v[56:57]
    v_pk_fma_f32 v[56:57], v[52:53], v[52:53], v[56:57]
    v_pk_fma_f32 v[56:57], v[54:55], v[54:55], v[56:57]
    v_add_f32 v65, v56, v57
    ds_write_b64 v4, v[64:65] offset:0
    s_waitcnt lgkmcnt(2)
    v_lshlrev_b32 v48, 16, v40
    v_and_b32 v49, 0xffff0000, v40
    v_lshlrev_b32 v50, 16, v41
    v_and_b32 v51, 0xffff0000, v41
    v_lshlrev_b32 v52, 16, v42
    v_and_b32 v53, 0xffff0000, v42
    v_lshlrev_b32 v54, 16, v43
    v_and_b32 v55, 0xffff0000, v43
    v_pk_mul_f32 v[48:49], v[48:49], v[168:169]
    v_pk_mul_f32 v[50:51], v[50:51], v[170:171]
    v_pk_mul_f32 v[52:53], v[52:53], v[172:173]
    v_pk_mul_f32 v[54:55], v[54:55], v[174:175]
    v_cvt_pk_bf16_f32 v64, v48, v49
    v_cvt_pk_bf16_f32 v65, v50, v51
    v_cvt_pk_bf16_f32 v66, v52, v53
    v_cvt_pk_bf16_f32 v67, v54, v55
    v_lshlrev_b32 v48, 16, v64
    v_and_b32 v49, 0xffff0000, v64
    v_lshlrev_b32 v50, 16, v65
    v_and_b32 v51, 0xffff0000, v65
    v_lshlrev_b32 v52, 16, v66
    v_and_b32 v53, 0xffff0000, v66
    v_lshlrev_b32 v54, 16, v67
    v_and_b32 v55, 0xffff0000, v67
    v_pk_add_f32 v[48:49], v[48:49], v[192:193]
    v_pk_add_f32 v[50:51], v[50:51], v[194:195]
    v_pk_add_f32 v[52:53], v[52:53], v[196:197]
    v_pk_add_f32 v[54:55], v[54:55], v[198:199]
    v_cvt_pk_bf16_f32 v76, v48, v49
    v_cvt_pk_bf16_f32 v77, v50, v51
    v_cvt_pk_bf16_f32 v78, v52, v53
    v_cvt_pk_bf16_f32 v79, v54, v55
    buffer_store_dwordx4 v[76:79], v152, s[24:27], 0 offen
    v_lshlrev_b32 v48, 16, v76
    v_and_b32 v49, 0xffff0000, v76
    v_lshlrev_b32 v50, 16, v77
    v_and_b32 v51, 0xffff0000, v77
    v_lshlrev_b32 v52, 16, v78
    v_and_b32 v53, 0xffff0000, v78
    v_lshlrev_b32 v54, 16, v79
    v_and_b32 v55, 0xffff0000, v79
    v_pk_mul_f32 v[56:57], v[48:49], v[216:217]
    v_pk_mul_f32 v[58:59], v[50:51], v[218:219]
    v_pk_mul_f32 v[60:61], v[52:53], v[220:221]
    v_pk_mul_f32 v[62:63], v[54:55], v[222:223]
    v_cvt_pk_bf16_f32 v80, v56, v57
    v_cvt_pk_bf16_f32 v81, v58, v59
    v_cvt_pk_bf16_f32 v82, v60, v61
    v_cvt_pk_bf16_f32 v83, v62, v63
    buffer_store_dwordx4 v[80:83], v152, s[28:31], 0 offen
    v_pk_add_f32 v[56:57], v[48:49], v[50:51]
    v_pk_add_f32 v[58:59], v[52:53], v[54:55]
    v_pk_add_f32 v[56:57], v[56:57], v[58:59]
    v_add_f32 v64, v56, v57
    v_mul_f32 v66, 0x3e000000, v64
    v_mov_b32 v67, v66
    v_pk_add_f32 v[48:49], v[48:49], v[66:67] neg_lo:[0,1] neg_hi:[0,1]
    v_pk_add_f32 v[50:51], v[50:51], v[66:67] neg_lo:[0,1] neg_hi:[0,1]
    v_pk_add_f32 v[52:53], v[52:53], v[66:67] neg_lo:[0,1] neg_hi:[0,1]
    v_pk_add_f32 v[54:55], v[54:55], v[66:67] neg_lo:[0,1] neg_hi:[0,1]
    v_pk_mul_f32 v[56:57], v[48:49], v[48:49]
    v_pk_fma_f32 v[56:57], v[50:51], v[50:51], v[56:57]
    v_pk_fma_f32 v[56:57], v[52:53], v[52:53], v[56:57]
    v_pk_fma_f32 v[56:57], v[54:55], v[54:55], v[56:57]
    v_add_f32 v65, v56, v57
    ds_write_b64 v4, v[64:65] offset:512
    s_waitcnt lgkmcnt(2)
    v_lshlrev_b32 v48, 16, v44
    v_and_b32 v49, 0xffff0000, v44
    v_lshlrev_b32 v50, 16, v45
    v_and_b32 v51, 0xffff0000, v45
    v_lshlrev_b32 v52, 16, v46
    v_and_b32 v53, 0xffff0000, v46
    v_lshlrev_b32 v54, 16, v47
    v_and_b32 v55, 0xffff0000, v47
    v_pk_mul_f32 v[48:49], v[48:49], v[176:177]
    v_pk_mul_f32 v[50:51], v[50:51], v[178:179]
    v_pk_mul_f32 v[52:53], v[52:53], v[180:181]
    v_pk_mul_f32 v[54:55], v[54:55], v[182:183]
    v_cvt_pk_bf16_f32 v64, v48, v49
    v_cvt_pk_bf16_f32 v65, v50, v51
    v_cvt_pk_bf16_f32 v66, v52, v53
    v_cvt_pk_bf16_f32 v67, v54, v55
    v_lshlrev_b32 v48, 16, v64
    v_and_b32 v49, 0xffff0000, v64
    v_lshlrev_b32 v50, 16, v65
    v_and_b32 v51, 0xffff0000, v65
    v_lshlrev_b32 v52, 16, v66
    v_and_b32 v53, 0xffff0000, v66
    v_lshlrev_b32 v54, 16, v67
    v_and_b32 v55, 0xffff0000, v67
    v_pk_add_f32 v[48:49], v[48:49], v[200:201]
    v_pk_add_f32 v[50:51], v[50:51], v[202:203]
    v_pk_add_f32 v[52:53], v[52:53], v[204:205]
    v_pk_add_f32 v[54:55], v[54:55], v[206:207]
    v_cvt_pk_bf16_f32 v84, v48, v49
    v_cvt_pk_bf16_f32 v85, v50, v51
    v_cvt_pk_bf16_f32 v86, v52, v53
    v_cvt_pk_bf16_f32 v87, v54, v55
    buffer_store_dwordx4 v[84:87], v153, s[24:27], 0 offen
    v_lshlrev_b32 v48, 16, v84
    v_and_b32 v49, 0xffff0000, v84
    v_lshlrev_b32 v50, 16, v85
    v_and_b32 v51, 0xffff0000, v85
    v_lshlrev_b32 v52, 16, v86
    v_and_b32 v53, 0xffff0000, v86
    v_lshlrev_b32 v54, 16, v87
    v_and_b32 v55, 0xffff0000, v87
    v_pk_mul_f32 v[56:57], v[48:49], v[224:225]
    v_pk_mul_f32 v[58:59], v[50:51], v[226:227]
    v_pk_mul_f32 v[60:61], v[52:53], v[228:229]
    v_pk_mul_f32 v[62:63], v[54:55], v[230:231]
    v_cvt_pk_bf16_f32 v88, v56, v57
    v_cvt_pk_bf16_f32 v89, v58, v59
    v_cvt_pk_bf16_f32 v90, v60, v61
    v_cvt_pk_bf16_f32 v91, v62, v63
    buffer_store_dwordx4 v[88:91], v153, s[28:31], 0 offen
    v_pk_add_f32 v[56:57], v[48:49], v[50:51]
    v_pk_add_f32 v[58:59], v[52:53], v[54:55]
    v_pk_add_f32 v[56:57], v[56:57], v[58:59]
    v_add_f32 v64, v56, v57
    v_mul_f32 v66, 0x3e000000, v64
    v_mov_b32 v67, v66
    v_pk_add_f32 v[48:49], v[48:49], v[66:67] neg_lo:[0,1] neg_hi:[0,1]
    v_pk_add_f32 v[50:51], v[50:51], v[66:67] neg_lo:[0,1] neg_hi:[0,1]
    v_pk_add_f32 v[52:53], v[52:53], v[66:67] neg_lo:[0,1] neg_hi:[0,1]
    v_pk_add_f32 v[54:55], v[54:55], v[66:67] neg_lo:[0,1] neg_hi:[0,1]
    v_pk_mul_f32 v[56:57], v[48:49], v[48:49]
    v_pk_fma_f32 v[56:57], v[50:51], v[50:51], v[56:57]
    v_pk_fma_f32 v[56:57], v[52:53], v[52:53], v[56:57]
    v_pk_fma_f32 v[56:57], v[54:55], v[54:55], v[56:57]
    v_add_f32 v65, v56, v57
    ds_write_b64 v4, v[64:65] offset:1024
    s_waitcnt lgkmcnt(0)
    v_mul_u32_u24 v5, 80, v2
    v_add_u32 v5, s57, v5
    ds_read_b128 v[24:27], v5 offset:0
    ds_read_b128 v[28:31], v5 offset:16
    ds_read_b128 v[32:35], v5 offset:32
    ds_read_b128 v[36:39], v5 offset:48
    ds_read_b128 v[40:43], v5 offset:64
    s_waitcnt lgkmcnt(0)
    v_add_f32 v44, v24, v26
    v_add_f32 v45, v25, v27
    v_add_f32 v44, v44, v28
    v_add_f32 v45, v45, v29
    v_add_f32 v44, v44, v30
    v_add_f32 v45, v45, v31
    v_add_f32 v44, v44, v32
    v_add_f32 v45, v45, v33
    v_add_f32 v44, v44, v34
    v_add_f32 v45, v45, v35
    v_add_f32 v44, v44, v36
    v_add_f32 v45, v45, v37
    v_add_f32 v44, v44, v38
    v_add_f32 v45, v45, v39
    v_add_f32 v44, v44, v40
    v_add_f32 v45, v45, v41
    v_add_f32 v44, v44, v42
    v_add_f32 v45, v45, v43
    v_mul_f32 v46, 0x3c4ccccd, v44
    v_mov_b32 v48, 0
    v_mul_f32 v47, 0x3e000000, v24
    v_sub_f32 v47, v47, v46
    v_fmac_f32 v48, v47, v47
    v_mul_f32 v47, 0x3e000000, v26
    v_sub_f32 v47, v47, v46
    v_fmac_f32 v48, v47, v47
    v_mul_f32 v47, 0x3e000000, v28
    v_sub_f32 v47, v47, v46
    v_fmac_f32 v48, v47, v47
    v_mul_f32 v47, 0x3e000000, v30
    v_sub_f32 v47, v47, v46
    v_fmac_f32 v48, v47, v47
    v_mul_f32 v47, 0x3e000000, v32
    v_sub_f32 v47, v47, v46
    v_fmac_f32 v48, v47, v47
    v_mul_f32 v47, 0x3e000000, v34
    v_sub_f32 v47, v47, v46
    v_fmac_f32 v48, v47, v47
    v_mul_f32 v47, 0x3e000000, v36
    v_sub_f32 v47, v47, v46
    v_fmac_f32 v48, v47, v47
    v_mul_f32 v47, 0x3e000000, v38
    v_sub_f32 v47, v47, v46
    v_fmac_f32 v48, v47, v47
    v_mul_f32 v47, 0x3e000000, v40
    v_sub_f32 v47, v47, v46
    v_fmac_f32 v48, v47, v47
    v_mul_f32 v47, 0x3e000000, v42
    v_sub_f32 v47, v47, v46
    v_fmac_f32 v48, v47, v47
    v_mov_b32 v47, 0x41000000
    v_fmac_f32 v45, v47, v48
    v_add_u32 v5, s38, v2
    v_lshlrev_b32 v5, 6, v5
    s_lshl_b32 s57, s42, 3
    v_add_u32 v5, s57, v5
    v_cmp_gt_u32 vcc, 16, v1
    v_mov_b32 v47, 0x7ffffff0
    s_nop 1
    v_cndmask_b32 v5, v47, v5, vcc
    s_add_u32 s60, s4, 0x1e00000
    s_addc_u32 s61, s5, 0
    s_mov_b32 s62, 0x20000
    s_mov_b32 s63, 0x00020000
    buffer_store_dwordx2 v[44:45], v5, s[60:63], 0 offen
l2_kernel_end:
    s_endpgm
l2_kernel_prod:
    s_sub_u32 s50, s40, 4
    v_lshrrev_b32 v10, 3, v1
    v_and_b32 v11, 7, v1
    s_and_b32 s51, s50, 1
    s_lshl_b32 s51, s51, 2
    v_lshrrev_b32 v12, 1, v10
    v_add_u32 v12, s51, v12
    v_xor_b32 v12, v11, v12
    v_lshlrev_b32 v12, 4, v12
    v_mul_u32_u24 v14, 2560, v10
    v_add_u32 v14, v14, v12
    v_mul_u32_u24 v15, 2560, v10
    v_add_u32 v15, v15, v12
    s_lshl_b32 s54, s50, 10
    s_mul_i32 s52, s50, 8
    s_add_u32 s53, s52, s47
    s_mul_i32 s53, s53, 2560
    s_add_u32 s56, s52, s44
    s_mul_i32 s56, s56, 2560
    s_cmp_ge_u32 s50, 2
    s_mov_b32 s57, 163840
    s_cselect_b32 s64, 4294927616, s57
    s_add_u32 s64, s64, s56
    s_waitcnt lgkmcnt(0)
    s_add_u32 s8, s4, 0x800000
    s_addc_u32 s9, s5, 0
    s_mov_b32 s10, 0x500000
    s_mov_b32 s11, 0x00020000
    s_add_u32 s12, s4, 0x1b00000
    s_addc_u32 s13, s5, 0
    s_mov_b32 s14, 0x190000
    s_mov_b32 s15, 0x00020000
    s_add_u32 m0, s54, 0
    s_add_u32 s55, s53, 0
    buffer_load_dwordx4 v14, s[8:11], s55 offen lds
    s_add_u32 m0, s54, 4096
    s_add_u32 s55, s53, 81920
    buffer_load_dwordx4 v14, s[8:11], s55 offen lds
    s_add_u32 m0, s54, 8192
    s_add_u32 s55, s53, 1280
    buffer_load_dwordx4 v14, s[8:11], s55 offen lds
    s_add_u32 m0, s54, 12288
    s_add_u32 s55, s53, 83200
    buffer_load_dwordx4 v14, s[8:11], s55 offen lds
    s_add_u32 m0, s54, 16384
    s_add_u32 s55, s56, 0
    buffer_load_dwordx4 v15, s[12:15], s55 offen lds
    s_add_u32 m0, s54, 20480
    s_add_u32 s55, s56, 81920
    buffer_load_dwordx4 v15, s[12:15], s55 offen lds
    s_add_u32 m0, s54, 24576
    s_add_u32 s55, s64, 0
    buffer_load_dwordx4 v15, s[12:15], s55 offen lds
    s_add_u32 m0, s54, 28672
    s_add_u32 s55, s56, 42240
    buffer_load_dwordx4 v15, s[12:15], s55 offen lds
    s_add_u32 m0, s54, 32768
    s_add_u32 s55, s56, 124160
    buffer_load_dwordx4 v15, s[12:15], s55 offen lds
    s_add_u32 m0, s54, 36864
    s_add_u32 s55, s53, 128
    buffer_load_dwordx4 v14, s[8:11], s55 offen lds
    s_add_u32 m0, s54, 40960
    s_add_u32 s55, s53, 82048
    buffer_load_dwordx4 v14, s[8:11], s55 offen lds
    s_add_u32 m0, s54, 45056
    s_add_u32 s55, s53, 1408
    buffer_load_dwordx4 v14, s[8:11], s55 offen lds
    s_add_u32 m0, s54, 49152
    s_add_u32 s55, s53, 83328
    buffer_load_dwordx4 v14, s[8:11], s55 offen lds
    s_add_u32 m0, s54, 53248
    s_add_u32 s55, s56, 128
    buffer_load_dwordx4 v15, s[12:15], s55 offen lds
    s_add_u32 m0, s54, 57344
    s_add_u32 s55, s56, 82048
    buffer_load_dwordx4 v15, s[12:15], s55 offen lds
    s_add_u32 m0, s54, 61440
    s_add_u32 s55, s64, 128
    buffer_load_dwordx4 v15, s[12:15], s55 offen lds
    s_add_u32 m0, s54, 65536
    s_add_u32 s55, s56, 42368
    buffer_load_dwordx4 v15, s[12:15], s55 offen lds
    s_add_u32 m0, s54, 69632
    s_add_u32 s55, s56, 124288
    buffer_load_dwordx4 v15, s[12:15], s55 offen lds
    s_waitcnt vmcnt(9)
    s_barrier
    s_add_u32 m0, s54, 73728
    s_add_u32 s55, s53, 256
    buffer_load_dwordx4 v14, s[8:11], s55 offen lds
    s_add_u32 m0, s54, 77824
    s_add_u32 s55, s53, 82176
    buffer_load_dwordx4 v14, s[8:11], s55 offen lds
    s_add_u32 m0, s54, 81920
    s_add_u32 s55, s53, 1536
    buffer_load_dwordx4 v14, s[8:11], s55 offen lds
    s_add_u32 m0, s54, 86016
    s_add_u32 s55, s53, 83456
    buffer_load_dwordx4 v14, s[8:11], s55 offen lds
    s_add_u32 m0, s54, 90112
    s_add_u32 s55, s56, 256
    buffer_load_dwordx4 v15, s[12:15], s55 offen lds
    s_add_u32 m0, s54, 94208
    s_add_u32 s55, s56, 82176
    buffer_load_dwordx4 v15, s[12:15], s55 offen lds
    s_add_u32 m0, s54, 98304
    s_add_u32 s55, s64, 256
    buffer_load_dwordx4 v15, s[12:15], s55 offen lds
    s_add_u32 m0, s54, 102400
    s_add_u32 s55, s56, 42496
    buffer_load_dwordx4 v15, s[12:15], s55 offen lds
    s_add_u32 m0, s54, 106496
    s_add_u32 s55, s56, 124416
    buffer_load_dwordx4 v15, s[12:15], s55 offen lds
    s_add_u32 m0, s54, 110592
    s_add_u32 s55, s53, 384
    buffer_load_dwordx4 v14, s[8:11], s55 offen lds
    s_add_u32 m0, s54, 114688
    s_add_u32 s55, s53, 82304
    buffer_load_dwordx4 v14, s[8:11], s55 offen lds
    s_add_u32 m0, s54, 118784
    s_add_u32 s55, s53, 1664
    buffer_load_dwordx4 v14, s[8:11], s55 offen lds
    s_add_u32 m0, s54, 122880
    s_add_u32 s55, s53, 83584
    buffer_load_dwordx4 v14, s[8:11], s55 offen lds
    s_add_u32 m0, s54, 126976
    s_add_u32 s55, s56, 384
    buffer_load_dwordx4 v15, s[12:15], s55 offen lds
    s_add_u32 m0, s54, 131072
    s_add_u32 s55, s56, 82304
    buffer_load_dwordx4 v15, s[12:15], s55 offen lds
    s_add_u32 m0, s54, 135168
    s_add_u32 s55, s64, 384
    buffer_load_dwordx4 v15, s[12:15], s55 offen lds
    s_add_u32 m0, s54, 139264
    s_add_u32 s55, s56, 42624
    buffer_load_dwordx4 v15, s[12:15], s55 offen lds
    s_add_u32 m0, s54, 143360
    s_add_u32 s55, s56, 124544
    buffer_load_dwordx4 v15, s[12:15], s55 offen lds
    s_waitcnt vmcnt(18)
    s_barrier
    s_add_u32 m0, s54, 0
    s_add_u32 s55, s53, 512
    buffer_load_dwordx4 v14, s[8:11], s55 offen lds
    s_add_u32 m0, s54, 4096
    s_add_u32 s55, s53, 82432
    buffer_load_dwordx4 v14, s[8:11], s55 offen lds
    s_add_u32 m0, s54, 8192
    s_add_u32 s55, s53, 1792
    buffer_load_dwordx4 v14, s[8:11], s55 offen lds
    s_add_u32 m0, s54, 12288
    s_add_u32 s55, s53, 83712
    buffer_load_dwordx4 v14, s[8:11], s55 offen lds
    s_add_u32 m0, s54, 16384
    s_add_u32 s55, s56, 512
    buffer_load_dwordx4 v15, s[12:15], s55 offen lds
    s_add_u32 m0, s54, 20480
    s_add_u32 s55, s56, 82432
    buffer_load_dwordx4 v15, s[12:15], s55 offen lds
    s_add_u32 m0, s54, 24576
    s_add_u32 s55, s64, 512
    buffer_load_dwordx4 v15, s[12:15], s55 offen lds
    s_add_u32 m0, s54, 28672
    s_add_u32 s55, s56, 42752
    buffer_load_dwordx4 v15, s[12:15], s55 offen lds
    s_add_u32 m0, s54, 32768
    s_add_u32 s55, s56, 124672
    buffer_load_dwordx4 v15, s[12:15], s55 offen lds
    s_waitcnt vmcnt(18)
    s_barrier
    s_add_u32 m0, s54, 36864
    s_add_u32 s55, s53, 640
    buffer_load_dwordx4 v14, s[8:11], s55 offen lds
    s_add_u32 m0, s54, 40960
    s_add_u32 s55, s53, 82560
    buffer_load_dwordx4 v14, s[8:11], s55 offen lds
    s_add_u32 m0, s54, 45056
    s_add_u32 s55, s53, 1920
    buffer_load_dwordx4 v14, s[8:11], s55 offen lds
    s_add_u32 m0, s54, 49152
    s_add_u32 s55, s53, 83840
    buffer_load_dwordx4 v14, s[8:11], s55 offen lds
    s_add_u32 m0, s54, 53248
    s_add_u32 s55, s56, 640
    buffer_load_dwordx4 v15, s[12:15], s55 offen lds
    s_add_u32 m0, s54, 57344
    s_add_u32 s55, s56, 82560
    buffer_load_dwordx4 v15, s[12:15], s55 offen lds
    s_add_u32 m0, s54, 61440
    s_add_u32 s55, s64, 640
    buffer_load_dwordx4 v15, s[12:15], s55 offen lds
    s_add_u32 m0, s54, 65536
    s_add_u32 s55, s56, 42880
    buffer_load_dwordx4 v15, s[12:15], s55 offen lds
    s_add_u32 m0, s54, 69632
    s_add_u32 s55, s56, 124800
    buffer_load_dwordx4 v15, s[12:15], s55 offen lds
    s_waitcnt vmcnt(18)
    s_barrier
    s_add_u32 m0, s54, 73728
    s_add_u32 s55, s53, 768
    buffer_load_dwordx4 v14, s[8:11], s55 offen lds
    s_add_u32 m0, s54, 77824
    s_add_u32 s55, s53, 82688
    buffer_load_dwordx4 v14, s[8:11], s55 offen lds
    s_add_u32 m0, s54, 81920
    s_add_u32 s55, s53, 2048
    buffer_load_dwordx4 v14, s[8:11], s55 offen lds
    s_add_u32 m0, s54, 86016
    s_add_u32 s55, s53, 83968
    buffer_load_dwordx4 v14, s[8:11], s55 offen lds
    s_add_u32 m0, s54, 90112
    s_add_u32 s55, s56, 768
    buffer_load_dwordx4 v15, s[12:15], s55 offen lds
    s_add_u32 m0, s54, 94208
    s_add_u32 s55, s56, 82688
    buffer_load_dwordx4 v15, s[12:15], s55 offen lds
    s_add_u32 m0, s54, 98304
    s_add_u32 s55, s64, 768
    buffer_load_dwordx4 v15, s[12:15], s55 offen lds
    s_add_u32 m0, s54, 102400
    s_add_u32 s55, s56, 43008
    buffer_load_dwordx4 v15, s[12:15], s55 offen lds
    s_add_u32 m0, s54, 106496
    s_add_u32 s55, s56, 124928
    buffer_load_dwordx4 v15, s[12:15], s55 offen lds
    s_waitcnt vmcnt(18)
    s_barrier
    s_add_u32 m0, s54, 110592
    s_add_u32 s55, s53, 896
    buffer_load_dwordx4 v14, s[8:11], s55 offen lds
    s_add_u32 m0, s54, 114688
    s_add_u32 s55, s53, 82816
    buffer_load_dwordx4 v14, s[8:11], s55 offen lds
    s_add_u32 m0, s54, 118784
    s_add_u32 s55, s53, 2176
    buffer_load_dwordx4 v14, s[8:11], s55 offen lds
    s_add_u32 m0, s54, 122880
    s_add_u32 s55, s53, 84096
    buffer_load_dwordx4 v14, s[8:11], s55 offen lds
    s_add_u32 m0, s54, 126976
    s_add_u32 s55, s56, 896
    buffer_load_dwordx4 v15, s[12:15], s55 offen lds
    s_add_u32 m0, s54, 131072
    s_add_u32 s55, s56, 82816
    buffer_load_dwordx4 v15, s[12:15], s55 offen lds
    s_add_u32 m0, s54, 135168
    s_add_u32 s55, s64, 896
    buffer_load_dwordx4 v15, s[12:15], s55 offen lds
    s_add_u32 m0, s54, 139264
    s_add_u32 s55, s56, 43136
    buffer_load_dwordx4 v15, s[12:15], s55 offen lds
    s_add_u32 m0, s54, 143360
    s_add_u32 s55, s56, 125056
    buffer_load_dwordx4 v15, s[12:15], s55 offen lds
    s_waitcnt vmcnt(18)
    s_barrier
    s_add_u32 m0, s54, 0
    s_add_u32 s55, s53, 1024
    buffer_load_dwordx4 v14, s[8:11], s55 offen lds
    s_add_u32 m0, s54, 4096
    s_add_u32 s55, s53, 82944
    buffer_load_dwordx4 v14, s[8:11], s55 offen lds
    s_add_u32 m0, s54, 8192
    s_add_u32 s55, s53, 2304
    buffer_load_dwordx4 v14, s[8:11], s55 offen lds
    s_add_u32 m0, s54, 12288
    s_add_u32 s55, s53, 84224
    buffer_load_dwordx4 v14, s[8:11], s55 offen lds
    s_add_u32 m0, s54, 16384
    s_add_u32 s55, s56, 1024
    buffer_load_dwordx4 v15, s[12:15], s55 offen lds
    s_add_u32 m0, s54, 20480
    s_add_u32 s55, s56, 82944
    buffer_load_dwordx4 v15, s[12:15], s55 offen lds
    s_add_u32 m0, s54, 24576
    s_add_u32 s55, s64, 1024
    buffer_load_dwordx4 v15, s[12:15], s55 offen lds
    s_add_u32 m0, s54, 28672
    s_add_u32 s55, s56, 43264
    buffer_load_dwordx4 v15, s[12:15], s55 offen lds
    s_add_u32 m0, s54, 32768
    s_add_u32 s55, s56, 125184
    buffer_load_dwordx4 v15, s[12:15], s55 offen lds
    s_waitcnt vmcnt(18)
    s_barrier
    s_add_u32 m0, s54, 36864
    s_add_u32 s55, s53, 1152
    buffer_load_dwordx4 v14, s[8:11], s55 offen lds
    s_add_u32 m0, s54, 40960
    s_add_u32 s55, s53, 83072
    buffer_load_dwordx4 v14, s[8:11], s55 offen lds
    s_add_u32 m0, s54, 45056
    s_add_u32 s55, s53, 2432
    buffer_load_dwordx4 v14, s[8:11], s55 offen lds
    s_add_u32 m0, s54, 49152
    s_add_u32 s55, s53, 84352
    buffer_load_dwordx4 v14, s[8:11], s55 offen lds
    s_add_u32 m0, s54, 53248
    s_add_u32 s55, s56, 1152
    buffer_load_dwordx4 v15, s[12:15], s55 offen lds
    s_add_u32 m0, s54, 57344
    s_add_u32 s55, s56, 83072
    buffer_load_dwordx4 v15, s[12:15], s55 offen lds
    s_add_u32 m0, s54, 61440
    s_add_u32 s55, s64, 1152
    buffer_load_dwordx4 v15, s[12:15], s55 offen lds
    s_add_u32 m0, s54, 65536
    s_add_u32 s55, s56, 43392
    buffer_load_dwordx4 v15, s[12:15], s55 offen lds
    s_add_u32 m0, s54, 69632
    s_add_u32 s55, s56, 125312
    buffer_load_dwordx4 v15, s[12:15], s55 offen lds
    s_waitcnt vmcnt(18)
    s_barrier
    s_waitcnt vmcnt(9)
    s_barrier
    s_waitcnt vmcnt(0)
    s_barrier
    s_endpgm
.globl l3_kernel
.p2align 8
.type l3_kernel,@function
l3_kernel:
    s_cmp_ge_u32 s2, 256
    s_cbranch_scc1 l3_kernel_end
    s_load_dwordx2 s[4:5], s[0:1], 96
    v_lshrrev_b32 v4, 6, v0
    v_and_b32 v1, 63, v0
    v_and_b32 v2, 15, v0
    v_readfirstlane_b32 s40, v4
    v_lshrrev_b32 v3, 4, v1
    s_and_b32 s41, s2, 7
    s_lshr_b32 s42, s2, 3
    s_lshr_b32 s43, s42, 4
    s_mul_i32 s41, s41, 2
    s_add_u32 s41, s41, s43
    s_and_b32 s42, s42, 15
    s_mul_i32 s44, s42, 96
    s_mov_b32 s45, s40
    s_mov_b32 s46, 0
    s_lshl_b32 s47, s41, 7
    s_mov_b32 s39, s47
    s_cmp_ge_u32 s40, 4
    s_cbranch_scc1 l3_kernel_prod
    s_waitcnt lgkmcnt(0)
    s_add_u32 s8, s4, 0x1100000
    s_addc_u32 s9, s5, 0
    s_mov_b32 s10, 0x280000
    s_mov_b32 s11, 0x00020000
    s_add_u32 s12, s4, 0x400000
    s_addc_u32 s13, s5, 0
    s_mov_b32 s14, 0x1e0000
    s_mov_b32 s15, 0x00020000
    s_add_u32 s24, s4, 0x1400000
    s_addc_u32 s25, s5, 0
    s_mov_b32 s26, 0x600000
    s_mov_b32 s27, 0x00020000
    v_lshrrev_b32 v4, 1, v2
    v_xor_b32 v4, v3, v4
    s_mul_i32 s53, s46, 16384
    s_mul_i32 s56, s45, 4096
    s_add_u32 s53, s53, s56
    s_mul_i32 s56, s46, 12288
    s_add_u32 s56, s56, 16384
    v_xor_b32 v5, 0, v4
    v_lshlrev_b32 v5, 4, v5
    v_lshl_add_u32 v5, v2, 7, v5
    v_add_u32 v7, s53, v5
    v_add_u32 v17, s56, v5
    v_add_u32 v9, 28672, v7
    v_add_u32 v19, 28672, v17
    v_add_u32 v11, 57344, v7
    v_add_u32 v21, 57344, v17
    v_add_u32 v13, 86016, v7
    v_add_u32 v23, 86016, v17
    v_add_u32 v15, 114688, v7
    v_add_u32 v25, 114688, v17
    v_xor_b32 v5, 4, v4
    v_lshlrev_b32 v5, 4, v5
    v_lshl_add_u32 v5, v2, 7, v5
    v_add_u32 v8, s53, v5
    v_add_u32 v18, s56, v5
    v_add_u32 v10, 28672, v8
    v_add_u32 v20, 28672, v18
    v_add_u32 v12, 57344, v8
    v_add_u32 v22, 57344, v18
    v_add_u32 v14, 86016, v8
    v_add_u32 v24, 86016, v18
    v_add_u32 v16, 114688, v8
    v_add_u32 v26, 114688, v18
    v_mov_b32 v112, 0
    v_mov_b32 v113, 0
    v_mov_b32 v114, 0
    v_mov_b32 v115, 0
    v_mov_b32 v116, 0
    v_mov_b32 v117, 0
    v_mov_b32 v118, 0
    v_mov_b32 v119, 0
    v_mov_b32 v120, 0
    v_mov_b32 v121, 0
    v_mov_b32 v122, 0
    v_mov_b32 v123, 0
    v_mov_b32 v124, 0
    v_mov_b32 v125, 0
    v_mov_b32 v126, 0
    v_mov_b32 v127, 0
    v_mov_b32 v128, 0
    v_mov_b32 v129, 0
    v_mov_b32 v130, 0
    v_mov_b32 v131, 0
    v_mov_b32 v132, 0
    v_mov_b32 v133, 0
    v_mov_b32 v134, 0
    v_mov_b32 v135, 0
    v_mov_b32 v136, 0
    v_mov_b32 v137, 0
    v_mov_b32 v138, 0
    v_mov_b32 v139, 0
    v_mov_b32 v140, 0
    v_mov_b32 v141, 0
    v_mov_b32 v142, 0
    v_mov_b32 v143, 0
    v_mov_b32 v144, 0
    v_mov_b32 v145, 0
    v_mov_b32 v146, 0
    v_mov_b32 v147, 0
    v_mov_b32 v148, 0
    v_mov_b32 v149, 0
    v_mov_b32 v150, 0
    v_mov_b32 v151, 0
    v_mov_b32 v152, 0
    v_mov_b32 v153, 0
    v_mov_b32 v154, 0
    v_mov_b32 v155, 0
    v_mov_b32 v156, 0
    v_mov_b32 v157, 0
    v_mov_b32 v158, 0
    v_mov_b32 v159, 0
    s_lshl_b32 s38, s45, 5
    s_add_u32 s38, s38, s39
    s_mul_i32 s57, s40, 6656
    s_lshl_b32 s58, s44, 1
    s_mov_b32 s59, 3072
    v_add_u32 v4, 0, v1
    v_mul_u32_u24 v5, 5462, v4
    v_lshrrev_b32 v5, 16, v5
    v_mul_u32_u24 v6, 12, v5
    v_sub_u32 v6, v4, v6
    v_lshlrev_b32 v6, 4, v6
    v_mul_u32_u24 v160, 208, v5
    v_add3_u32 v160, v160, v6, s57
    v_add_u32 v172, s58, v6
    v_add_u32 v5, s38, v5
    v_mul_lo_u32 v166, v5, s59
    v_add_u32 v166, v166, v172
    v_add_u32 v4, 64, v1
    v_mul_u32_u24 v5, 5462, v4
    v_lshrrev_b32 v5, 16, v5
    v_mul_u32_u24 v6, 12, v5
    v_sub_u32 v6, v4, v6
    v_lshlrev_b32 v6, 4, v6
    v_mul_u32_u24 v161, 208, v5
    v_add3_u32 v161, v161, v6, s57
    v_add_u32 v173, s58, v6
    v_add_u32 v5, s38, v5
    v_mul_lo_u32 v167, v5, s59
    v_add_u32 v167, v167, v173
    v_add_u32 v4, 128, v1
    v_mul_u32_u24 v5, 5462, v4
    v_lshrrev_b32 v5, 16, v5
    v_mul_u32_u24 v6, 12, v5
    v_sub_u32 v6, v4, v6
    v_lshlrev_b32 v6, 4, v6
    v_mul_u32_u24 v162, 208, v5
    v_add3_u32 v162, v162, v6, s57
    v_add_u32 v174, s58, v6
    v_add_u32 v5, s38, v5
    v_mul_lo_u32 v168, v5, s59
    v_add_u32 v168, v168, v174
    v_add_u32 v4, 192, v1
    v_mul_u32_u24 v5, 5462, v4
    v_lshrrev_b32 v5, 16, v5
    v_mul_u32_u24 v6, 12, v5
    v_sub_u32 v6, v4, v6
    v_lshlrev_b32 v6, 4, v6
    v_mul_u32_u24 v163, 208, v5
    v_add3_u32 v163, v163, v6, s57
    v_add_u32 v175, s58, v6
    v_add_u32 v5, s38, v5
    v_mul_lo_u32 v169, v5, s59
    v_add_u32 v169, v169, v175
    v_add_u32 v4, 256, v1
    v_mul_u32_u24 v5, 5462, v4
    v_lshrrev_b32 v5, 16, v5
    v_mul_u32_u24 v6, 12, v5
    v_sub_u32 v6, v4, v6
    v_lshlrev_b32 v6, 4, v6
    v_mul_u32_u24 v164, 208, v5
    v_add3_u32 v164, v164, v6, s57
    v_add_u32 v176, s58, v6
    v_add_u32 v5, s38, v5
    v_mul_lo_u32 v170, v5, s59
    v_add_u32 v170, v170, v176
    v_add_u32 v4, 320, v1
    v_mul_u32_u24 v5, 5462, v4
    v_lshrrev_b32 v5, 16, v5
    v_mul_u32_u24 v6, 12, v5
    v_sub_u32 v6, v4, v6
    v_lshlrev_b32 v6, 4, v6
    v_mul_u32_u24 v165, 208, v5
    v_add3_u32 v165, v165, v6, s57
    v_add_u32 v177, s58, v6
    v_add_u32 v5, s38, v5
    v_mul_lo_u32 v171, v5, s59
    v_add_u32 v171, v171, v177
    v_mul_u32_u24 v178, 208, v2
    v_lshl_add_u32 v178, v3, 3, v178
    v_add_u32 v178, s57, v178
    s_barrier
    ds_read_b128 v[28:31], v7 offset:0
    ds_read_b128 v[44:47], v17 offset:0
    ds_read_b128 v[48:51], v17 offset:2048
    ds_read_b128 v[52:55], v17 offset:4096
    ds_read_b128 v[56:59], v17 offset:6144
    ds_read_b128 v[60:63], v17 offset:8192
    ds_read_b128 v[64:67], v17 offset:10240
    ds_read_b128 v[32:35], v7 offset:2048
    s_waitcnt lgkmcnt(0)
    v_mfma_f32_16x16x32_bf16 v[112:115], v[44:47], v[28:31], v[112:115]
    ds_read_b128 v[36:39], v8 offset:0
    v_mfma_f32_16x16x32_bf16 v[116:119], v[48:51], v[28:31], v[116:119]
    ds_read_b128 v[68:71], v18 offset:0
    v_mfma_f32_16x16x32_bf16 v[120:123], v[52:55], v[28:31], v[120:123]
    ds_read_b128 v[72:75], v18 offset:2048
    v_mfma_f32_16x16x32_bf16 v[124:127], v[56:59], v[28:31], v[124:127]
    ds_read_b128 v[76:79], v18 offset:4096
    v_mfma_f32_16x16x32_bf16 v[128:131], v[60:63], v[28:31], v[128:131]
    ds_read_b128 v[80:83], v18 offset:6144
    v_mfma_f32_16x16x32_bf16 v[132:135], v[64:67], v[28:31], v[132:135]
    ds_read_b128 v[84:87], v18 offset:8192
    v_mfma_f32_16x16x32_bf16 v[136:139], v[44:47], v[32:35], v[136:139]
    ds_read_b128 v[88:91], v18 offset:10240
    v_mfma_f32_16x16x32_bf16 v[140:143], v[48:51], v[32:35], v[140:143]
    ds_read_b128 v[40:43], v8 offset:2048
    v_mfma_f32_16x16x32_bf16 v[144:147], v[52:55], v[32:35], v[144:147]
    v_mfma_f32_16x16x32_bf16 v[148:151], v[56:59], v[32:35], v[148:151]
    v_mfma_f32_16x16x32_bf16 v[152:155], v[60:63], v[32:35], v[152:155]
    v_mfma_f32_16x16x32_bf16 v[156:159], v[64:67], v[32:35], v[156:159]
    s_waitcnt lgkmcnt(0)
    s_barrier
    v_mfma_f32_16x16x32_bf16 v[112:115], v[68:71], v[36:39], v[112:115]
    ds_read_b128 v[28:31], v9 offset:0
    v_mfma_f32_16x16x32_bf16 v[116:119], v[72:75], v[36:39], v[116:119]
    ds_read_b128 v[44:47], v19 offset:0
    v_mfma_f32_16x16x32_bf16 v[120:123], v[76:79], v[36:39], v[120:123]
    ds_read_b128 v[48:51], v19 offset:2048
    v_mfma_f32_16x16x32_bf16 v[124:127], v[80:83], v[36:39], v[124:127]
    ds_read_b128 v[52:55], v19 offset:4096
    v_mfma_f32_16x16x32_bf16 v[128:131], v[84:87], v[36:39], v[128:131]
    ds_read_b128 v[56:59], v19 offset:6144
    v_mfma_f32_16x16x32_bf16 v[132:135], v[88:91], v[36:39], v[132:135]
    ds_read_b128 v[60:63], v19 offset:8192
    v_mfma_f32_16x16x32_bf16 v[136:139], v[68:71], v[40:43], v[136:139]
    ds_read_b128 v[64:67], v19 offset:10240
    v_mfma_f32_16x16x32_bf16 v[140:143], v[72:75], v[40:43], v[140:143]
    ds_read_b128 v[32:35], v9 offset:2048
    v_mfma_f32_16x16x32_bf16 v[144:147], v[76:79], v[40:43], v[144:147]
    v_mfma_f32_16x16x32_bf16 v[148:151], v[80:83], v[40:43], v[148:151]
    v_mfma_f32_16x16x32_bf16 v[152:155], v[84:87], v[40:43], v[152:155]
    v_mfma_f32_16x16x32_bf16 v[156:159], v[88:91], v[40:43], v[156:159]
    s_waitcnt lgkmcnt(0)
    v_mfma_f32_16x16x32_bf16 v[112:115], v[44:47], v[28:31], v[112:115]
    ds_read_b128 v[36:39], v10 offset:0
    v_mfma_f32_16x16x32_bf16 v[116:119], v[48:51], v[28:31], v[116:119]
    ds_read_b128 v[68:71], v20 offset:0
    v_mfma_f32_16x16x32_bf16 v[120:123], v[52:55], v[28:31], v[120:123]
    ds_read_b128 v[72:75], v20 offset:2048
    v_mfma_f32_16x16x32_bf16 v[124:127], v[56:59], v[28:31], v[124:127]
    ds_read_b128 v[76:79], v20 offset:4096
    v_mfma_f32_16x16x32_bf16 v[128:131], v[60:63], v[28:31], v[128:131]
    ds_read_b128 v[80:83], v20 offset:6144
    v_mfma_f32_16x16x32_bf16 v[132:135], v[64:67], v[28:31], v[132:135]
    ds_read_b128 v[84:87], v20 offset:8192
    v_mfma_f32_16x16x32_bf16 v[136:139], v[44:47], v[32:35], v[136:139]
    ds_read_b128 v[88:91], v20 offset:10240
    v_mfma_f32_16x16x32_bf16 v[140:143], v[48:51], v[32:35], v[140:143]
    ds_read_b128 v[40:43], v10 offset:2048
    v_mfma_f32_16x16x32_bf16 v[144:147], v[52:55], v[32:35], v[144:147]
    v_mfma_f32_16x16x32_bf16 v[148:151], v[56:59], v[32:35], v[148:151]
    v_mfma_f32_16x16x32_bf16 v[152:155], v[60:63], v[32:35], v[152:155]
    v_mfma_f32_16x16x32_bf16 v[156:159], v[64:67], v[32:35], v[156:159]
    s_waitcnt lgkmcnt(0)
    s_barrier
    s_waitcnt vmcnt(0)
    v_mfma_f32_16x16x32_bf16 v[112:115], v[68:71], v[36:39], v[112:115]
    ds_read_b128 v[28:31], v11 offset:0
    v_mfma_f32_16x16x32_bf16 v[116:119], v[72:75], v[36:39], v[116:119]
    ds_read_b128 v[44:47], v21 offset:0
    v_mfma_f32_16x16x32_bf16 v[120:123], v[76:79], v[36:39], v[120:123]
    ds_read_b128 v[48:51], v21 offset:2048
    v_mfma_f32_16x16x32_bf16 v[124:127], v[80:83], v[36:39], v[124:127]
    ds_read_b128 v[52:55], v21 offset:4096
    v_mfma_f32_16x16x32_bf16 v[128:131], v[84:87], v[36:39], v[128:131]
    ds_read_b128 v[56:59], v21 offset:6144
    v_mfma_f32_16x16x32_bf16 v[132:135], v[88:91], v[36:39], v[132:135]
    ds_read_b128 v[60:63], v21 offset:8192
    v_mfma_f32_16x16x32_bf16 v[136:139], v[68:71], v[40:43], v[136:139]
    ds_read_b128 v[64:67], v21 offset:10240
    v_mfma_f32_16x16x32_bf16 v[140:143], v[72:75], v[40:43], v[140:143]
    ds_read_b128 v[32:35], v11 offset:2048
    v_mfma_f32_16x16x32_bf16 v[144:147], v[76:79], v[40:43], v[144:147]
    v_mfma_f32_16x16x32_bf16 v[148:151], v[80:83], v[40:43], v[148:151]
    v_mfma_f32_16x16x32_bf16 v[152:155], v[84:87], v[40:43], v[152:155]
    v_mfma_f32_16x16x32_bf16 v[156:159], v[88:91], v[40:43], v[156:159]
    s_waitcnt lgkmcnt(0)
    v_mfma_f32_16x16x32_bf16 v[112:115], v[44:47], v[28:31], v[112:115]
    ds_read_b128 v[36:39], v12 offset:0
    v_mfma_f32_16x16x32_bf16 v[116:119], v[48:51], v[28:31], v[116:119]
    ds_read_b128 v[68:71], v22 offset:0
    v_mfma_f32_16x16x32_bf16 v[120:123], v[52:55], v[28:31], v[120:123]
    ds_read_b128 v[72:75], v22 offset:2048
    v_mfma_f32_16x16x32_bf16 v[124:127], v[56:59], v[28:31], v[124:127]
    ds_read_b128 v[76:79], v22 offset:4096
    v_mfma_f32_16x16x32_bf16 v[128:131], v[60:63], v[28:31], v[128:131]
    ds_read_b128 v[80:83], v22 offset:6144
    v_mfma_f32_16x16x32_bf16 v[132:135], v[64:67], v[28:31], v[132:135]
    ds_read_b128 v[84:87], v22 offset:8192
    v_mfma_f32_16x16x32_bf16 v[136:139], v[44:47], v[32:35], v[136:139]
    ds_read_b128 v[88:91], v22 offset:10240
    v_mfma_f32_16x16x32_bf16 v[140:143], v[48:51], v[32:35], v[140:143]
    ds_read_b128 v[40:43], v12 offset:2048
    v_mfma_f32_16x16x32_bf16 v[144:147], v[52:55], v[32:35], v[144:147]
    v_mfma_f32_16x16x32_bf16 v[148:151], v[56:59], v[32:35], v[148:151]
    v_mfma_f32_16x16x32_bf16 v[152:155], v[60:63], v[32:35], v[152:155]
    v_mfma_f32_16x16x32_bf16 v[156:159], v[64:67], v[32:35], v[156:159]
    s_waitcnt lgkmcnt(0)
    s_barrier
    v_mfma_f32_16x16x32_bf16 v[112:115], v[68:71], v[36:39], v[112:115]
    ds_read_b128 v[28:31], v13 offset:0
    v_mfma_f32_16x16x32_bf16 v[116:119], v[72:75], v[36:39], v[116:119]
    ds_read_b128 v[44:47], v23 offset:0
    v_mfma_f32_16x16x32_bf16 v[120:123], v[76:79], v[36:39], v[120:123]
    ds_read_b128 v[48:51], v23 offset:2048
    v_mfma_f32_16x16x32_bf16 v[124:127], v[80:83], v[36:39], v[124:127]
    ds_read_b128 v[52:55], v23 offset:4096
    v_mfma_f32_16x16x32_bf16 v[128:131], v[84:87], v[36:39], v[128:131]
    ds_read_b128 v[56:59], v23 offset:6144
    v_mfma_f32_16x16x32_bf16 v[132:135], v[88:91], v[36:39], v[132:135]
    ds_read_b128 v[60:63], v23 offset:8192
    v_mfma_f32_16x16x32_bf16 v[136:139], v[68:71], v[40:43], v[136:139]
    ds_read_b128 v[64:67], v23 offset:10240
    v_mfma_f32_16x16x32_bf16 v[140:143], v[72:75], v[40:43], v[140:143]
    ds_read_b128 v[32:35], v13 offset:2048
    v_mfma_f32_16x16x32_bf16 v[144:147], v[76:79], v[40:43], v[144:147]
    v_mfma_f32_16x16x32_bf16 v[148:151], v[80:83], v[40:43], v[148:151]
    v_mfma_f32_16x16x32_bf16 v[152:155], v[84:87], v[40:43], v[152:155]
    v_mfma_f32_16x16x32_bf16 v[156:159], v[88:91], v[40:43], v[156:159]
    s_waitcnt lgkmcnt(0)
    v_mfma_f32_16x16x32_bf16 v[112:115], v[44:47], v[28:31], v[112:115]
    ds_read_b128 v[36:39], v14 offset:0
    v_mfma_f32_16x16x32_bf16 v[116:119], v[48:51], v[28:31], v[116:119]
    ds_read_b128 v[68:71], v24 offset:0
    v_mfma_f32_16x16x32_bf16 v[120:123], v[52:55], v[28:31], v[120:123]
    ds_read_b128 v[72:75], v24 offset:2048
    v_mfma_f32_16x16x32_bf16 v[124:127], v[56:59], v[28:31], v[124:127]
    ds_read_b128 v[76:79], v24 offset:4096
    v_mfma_f32_16x16x32_bf16 v[128:131], v[60:63], v[28:31], v[128:131]
    ds_read_b128 v[80:83], v24 offset:6144
    v_mfma_f32_16x16x32_bf16 v[132:135], v[64:67], v[28:31], v[132:135]
    ds_read_b128 v[84:87], v24 offset:8192
    v_mfma_f32_16x16x32_bf16 v[136:139], v[44:47], v[32:35], v[136:139]
    ds_read_b128 v[88:91], v24 offset:10240
    v_mfma_f32_16x16x32_bf16 v[140:143], v[48:51], v[32:35], v[140:143]
    ds_read_b128 v[40:43], v14 offset:2048
    v_mfma_f32_16x16x32_bf16 v[144:147], v[52:55], v[32:35], v[144:147]
    v_mfma_f32_16x16x32_bf16 v[148:151], v[56:59], v[32:35], v[148:151]
    v_mfma_f32_16x16x32_bf16 v[152:155], v[60:63], v[32:35], v[152:155]
    v_mfma_f32_16x16x32_bf16 v[156:159], v[64:67], v[32:35], v[156:159]
    s_waitcnt lgkmcnt(0)
    s_barrier
    v_mfma_f32_16x16x32_bf16 v[112:115], v[68:71], v[36:39], v[112:115]
    ds_read_b128 v[28:31], v15 offset:0
    v_mfma_f32_16x16x32_bf16 v[116:119], v[72:75], v[36:39], v[116:119]
    ds_read_b128 v[44:47], v25 offset:0
    v_mfma_f32_16x16x32_bf16 v[120:123], v[76:79], v[36:39], v[120:123]
    ds_read_b128 v[48:51], v25 offset:2048
    v_mfma_f32_16x16x32_bf16 v[124:127], v[80:83], v[36:39], v[124:127]
    ds_read_b128 v[52:55], v25 offset:4096
    v_mfma_f32_16x16x32_bf16 v[128:131], v[84:87], v[36:39], v[128:131]
    ds_read_b128 v[56:59], v25 offset:6144
    v_mfma_f32_16x16x32_bf16 v[132:135], v[88:91], v[36:39], v[132:135]
    ds_read_b128 v[60:63], v25 offset:8192
    v_mfma_f32_16x16x32_bf16 v[136:139], v[68:71], v[40:43], v[136:139]
    ds_read_b128 v[64:67], v25 offset:10240
    v_mfma_f32_16x16x32_bf16 v[140:143], v[72:75], v[40:43], v[140:143]
    ds_read_b128 v[32:35], v15 offset:2048
    v_mfma_f32_16x16x32_bf16 v[144:147], v[76:79], v[40:43], v[144:147]
    v_mfma_f32_16x16x32_bf16 v[148:151], v[80:83], v[40:43], v[148:151]
    v_mfma_f32_16x16x32_bf16 v[152:155], v[84:87], v[40:43], v[152:155]
    v_mfma_f32_16x16x32_bf16 v[156:159], v[88:91], v[40:43], v[156:159]
    s_waitcnt lgkmcnt(0)
    v_mfma_f32_16x16x32_bf16 v[112:115], v[44:47], v[28:31], v[112:115]
    ds_read_b128 v[36:39], v16 offset:0
    v_mfma_f32_16x16x32_bf16 v[116:119], v[48:51], v[28:31], v[116:119]
    ds_read_b128 v[68:71], v26 offset:0
    v_mfma_f32_16x16x32_bf16 v[120:123], v[52:55], v[28:31], v[120:123]
    ds_read_b128 v[72:75], v26 offset:2048
    v_mfma_f32_16x16x32_bf16 v[124:127], v[56:59], v[28:31], v[124:127]
    ds_read_b128 v[76:79], v26 offset:4096
    v_mfma_f32_16x16x32_bf16 v[128:131], v[60:63], v[28:31], v[128:131]
    ds_read_b128 v[80:83], v26 offset:6144
    v_mfma_f32_16x16x32_bf16 v[132:135], v[64:67], v[28:31], v[132:135]
    ds_read_b128 v[84:87], v26 offset:8192
    v_mfma_f32_16x16x32_bf16 v[136:139], v[44:47], v[32:35], v[136:139]
    ds_read_b128 v[88:91], v26 offset:10240
    v_mfma_f32_16x16x32_bf16 v[140:143], v[48:51], v[32:35], v[140:143]
    ds_read_b128 v[40:43], v16 offset:2048
    v_mfma_f32_16x16x32_bf16 v[144:147], v[52:55], v[32:35], v[144:147]
    v_mfma_f32_16x16x32_bf16 v[148:151], v[56:59], v[32:35], v[148:151]
    v_mfma_f32_16x16x32_bf16 v[152:155], v[60:63], v[32:35], v[152:155]
    v_mfma_f32_16x16x32_bf16 v[156:159], v[64:67], v[32:35], v[156:159]
    s_waitcnt lgkmcnt(0)
    s_barrier
    v_mfma_f32_16x16x32_bf16 v[112:115], v[68:71], v[36:39], v[112:115]
    ds_read_b128 v[28:31], v7 offset:0
    v_mfma_f32_16x16x32_bf16 v[116:119], v[72:75], v[36:39], v[116:119]
    ds_read_b128 v[44:47], v17 offset:0
    v_mfma_f32_16x16x32_bf16 v[120:123], v[76:79], v[36:39], v[120:123]
    ds_read_b128 v[48:51], v17 offset:2048
    v_mfma_f32_16x16x32_bf16 v[124:127], v[80:83], v[36:39], v[124:127]
    ds_read_b128 v[52:55], v17 offset:4096
    v_mfma_f32_16x16x32_bf16 v[128:131], v[84:87], v[36:39], v[128:131]
    ds_read_b128 v[56:59], v17 offset:6144
    v_mfma_f32_16x16x32_bf16 v[132:135], v[88:91], v[36:39], v[132:135]
    ds_read_b128 v[60:63], v17 offset:8192
    v_mfma_f32_16x16x32_bf16 v[136:139], v[68:71], v[40:43], v[136:139]
    ds_read_b128 v[64:67], v17 offset:10240
    v_mfma_f32_16x16x32_bf16 v[140:143], v[72:75], v[40:43], v[140:143]
    ds_read_b128 v[32:35], v7 offset:2048
    v_mfma_f32_16x16x32_bf16 v[144:147], v[76:79], v[40:43], v[144:147]
    v_mfma_f32_16x16x32_bf16 v[148:151], v[80:83], v[40:43], v[148:151]
    v_mfma_f32_16x16x32_bf16 v[152:155], v[84:87], v[40:43], v[152:155]
    v_mfma_f32_16x16x32_bf16 v[156:159], v[88:91], v[40:43], v[156:159]
    s_waitcnt lgkmcnt(0)
    v_mfma_f32_16x16x32_bf16 v[112:115], v[44:47], v[28:31], v[112:115]
    ds_read_b128 v[36:39], v8 offset:0
    v_mfma_f32_16x16x32_bf16 v[116:119], v[48:51], v[28:31], v[116:119]
    ds_read_b128 v[68:71], v18 offset:0
    v_mfma_f32_16x16x32_bf16 v[120:123], v[52:55], v[28:31], v[120:123]
    ds_read_b128 v[72:75], v18 offset:2048
    v_mfma_f32_16x16x32_bf16 v[124:127], v[56:59], v[28:31], v[124:127]
    ds_read_b128 v[76:79], v18 offset:4096
    v_mfma_f32_16x16x32_bf16 v[128:131], v[60:63], v[28:31], v[128:131]
    ds_read_b128 v[80:83], v18 offset:6144
    v_mfma_f32_16x16x32_bf16 v[132:135], v[64:67], v[28:31], v[132:135]
    ds_read_b128 v[84:87], v18 offset:8192
    v_mfma_f32_16x16x32_bf16 v[136:139], v[44:47], v[32:35], v[136:139]
    ds_read_b128 v[88:91], v18 offset:10240
    v_mfma_f32_16x16x32_bf16 v[140:143], v[48:51], v[32:35], v[140:143]
    ds_read_b128 v[40:43], v8 offset:2048
    v_mfma_f32_16x16x32_bf16 v[144:147], v[52:55], v[32:35], v[144:147]
    v_mfma_f32_16x16x32_bf16 v[148:151], v[56:59], v[32:35], v[148:151]
    v_mfma_f32_16x16x32_bf16 v[152:155], v[60:63], v[32:35], v[152:155]
    v_mfma_f32_16x16x32_bf16 v[156:159], v[64:67], v[32:35], v[156:159]
    s_waitcnt lgkmcnt(0)
    s_barrier
    v_mfma_f32_16x16x32_bf16 v[112:115], v[68:71], v[36:39], v[112:115]
    ds_read_b128 v[28:31], v9 offset:0
    v_mfma_f32_16x16x32_bf16 v[116:119], v[72:75], v[36:39], v[116:119]
    ds_read_b128 v[44:47], v19 offset:0
    v_mfma_f32_16x16x32_bf16 v[120:123], v[76:79], v[36:39], v[120:123]
    ds_read_b128 v[48:51], v19 offset:2048
    v_mfma_f32_16x16x32_bf16 v[124:127], v[80:83], v[36:39], v[124:127]
    ds_read_b128 v[52:55], v19 offset:4096
    v_mfma_f32_16x16x32_bf16 v[128:131], v[84:87], v[36:39], v[128:131]
    ds_read_b128 v[56:59], v19 offset:6144
    v_mfma_f32_16x16x32_bf16 v[132:135], v[88:91], v[36:39], v[132:135]
    ds_read_b128 v[60:63], v19 offset:8192
    v_mfma_f32_16x16x32_bf16 v[136:139], v[68:71], v[40:43], v[136:139]
    ds_read_b128 v[64:67], v19 offset:10240
    v_mfma_f32_16x16x32_bf16 v[140:143], v[72:75], v[40:43], v[140:143]
    ds_read_b128 v[32:35], v9 offset:2048
    v_mfma_f32_16x16x32_bf16 v[144:147], v[76:79], v[40:43], v[144:147]
    v_mfma_f32_16x16x32_bf16 v[148:151], v[80:83], v[40:43], v[148:151]
    v_mfma_f32_16x16x32_bf16 v[152:155], v[84:87], v[40:43], v[152:155]
    v_mfma_f32_16x16x32_bf16 v[156:159], v[88:91], v[40:43], v[156:159]
    s_waitcnt lgkmcnt(0)
    v_mfma_f32_16x16x32_bf16 v[112:115], v[44:47], v[28:31], v[112:115]
    ds_read_b128 v[36:39], v10 offset:0
    v_mfma_f32_16x16x32_bf16 v[116:119], v[48:51], v[28:31], v[116:119]
    ds_read_b128 v[68:71], v20 offset:0
    v_mfma_f32_16x16x32_bf16 v[120:123], v[52:55], v[28:31], v[120:123]
    ds_read_b128 v[72:75], v20 offset:2048
    v_mfma_f32_16x16x32_bf16 v[124:127], v[56:59], v[28:31], v[124:127]
    ds_read_b128 v[76:79], v20 offset:4096
    v_mfma_f32_16x16x32_bf16 v[128:131], v[60:63], v[28:31], v[128:131]
    ds_read_b128 v[80:83], v20 offset:6144
    v_mfma_f32_16x16x32_bf16 v[132:135], v[64:67], v[28:31], v[132:135]
    ds_read_b128 v[84:87], v20 offset:8192
    v_mfma_f32_16x16x32_bf16 v[136:139], v[44:47], v[32:35], v[136:139]
    ds_read_b128 v[88:91], v20 offset:10240
    v_mfma_f32_16x16x32_bf16 v[140:143], v[48:51], v[32:35], v[140:143]
    ds_read_b128 v[40:43], v10 offset:2048
    v_mfma_f32_16x16x32_bf16 v[144:147], v[52:55], v[32:35], v[144:147]
    v_mfma_f32_16x16x32_bf16 v[148:151], v[56:59], v[32:35], v[148:151]
    v_mfma_f32_16x16x32_bf16 v[152:155], v[60:63], v[32:35], v[152:155]
    v_mfma_f32_16x16x32_bf16 v[156:159], v[64:67], v[32:35], v[156:159]
    s_waitcnt lgkmcnt(0)
    s_barrier
    v_mfma_f32_16x16x32_bf16 v[112:115], v[68:71], v[36:39], v[112:115]
    ds_read_b128 v[28:31], v11 offset:0
    v_mfma_f32_16x16x32_bf16 v[116:119], v[72:75], v[36:39], v[116:119]
    ds_read_b128 v[44:47], v21 offset:0
    v_mfma_f32_16x16x32_bf16 v[120:123], v[76:79], v[36:39], v[120:123]
    ds_read_b128 v[48:51], v21 offset:2048
    v_mfma_f32_16x16x32_bf16 v[124:127], v[80:83], v[36:39], v[124:127]
    ds_read_b128 v[52:55], v21 offset:4096
    v_mfma_f32_16x16x32_bf16 v[128:131], v[84:87], v[36:39], v[128:131]
    ds_read_b128 v[56:59], v21 offset:6144
    v_mfma_f32_16x16x32_bf16 v[132:135], v[88:91], v[36:39], v[132:135]
    ds_read_b128 v[60:63], v21 offset:8192
    v_mfma_f32_16x16x32_bf16 v[136:139], v[68:71], v[40:43], v[136:139]
    ds_read_b128 v[64:67], v21 offset:10240
    v_mfma_f32_16x16x32_bf16 v[140:143], v[72:75], v[40:43], v[140:143]
    ds_read_b128 v[32:35], v11 offset:2048
    v_mfma_f32_16x16x32_bf16 v[144:147], v[76:79], v[40:43], v[144:147]
    v_mfma_f32_16x16x32_bf16 v[148:151], v[80:83], v[40:43], v[148:151]
    v_mfma_f32_16x16x32_bf16 v[152:155], v[84:87], v[40:43], v[152:155]
    v_mfma_f32_16x16x32_bf16 v[156:159], v[88:91], v[40:43], v[156:159]
    s_waitcnt lgkmcnt(0)
    v_mfma_f32_16x16x32_bf16 v[112:115], v[44:47], v[28:31], v[112:115]
    ds_read_b128 v[36:39], v12 offset:0
    v_mfma_f32_16x16x32_bf16 v[116:119], v[48:51], v[28:31], v[116:119]
    ds_read_b128 v[68:71], v22 offset:0
    v_mfma_f32_16x16x32_bf16 v[120:123], v[52:55], v[28:31], v[120:123]
    ds_read_b128 v[72:75], v22 offset:2048
    v_mfma_f32_16x16x32_bf16 v[124:127], v[56:59], v[28:31], v[124:127]
    ds_read_b128 v[76:79], v22 offset:4096
    v_mfma_f32_16x16x32_bf16 v[128:131], v[60:63], v[28:31], v[128:131]
    ds_read_b128 v[80:83], v22 offset:6144
    v_mfma_f32_16x16x32_bf16 v[132:135], v[64:67], v[28:31], v[132:135]
    ds_read_b128 v[84:87], v22 offset:8192
    v_mfma_f32_16x16x32_bf16 v[136:139], v[44:47], v[32:35], v[136:139]
    ds_read_b128 v[88:91], v22 offset:10240
    v_mfma_f32_16x16x32_bf16 v[140:143], v[48:51], v[32:35], v[140:143]
    ds_read_b128 v[40:43], v12 offset:2048
    v_mfma_f32_16x16x32_bf16 v[144:147], v[52:55], v[32:35], v[144:147]
    v_mfma_f32_16x16x32_bf16 v[148:151], v[56:59], v[32:35], v[148:151]
    v_mfma_f32_16x16x32_bf16 v[152:155], v[60:63], v[32:35], v[152:155]
    v_mfma_f32_16x16x32_bf16 v[156:159], v[64:67], v[32:35], v[156:159]
    s_waitcnt lgkmcnt(0)
    s_barrier
    v_mfma_f32_16x16x32_bf16 v[112:115], v[68:71], v[36:39], v[112:115]
    ds_read_b128 v[28:31], v13 offset:0
    v_mfma_f32_16x16x32_bf16 v[116:119], v[72:75], v[36:39], v[116:119]
    ds_read_b128 v[44:47], v23 offset:0
    v_mfma_f32_16x16x32_bf16 v[120:123], v[76:79], v[36:39], v[120:123]
    ds_read_b128 v[48:51], v23 offset:2048
    v_mfma_f32_16x16x32_bf16 v[124:127], v[80:83], v[36:39], v[124:127]
    ds_read_b128 v[52:55], v23 offset:4096
    v_mfma_f32_16x16x32_bf16 v[128:131], v[84:87], v[36:39], v[128:131]
    ds_read_b128 v[56:59], v23 offset:6144
    v_mfma_f32_16x16x32_bf16 v[132:135], v[88:91], v[36:39], v[132:135]
    ds_read_b128 v[60:63], v23 offset:8192
    v_mfma_f32_16x16x32_bf16 v[136:139], v[68:71], v[40:43], v[136:139]
    ds_read_b128 v[64:67], v23 offset:10240
    v_mfma_f32_16x16x32_bf16 v[140:143], v[72:75], v[40:43], v[140:143]
    ds_read_b128 v[32:35], v13 offset:2048
    v_mfma_f32_16x16x32_bf16 v[144:147], v[76:79], v[40:43], v[144:147]
    v_mfma_f32_16x16x32_bf16 v[148:151], v[80:83], v[40:43], v[148:151]
    v_mfma_f32_16x16x32_bf16 v[152:155], v[84:87], v[40:43], v[152:155]
    v_mfma_f32_16x16x32_bf16 v[156:159], v[88:91], v[40:43], v[156:159]
    s_waitcnt lgkmcnt(0)
    v_mfma_f32_16x16x32_bf16 v[112:115], v[44:47], v[28:31], v[112:115]
    ds_read_b128 v[36:39], v14 offset:0
    v_mfma_f32_16x16x32_bf16 v[116:119], v[48:51], v[28:31], v[116:119]
    ds_read_b128 v[68:71], v24 offset:0
    v_mfma_f32_16x16x32_bf16 v[120:123], v[52:55], v[28:31], v[120:123]
    ds_read_b128 v[72:75], v24 offset:2048
    v_mfma_f32_16x16x32_bf16 v[124:127], v[56:59], v[28:31], v[124:127]
    ds_read_b128 v[76:79], v24 offset:4096
    v_mfma_f32_16x16x32_bf16 v[128:131], v[60:63], v[28:31], v[128:131]
    ds_read_b128 v[80:83], v24 offset:6144
    v_mfma_f32_16x16x32_bf16 v[132:135], v[64:67], v[28:31], v[132:135]
    ds_read_b128 v[84:87], v24 offset:8192
    v_mfma_f32_16x16x32_bf16 v[136:139], v[44:47], v[32:35], v[136:139]
    ds_read_b128 v[88:91], v24 offset:10240
    v_mfma_f32_16x16x32_bf16 v[140:143], v[48:51], v[32:35], v[140:143]
    ds_read_b128 v[40:43], v14 offset:2048
    v_mfma_f32_16x16x32_bf16 v[144:147], v[52:55], v[32:35], v[144:147]
    v_mfma_f32_16x16x32_bf16 v[148:151], v[56:59], v[32:35], v[148:151]
    v_mfma_f32_16x16x32_bf16 v[152:155], v[60:63], v[32:35], v[152:155]
    v_mfma_f32_16x16x32_bf16 v[156:159], v[64:67], v[32:35], v[156:159]
    s_waitcnt lgkmcnt(0)
    s_barrier
    v_mfma_f32_16x16x32_bf16 v[112:115], v[68:71], v[36:39], v[112:115]
    ds_read_b128 v[28:31], v15 offset:0
    v_mfma_f32_16x16x32_bf16 v[116:119], v[72:75], v[36:39], v[116:119]
    ds_read_b128 v[44:47], v25 offset:0
    v_mfma_f32_16x16x32_bf16 v[120:123], v[76:79], v[36:39], v[120:123]
    ds_read_b128 v[48:51], v25 offset:2048
    v_mfma_f32_16x16x32_bf16 v[124:127], v[80:83], v[36:39], v[124:127]
    ds_read_b128 v[52:55], v25 offset:4096
    v_mfma_f32_16x16x32_bf16 v[128:131], v[84:87], v[36:39], v[128:131]
    ds_read_b128 v[56:59], v25 offset:6144
    v_mfma_f32_16x16x32_bf16 v[132:135], v[88:91], v[36:39], v[132:135]
    ds_read_b128 v[60:63], v25 offset:8192
    v_mfma_f32_16x16x32_bf16 v[136:139], v[68:71], v[40:43], v[136:139]
    ds_read_b128 v[64:67], v25 offset:10240
    v_mfma_f32_16x16x32_bf16 v[140:143], v[72:75], v[40:43], v[140:143]
    ds_read_b128 v[32:35], v15 offset:2048
    v_mfma_f32_16x16x32_bf16 v[144:147], v[76:79], v[40:43], v[144:147]
    v_mfma_f32_16x16x32_bf16 v[148:151], v[80:83], v[40:43], v[148:151]
    v_mfma_f32_16x16x32_bf16 v[152:155], v[84:87], v[40:43], v[152:155]
    v_mfma_f32_16x16x32_bf16 v[156:159], v[88:91], v[40:43], v[156:159]
    s_waitcnt lgkmcnt(0)
    v_mfma_f32_16x16x32_bf16 v[112:115], v[44:47], v[28:31], v[112:115]
    ds_read_b128 v[36:39], v16 offset:0
    v_mfma_f32_16x16x32_bf16 v[116:119], v[48:51], v[28:31], v[116:119]
    ds_read_b128 v[68:71], v26 offset:0
    v_mfma_f32_16x16x32_bf16 v[120:123], v[52:55], v[28:31], v[120:123]
    ds_read_b128 v[72:75], v26 offset:2048
    v_mfma_f32_16x16x32_bf16 v[124:127], v[56:59], v[28:31], v[124:127]
    ds_read_b128 v[76:79], v26 offset:4096
    v_mfma_f32_16x16x32_bf16 v[128:131], v[60:63], v[28:31], v[128:131]
    ds_read_b128 v[80:83], v26 offset:6144
    v_mfma_f32_16x16x32_bf16 v[132:135], v[64:67], v[28:31], v[132:135]
    ds_read_b128 v[84:87], v26 offset:8192
    v_mfma_f32_16x16x32_bf16 v[136:139], v[44:47], v[32:35], v[136:139]
    ds_read_b128 v[88:91], v26 offset:10240
    v_mfma_f32_16x16x32_bf16 v[140:143], v[48:51], v[32:35], v[140:143]
    ds_read_b128 v[40:43], v16 offset:2048
    v_mfma_f32_16x16x32_bf16 v[144:147], v[52:55], v[32:35], v[144:147]
    v_mfma_f32_16x16x32_bf16 v[148:151], v[56:59], v[32:35], v[148:151]
    v_mfma_f32_16x16x32_bf16 v[152:155], v[60:63], v[32:35], v[152:155]
    v_mfma_f32_16x16x32_bf16 v[156:159], v[64:67], v[32:35], v[156:159]
    s_waitcnt lgkmcnt(0)
    v_mfma_f32_16x16x32_bf16 v[112:115], v[68:71], v[36:39], v[112:115]
    v_mfma_f32_16x16x32_bf16 v[116:119], v[72:75], v[36:39], v[116:119]
    v_mfma_f32_16x16x32_bf16 v[120:123], v[76:79], v[36:39], v[120:123]
    v_mfma_f32_16x16x32_bf16 v[124:127], v[80:83], v[36:39], v[124:127]
    v_mfma_f32_16x16x32_bf16 v[128:131], v[84:87], v[36:39], v[128:131]
    v_mfma_f32_16x16x32_bf16 v[132:135], v[88:91], v[36:39], v[132:135]
    v_mfma_f32_16x16x32_bf16 v[136:139], v[68:71], v[40:43], v[136:139]
    v_mfma_f32_16x16x32_bf16 v[140:143], v[72:75], v[40:43], v[140:143]
    v_mfma_f32_16x16x32_bf16 v[144:147], v[76:79], v[40:43], v[144:147]
    v_mfma_f32_16x16x32_bf16 v[148:151], v[80:83], v[40:43], v[148:151]
    v_mfma_f32_16x16x32_bf16 v[152:155], v[84:87], v[40:43], v[152:155]
    v_mfma_f32_16x16x32_bf16 v[156:159], v[88:91], v[40:43], v[156:159]
    s_nop 7
    s_nop 7
    s_barrier
    s_lshl_b32 s57, s45, 8
    s_add_u32 s57, s57, 143360
    v_lshl_add_u32 v4, v2, 3, s57
    v_lshlrev_b32 v5, 4, v3
    v_add_u32 v5, 144384, v5
    ds_read_b64 v[92:93], v4
    ds_read_b64 v[94:95], v4 offset:128
    ds_read_b128 v[28:31], v5 offset:0
    ds_read_b128 v[52:55], v5 offset:1024
    ds_read_b128 v[32:35], v5 offset:64
    ds_read_b128 v[56:59], v5 offset:1088
    ds_read_b128 v[36:39], v5 offset:128
    ds_read_b128 v[60:63], v5 offset:1152
    ds_read_b128 v[40:43], v5 offset:192
    ds_read_b128 v[64:67], v5 offset:1216
    ds_read_b128 v[44:47], v5 offset:256
    ds_read_b128 v[68:71], v5 offset:1280
    ds_read_b128 v[48:51], v5 offset:320
    ds_read_b128 v[72:75], v5 offset:1344
    s_waitcnt lgkmcnt(0)
    v_fma_f32 v112, -v93, v28, v112
    v_fma_f32 v112, v92, v112, v52
    v_max_f32 v112, 0, v112
    v_fma_f32 v113, -v93, v29, v113
    v_fma_f32 v113, v92, v113, v53
    v_max_f32 v113, 0, v113
    v_fma_f32 v114, -v93, v30, v114
    v_fma_f32 v114, v92, v114, v54
    v_max_f32 v114, 0, v114
    v_fma_f32 v115, -v93, v31, v115
    v_fma_f32 v115, v92, v115, v55
    v_max_f32 v115, 0, v115
    v_fma_f32 v116, -v93, v32, v116
    v_fma_f32 v116, v92, v116, v56
    v_max_f32 v116, 0, v116
    v_fma_f32 v117, -v93, v33, v117
    v_fma_f32 v117, v92, v117, v57
    v_max_f32 v117, 0, v117
    v_fma_f32 v118, -v93, v34, v118
    v_fma_f32 v118, v92, v118, v58
    v_max_f32 v118, 0, v118
    v_fma_f32 v119, -v93, v35, v119
    v_fma_f32 v119, v92, v119, v59
    v_max_f32 v119, 0, v119
    v_fma_f32 v120, -v93, v36, v120
    v_fma_f32 v120, v92, v120, v60
    v_max_f32 v120, 0, v120
    v_fma_f32 v121, -v93, v37, v121
    v_fma_f32 v121, v92, v121, v61
    v_max_f32 v121, 0, v121
    v_fma_f32 v122, -v93, v38, v122
    v_fma_f32 v122, v92, v122, v62
    v_max_f32 v122, 0, v122
    v_fma_f32 v123, -v93, v39, v123
    v_fma_f32 v123, v92, v123, v63
    v_max_f32 v123, 0, v123
    v_fma_f32 v124, -v93, v40, v124
    v_fma_f32 v124, v92, v124, v64
    v_max_f32 v124, 0, v124
    v_fma_f32 v125, -v93, v41, v125
    v_fma_f32 v125, v92, v125, v65
    v_max_f32 v125, 0, v125
    v_fma_f32 v126, -v93, v42, v126
    v_fma_f32 v126, v92, v126, v66
    v_max_f32 v126, 0, v126
    v_fma_f32 v127, -v93, v43, v127
    v_fma_f32 v127, v92, v127, v67
    v_max_f32 v127, 0, v127
    v_fma_f32 v128, -v93, v44, v128
    v_fma_f32 v128, v92, v128, v68
    v_max_f32 v128, 0, v128
    v_fma_f32 v129, -v93, v45, v129
    v_fma_f32 v129, v92, v129, v69
    v_max_f32 v129, 0, v129
    v_fma_f32 v130, -v93, v46, v130
    v_fma_f32 v130, v92, v130, v70
    v_max_f32 v130, 0, v130
    v_fma_f32 v131, -v93, v47, v131
    v_fma_f32 v131, v92, v131, v71
    v_max_f32 v131, 0, v131
    v_fma_f32 v132, -v93, v48, v132
    v_fma_f32 v132, v92, v132, v72
    v_max_f32 v132, 0, v132
    v_fma_f32 v133, -v93, v49, v133
    v_fma_f32 v133, v92, v133, v73
    v_max_f32 v133, 0, v133
    v_fma_f32 v134, -v93, v50, v134
    v_fma_f32 v134, v92, v134, v74
    v_max_f32 v134, 0, v134
    v_fma_f32 v135, -v93, v51, v135
    v_fma_f32 v135, v92, v135, v75
    v_max_f32 v135, 0, v135
    v_cvt_pk_bf16_f32 v76, v112, v113
    v_cvt_pk_bf16_f32 v77, v114, v115
    v_cvt_pk_bf16_f32 v78, v116, v117
    v_cvt_pk_bf16_f32 v79, v118, v119
    v_cvt_pk_bf16_f32 v80, v120, v121
    v_cvt_pk_bf16_f32 v81, v122, v123
    v_cvt_pk_bf16_f32 v82, v124, v125
    v_cvt_pk_bf16_f32 v83, v126, v127
    v_cvt_pk_bf16_f32 v84, v128, v129
    v_cvt_pk_bf16_f32 v85, v130, v131
    v_cvt_pk_bf16_f32 v86, v132, v133
    v_cvt_pk_bf16_f32 v87, v134, v135
    ds_write_b64 v178, v[76:77] offset:0
    ds_write_b64 v178, v[78:79] offset:32
    ds_write_b64 v178, v[80:81] offset:64
    ds_write_b64 v178, v[82:83] offset:96
    ds_write_b64 v178, v[84:85] offset:128
    ds_write_b64 v178, v[86:87] offset:160
    v_fma_f32 v136, -v95, v28, v136
    v_fma_f32 v136, v94, v136, v52
    v_max_f32 v136, 0, v136
    v_fma_f32 v137, -v95, v29, v137
    v_fma_f32 v137, v94, v137, v53
    v_max_f32 v137, 0, v137
    v_fma_f32 v138, -v95, v30, v138
    v_fma_f32 v138, v94, v138, v54
    v_max_f32 v138, 0, v138
    v_fma_f32 v139, -v95, v31, v139
    v_fma_f32 v139, v94, v139, v55
    v_max_f32 v139, 0, v139
    v_fma_f32 v140, -v95, v32, v140
    v_fma_f32 v140, v94, v140, v56
    v_max_f32 v140, 0, v140
    v_fma_f32 v141, -v95, v33, v141
    v_fma_f32 v141, v94, v141, v57
    v_max_f32 v141, 0, v141
    v_fma_f32 v142, -v95, v34, v142
    v_fma_f32 v142, v94, v142, v58
    v_max_f32 v142, 0, v142
    v_fma_f32 v143, -v95, v35, v143
    v_fma_f32 v143, v94, v143, v59
    v_max_f32 v143, 0, v143
    v_fma_f32 v144, -v95, v36, v144
    v_fma_f32 v144, v94, v144, v60
    v_max_f32 v144, 0, v144
    v_fma_f32 v145, -v95, v37, v145
    v_fma_f32 v145, v94, v145, v61
    v_max_f32 v145, 0, v145
    v_fma_f32 v146, -v95, v38, v146
    v_fma_f32 v146, v94, v146, v62
    v_max_f32 v146, 0, v146
    v_fma_f32 v147, -v95, v39, v147
    v_fma_f32 v147, v94, v147, v63
    v_max_f32 v147, 0, v147
    v_fma_f32 v148, -v95, v40, v148
    v_fma_f32 v148, v94, v148, v64
    v_max_f32 v148, 0, v148
    v_fma_f32 v149, -v95, v41, v149
    v_fma_f32 v149, v94, v149, v65
    v_max_f32 v149, 0, v149
    v_fma_f32 v150, -v95, v42, v150
    v_fma_f32 v150, v94, v150, v66
    v_max_f32 v150, 0, v150
    v_fma_f32 v151, -v95, v43, v151
    v_fma_f32 v151, v94, v151, v67
    v_max_f32 v151, 0, v151
    v_fma_f32 v152, -v95, v44, v152
    v_fma_f32 v152, v94, v152, v68
    v_max_f32 v152, 0, v152
    v_fma_f32 v153, -v95, v45, v153
    v_fma_f32 v153, v94, v153, v69
    v_max_f32 v153, 0, v153
    v_fma_f32 v154, -v95, v46, v154
    v_fma_f32 v154, v94, v154, v70
    v_max_f32 v154, 0, v154
    v_fma_f32 v155, -v95, v47, v155
    v_fma_f32 v155, v94, v155, v71
    v_max_f32 v155, 0, v155
    v_fma_f32 v156, -v95, v48, v156
    v_fma_f32 v156, v94, v156, v72
    v_max_f32 v156, 0, v156
    v_fma_f32 v157, -v95, v49, v157
    v_fma_f32 v157, v94, v157, v73
    v_max_f32 v157, 0, v157
    v_fma_f32 v158, -v95, v50, v158
    v_fma_f32 v158, v94, v158, v74
    v_max_f32 v158, 0, v158
    v_fma_f32 v159, -v95, v51, v159
    v_fma_f32 v159, v94, v159, v75
    v_max_f32 v159, 0, v159
    v_cvt_pk_bf16_f32 v96, v136, v137
    v_cvt_pk_bf16_f32 v97, v138, v139
    v_cvt_pk_bf16_f32 v98, v140, v141
    v_cvt_pk_bf16_f32 v99, v142, v143
    v_cvt_pk_bf16_f32 v100, v144, v145
    v_cvt_pk_bf16_f32 v101, v146, v147
    v_cvt_pk_bf16_f32 v102, v148, v149
    v_cvt_pk_bf16_f32 v103, v150, v151
    v_cvt_pk_bf16_f32 v104, v152, v153
    v_cvt_pk_bf16_f32 v105, v154, v155
    v_cvt_pk_bf16_f32 v106, v156, v157
    v_cvt_pk_bf16_f32 v107, v158, v159
    ds_write_b64 v178, v[96:97] offset:3328
    ds_write_b64 v178, v[98:99] offset:3360
    ds_write_b64 v178, v[100:101] offset:3392
    ds_write_b64 v178, v[102:103] offset:3424
    ds_write_b64 v178, v[104:105] offset:3456
    ds_write_b64 v178, v[106:107] offset:3488
    s_waitcnt lgkmcnt(0)
    ds_read_b128 v[28:31], v160
    ds_read_b128 v[32:35], v161
    ds_read_b128 v[36:39], v162
    ds_read_b128 v[40:43], v163
    ds_read_b128 v[44:47], v164
    ds_read_b128 v[48:51], v165
    s_waitcnt lgkmcnt(5)
    buffer_store_dwordx4 v[28:31], v166, s[24:27], 0 offen
    s_waitcnt lgkmcnt(4)
    buffer_store_dwordx4 v[32:35], v167, s[24:27], 0 offen
    s_waitcnt lgkmcnt(3)
    buffer_store_dwordx4 v[36:39], v168, s[24:27], 0 offen
    s_waitcnt lgkmcnt(2)
    buffer_store_dwordx4 v[40:43], v169, s[24:27], 0 offen
    s_waitcnt lgkmcnt(1)
    buffer_store_dwordx4 v[44:47], v170, s[24:27], 0 offen
    s_waitcnt lgkmcnt(0)
    buffer_store_dwordx4 v[48:51], v171, s[24:27], 0 offen
l3_kernel_end:
    s_endpgm
l3_kernel_prod:
    s_sub_u32 s50, s40, 4
    v_lshrrev_b32 v10, 3, v1
    v_and_b32 v11, 7, v1
    s_and_b32 s51, s50, 1
    s_lshl_b32 s51, s51, 2
    v_lshrrev_b32 v12, 1, v10
    v_add_u32 v12, s51, v12
    v_xor_b32 v12, v11, v12
    v_lshlrev_b32 v12, 4, v12
    v_mul_u32_u24 v14, 1280, v10
    v_add_u32 v14, v14, v12
    v_mul_u32_u24 v15, 1280, v10
    v_add_u32 v15, v15, v12
    s_lshl_b32 s54, s50, 10
    s_mul_i32 s52, s50, 8
    s_add_u32 s53, s52, s47
    s_mul_i32 s53, s53, 1280
    s_add_u32 s56, s52, s44
    s_mul_i32 s56, s56, 1280
    s_waitcnt lgkmcnt(0)
    s_add_u32 s8, s4, 0x1100000
    s_addc_u32 s9, s5, 0
    s_mov_b32 s10, 0x280000
    s_mov_b32 s11, 0x00020000
    s_add_u32 s12, s4, 0x400000
    s_addc_u32 s13, s5, 0
    s_mov_b32 s14, 0x1e0000
    s_mov_b32 s15, 0x00020000
    s_add_u32 m0, s54, 0
    s_add_u32 s55, s53, 0
    buffer_load_dwordx4 v14, s[8:11], s55 offen lds
    s_add_u32 m0, s54, 4096
    s_add_u32 s55, s53, 40960
    buffer_load_dwordx4 v14, s[8:11], s55 offen lds
    s_add_u32 m0, s54, 8192
    s_add_u32 s55, s53, 81920
    buffer_load_dwordx4 v14, s[8:11], s55 offen lds
    s_add_u32 m0, s54, 12288
    s_add_u32 s55, s53, 122880
    buffer_load_dwordx4 v14, s[8:11], s55 offen lds
    s_add_u32 m0, s54, 16384
    s_add_u32 s55, s56, 0
    buffer_load_dwordx4 v15, s[12:15], s55 offen lds
    s_add_u32 m0, s54, 20480
    s_add_u32 s55, s56, 40960
    buffer_load_dwordx4 v15, s[12:15], s55 offen lds
    s_add_u32 m0, s54, 24576
    s_add_u32 s55, s56, 81920
    buffer_load_dwordx4 v15, s[12:15], s55 offen lds
    s_add_u32 m0, s54, 28672
    s_add_u32 s55, s53, 128
    buffer_load_dwordx4 v14, s[8:11], s55 offen lds
    s_add_u32 m0, s54, 32768
    s_add_u32 s55, s53, 41088
    buffer_load_dwordx4 v14, s[8:11], s55 offen lds
    s_add_u32 m0, s54, 36864
    s_add_u32 s55, s53, 82048
    buffer_load_dwordx4 v14, s[8:11], s55 offen lds
    s_add_u32 m0, s54, 40960
    s_add_u32 s55, s53, 123008
    buffer_load_dwordx4 v14, s[8:11], s55 offen lds
    s_add_u32 m0, s54, 45056
    s_add_u32 s55, s56, 128
    buffer_load_dwordx4 v15, s[12:15], s55 offen lds
    s_add_u32 m0, s54, 49152
    s_add_u32 s55, s56, 41088
    buffer_load_dwordx4 v15, s[12:15], s55 offen lds
    s_add_u32 m0, s54, 53248
    s_add_u32 s55, s56, 82048
    buffer_load_dwordx4 v15, s[12:15], s55 offen lds
    s_waitcnt vmcnt(7)
    s_barrier
    s_add_u32 m0, s54, 57344
    s_add_u32 s55, s53, 256
    buffer_load_dwordx4 v14, s[8:11], s55 offen lds
    s_add_u32 m0, s54, 61440
    s_add_u32 s55, s53, 41216
    buffer_load_dwordx4 v14, s[8:11], s55 offen lds
    s_add_u32 m0, s54, 65536
    s_add_u32 s55, s53, 82176
    buffer_load_dwordx4 v14, s[8:11], s55 offen lds
    s_add_u32 m0, s54, 69632
    s_add_u32 s55, s53, 123136
    buffer_load_dwordx4 v14, s[8:11], s55 offen lds
    s_add_u32 m0, s54, 73728
    s_add_u32 s55, s56, 256
    buffer_load_dwordx4 v15, s[12:15], s55 offen lds
    s_add_u32 m0, s54, 77824
    s_add_u32 s55, s56, 41216
    buffer_load_dwordx4 v15, s[12:15], s55 offen lds
    s_add_u32 m0, s54, 81920
    s_add_u32 s55, s56, 82176
    buffer_load_dwordx4 v15, s[12:15], s55 offen lds
    s_add_u32 m0, s54, 86016
    s_add_u32 s55, s53, 384
    buffer_load_dwordx4 v14, s[8:11], s55 offen lds
    s_add_u32 m0, s54, 90112
    s_add_u32 s55, s53, 41344
    buffer_load_dwordx4 v14, s[8:11], s55 offen lds
    s_add_u32 m0, s54, 94208
    s_add_u32 s55, s53, 82304
    buffer_load_dwordx4 v14, s[8:11], s55 offen lds
    s_add_u32 m0, s54, 98304
    s_add_u32 s55, s53, 123264
    buffer_load_dwordx4 v14, s[8:11], s55 offen lds
    s_add_u32 m0, s54, 102400
    s_add_u32 s55, s56, 384
    buffer_load_dwordx4 v15, s[12:15], s55 offen lds
    s_add_u32 m0, s54, 106496
    s_add_u32 s55, s56, 41344
    buffer_load_dwordx4 v15, s[12:15], s55 offen lds
    s_add_u32 m0, s54, 110592
    s_add_u32 s55, s56, 82304
    buffer_load_dwordx4 v15, s[12:15], s55 offen lds
    s_add_u32 s24, s4, 0x1400000
    s_addc_u32 s25, s5, 0
    s_mov_b32 s26, 0x600000
    s_mov_b32 s27, 0x00020000
    s_add_u32 s72, s4, 0x1e00000
    s_addc_u32 s73, s5, 0
    s_mov_b32 s74, 0x20000
    s_mov_b32 s75, 0x00020000
    s_add_u32 s76, s4, 0x1f00000
    s_addc_u32 s77, s5, 0
    s_mov_b32 s78, 0x3000
    s_mov_b32 s79, 0x00020000
    s_lshl_b32 s80, s50, 5
    s_add_u32 s80, s80, s47
    v_and_b32 v20, 31, v1
    v_add_u32 v20, s80, v20
    v_lshlrev_b32 v20, 6, v20
    buffer_load_dwordx4 v[24:27], v20, s[72:75], 0 offen offset:0
    buffer_load_dwordx4 v[28:31], v20, s[72:75], 0 offen offset:16
    buffer_load_dwordx4 v[32:35], v20, s[72:75], 0 offen offset:32
    buffer_load_dwordx4 v[36:39], v20, s[72:75], 0 offen offset:48
    s_lshl_b32 s81, s44, 2
    v_lshl_add_u32 v21, v1, 4, s81
    s_mov_b32 s82, 6144
    buffer_load_dwordx4 v[48:51], v21, s[76:79], 0 offen
    buffer_load_dwordx4 v[52:55], v21, s[76:79], s82 offen
    s_waitcnt vmcnt(20)
    s_barrier
    s_add_u32 m0, s54, 114688
    s_add_u32 s55, s53, 512
    buffer_load_dwordx4 v14, s[8:11], s55 offen lds
    s_add_u32 m0, s54, 118784
    s_add_u32 s55, s53, 41472
    buffer_load_dwordx4 v14, s[8:11], s55 offen lds
    s_add_u32 m0, s54, 122880
    s_add_u32 s55, s53, 82432
    buffer_load_dwordx4 v14, s[8:11], s55 offen lds
    s_add_u32 m0, s54, 126976
    s_add_u32 s55, s53, 123392
    buffer_load_dwordx4 v14, s[8:11], s55 offen lds
    s_add_u32 m0, s54, 131072
    s_add_u32 s55, s56, 512
    buffer_load_dwordx4 v15, s[12:15], s55 offen lds
    s_add_u32 m0, s54, 135168
    s_add_u32 s55, s56, 41472
    buffer_load_dwordx4 v15, s[12:15], s55 offen lds
    s_add_u32 m0, s54, 139264
    s_add_u32 s55, s56, 82432
    buffer_load_dwordx4 v15, s[12:15], s55 offen lds
    s_add_u32 m0, s54, 0
    s_add_u32 s55, s53, 640
    buffer_load_dwordx4 v14, s[8:11], s55 offen lds
    s_add_u32 m0, s54, 4096
    s_add_u32 s55, s53, 41600
    buffer_load_dwordx4 v14, s[8:11], s55 offen lds
    s_add_u32 m0, s54, 8192
    s_add_u32 s55, s53, 82560
    buffer_load_dwordx4 v14, s[8:11], s55 offen lds
    s_add_u32 m0, s54, 12288
    s_add_u32 s55, s53, 123520
    buffer_load_dwordx4 v14, s[8:11], s55 offen lds
    s_add_u32 m0, s54, 16384
    s_add_u32 s55, s56, 640
    buffer_load_dwordx4 v15, s[12:15], s55 offen lds
    s_add_u32 m0, s54, 20480
    s_add_u32 s55, s56, 41600
    buffer_load_dwordx4 v15, s[12:15], s55 offen lds
    s_add_u32 m0, s54, 24576
    s_add_u32 s55, s56, 82560
    buffer_load_dwordx4 v15, s[12:15], s55 offen lds
    s_waitcnt vmcnt(27)
    s_barrier
    s_add_u32 m0, s54, 28672
    s_add_u32 s55, s53, 768
    buffer_load_dwordx4 v14, s[8:11], s55 offen lds
    s_add_u32 m0, s54, 32768
    s_add_u32 s55, s53, 41728
    buffer_load_dwordx4 v14, s[8:11], s55 offen lds
    s_add_u32 m0, s54, 36864
    s_add_u32 s55, s53, 82688
    buffer_load_dwordx4 v14, s[8:11], s55 offen lds
    s_add_u32 m0, s54, 40960
    s_add_u32 s55, s53, 123648
    buffer_load_dwordx4 v14, s[8:11], s55 offen lds
    s_add_u32 m0, s54, 45056
    s_add_u32 s55, s56, 768
    buffer_load_dwordx4 v15, s[12:15], s55 offen lds
    s_add_u32 m0, s54, 49152
    s_add_u32 s55, s56, 41728
    buffer_load_dwordx4 v15, s[12:15], s55 offen lds
    s_add_u32 m0, s54, 53248
    s_add_u32 s55, s56, 82688
    buffer_load_dwordx4 v15, s[12:15], s55 offen lds
    s_waitcnt vmcnt(27)
    s_barrier
    s_add_u32 m0, s54, 57344
    s_add_u32 s55, s53, 896
    buffer_load_dwordx4 v14, s[8:11], s55 offen lds
    s_add_u32 m0, s54, 61440
    s_add_u32 s55, s53, 41856
    buffer_load_dwordx4 v14, s[8:11], s55 offen lds
    s_add_u32 m0, s54, 65536
    s_add_u32 s55, s53, 82816
    buffer_load_dwordx4 v14, s[8:11], s55 offen lds
    s_add_u32 m0, s54, 69632
    s_add_u32 s55, s53, 123776
    buffer_load_dwordx4 v14, s[8:11], s55 offen lds
    s_add_u32 m0, s54, 73728
    s_add_u32 s55, s56, 896
    buffer_load_dwordx4 v15, s[12:15], s55 offen lds
    s_add_u32 m0, s54, 77824
    s_add_u32 s55, s56, 41856
    buffer_load_dwordx4 v15, s[12:15], s55 offen lds
    s_add_u32 m0, s54, 81920
    s_add_u32 s55, s56, 82816
    buffer_load_dwordx4 v15, s[12:15], s55 offen lds
    s_waitcnt vmcnt(21)
    s_barrier
    s_add_u32 m0, s54, 86016
    s_add_u32 s55, s53, 1024
    buffer_load_dwordx4 v14, s[8:11], s55 offen lds
    s_add_u32 m0, s54, 90112
    s_add_u32 s55, s53, 41984
    buffer_load_dwordx4 v14, s[8:11], s55 offen lds
    s_add_u32 m0, s54, 94208
    s_add_u32 s55, s53, 82944
    buffer_load_dwordx4 v14, s[8:11], s55 offen lds
    s_add_u32 m0, s54, 98304
    s_add_u32 s55, s53, 123904
    buffer_load_dwordx4 v14, s[8:11], s55 offen lds
    s_add_u32 m0, s54, 102400
    s_add_u32 s55, s56, 1024
    buffer_load_dwordx4 v15, s[12:15], s55 offen lds
    s_add_u32 m0, s54, 106496
    s_add_u32 s55, s56, 41984
    buffer_load_dwordx4 v15, s[12:15], s55 offen lds
    s_add_u32 m0, s54, 110592
    s_add_u32 s55, s56, 82944
    buffer_load_dwordx4 v15, s[12:15], s55 offen lds
    s_waitcnt vmcnt(21)
    s_barrier
    s_add_u32 m0, s54, 114688
    s_add_u32 s55, s53, 1152
    buffer_load_dwordx4 v14, s[8:11], s55 offen lds
    s_add_u32 m0, s54, 118784
    s_add_u32 s55, s53, 42112
    buffer_load_dwordx4 v14, s[8:11], s55 offen lds
    s_add_u32 m0, s54, 122880
    s_add_u32 s55, s53, 83072
    buffer_load_dwordx4 v14, s[8:11], s55 offen lds
    s_add_u32 m0, s54, 126976
    s_add_u32 s55, s53, 124032
    buffer_load_dwordx4 v14, s[8:11], s55 offen lds
    s_add_u32 m0, s54, 131072
    s_add_u32 s55, s56, 1152
    buffer_load_dwordx4 v15, s[12:15], s55 offen lds
    s_add_u32 m0, s54, 135168
    s_add_u32 s55, s56, 42112
    buffer_load_dwordx4 v15, s[12:15], s55 offen lds
    s_add_u32 m0, s54, 139264
    s_add_u32 s55, s56, 83072
    buffer_load_dwordx4 v15, s[12:15], s55 offen lds
    v_add_f32 v60, v24, v26
    v_add_f32 v61, v25, v27
    v_add_f32 v60, v60, v28
    v_add_f32 v61, v61, v29
    v_add_f32 v60, v60, v30
    v_add_f32 v61, v61, v31
    v_add_f32 v60, v60, v32
    v_add_f32 v61, v61, v33
    v_add_f32 v60, v60, v34
    v_add_f32 v61, v61, v35
    v_add_f32 v60, v60, v36
    v_add_f32 v61, v61, v37
    v_add_f32 v60, v60, v38
    v_add_f32 v61, v61, v39
    v_mul_f32 v62, 0x3acccccd, v60
    v_mov_b32 v64, 0
    v_mul_f32 v63, 0x3c4ccccd, v24
    v_sub_f32 v63, v63, v62
    v_fmac_f32 v64, v63, v63
    v_mul_f32 v63, 0x3c4ccccd, v26
    s_waitcnt vmcnt(21)
    s_barrier
    v_sub_f32 v63, v63, v62
    v_fmac_f32 v64, v63, v63
    v_mul_f32 v63, 0x3c4ccccd, v28
    v_sub_f32 v63, v63, v62
    v_fmac_f32 v64, v63, v63
    v_mul_f32 v63, 0x3c4ccccd, v30
    v_sub_f32 v63, v63, v62
    v_fmac_f32 v64, v63, v63
    v_mul_f32 v63, 0x3c4ccccd, v32
    v_sub_f32 v63, v63, v62
    v_fmac_f32 v64, v63, v63
    v_mul_f32 v63, 0x3c4ccccd, v34
    v_sub_f32 v63, v63, v62
    v_fmac_f32 v64, v63, v63
    v_mul_f32 v63, 0x3c4ccccd, v36
    v_sub_f32 v63, v63, v62
    v_fmac_f32 v64, v63, v63
    v_mul_f32 v63, 0x3c4ccccd, v38
    v_sub_f32 v63, v63, v62
    v_fmac_f32 v64, v63, v63
    s_waitcnt vmcnt(14)
    s_barrier
    v_mov_b32 v63, 0x42a00000
    v_fmac_f32 v61, v63, v64
    v_mul_f32 v61, 0x3acccccd, v61
    v_cvt_pk_bf16_f32 v63, v62, v61
    v_lshlrev_b32 v67, 16, v63
    v_and_b32 v61, 0xffff0000, v63
    v_add_f32 v61, 0x3727c5ac, v61
    v_cvt_pk_bf16_f32 v61, v61, v61
    v_lshlrev_b32 v61, 16, v61
    v_sqrt_f32 v61, v61
    s_nop 0
    v_cvt_pk_bf16_f32 v61, v61, v61
    v_lshlrev_b32 v61, 16, v61
    v_rcp_f32 v66, v61
    s_nop 0
    s_lshl_b32 s83, s50, 8
    s_add_u32 s83, s83, 143360
    v_and_b32 v20, 31, v1
    v_lshl_add_u32 v20, v20, 3, s83
    ds_write_b64 v20, v[66:67]
    s_waitcnt vmcnt(7)
    s_barrier
    v_lshlrev_b32 v21, 4, v1
    v_add_u32 v21, 144384, v21
    ds_write_b128 v21, v[48:51]
    ds_write_b128 v21, v[52:55] offset:1024
    s_waitcnt vmcnt(0)
    s_barrier
    s_waitcnt lgkmcnt(0)
    s_barrier
    s_endpgm
.globl l4_kernel
.p2align 8
.type l4_kernel,@function
l4_kernel:
    s_cmp_ge_u32 s2, 256
    s_cbranch_scc1 l4_kernel_end
    s_load_dwordx2 s[4:5], s[0:1], 96
    s_load_dwordx2 s[30:31], s[0:1], 80
    v_lshrrev_b32 v4, 6, v0
    v_and_b32 v1, 63, v0
    v_and_b32 v2, 15, v0
    v_readfirstlane_b32 s40, v4
    v_lshrrev_b32 v3, 4, v1
    s_and_b32 s41, s2, 7
    s_lshr_b32 s42, s2, 3
    s_lshr_b32 s43, s42, 3
    s_mul_i32 s41, s41, 4
    s_add_u32 s41, s41, s43
    s_and_b32 s42, s42, 7
    s_mul_i32 s44, s42, 80
    s_and_b32 s45, s40, 1
    s_lshr_b32 s46, s40, 1
    s_lshl_b32 s47, s41, 6
    s_mov_b32 s39, s47
    s_cmp_ge_u32 s40, 4
    s_cbranch_scc1 l4_kernel_prod
    s_waitcnt lgkmcnt(0)
    s_add_u32 s8, s4, 0x1400000
    s_addc_u32 s9, s5, 0
    s_mov_b32 s10, 0x600000
    s_mov_b32 s11, 0x00020000
    s_add_u32 s12, s4, 0x600000
    s_addc_u32 s13, s5, 0
    s_mov_b32 s14, 0x1e0000
    s_mov_b32 s15, 0x00020000
    s_mov_b32 s20, s4
    s_mov_b32 s21, s5
    s_mov_b32 s22, 0x1e00
    s_mov_b32 s23, 0x00020000
    s_mov_b32 s24, s30
    s_mov_b32 s25, s31
    s_mov_b32 s26, 0x280000
    s_mov_b32 s27, 0x00020000
    s_add_u32 s16, s4, 0xe00000
    s_addc_u32 s17, s5, 0
    s_mov_b32 s18, 0x280000
    s_mov_b32 s19, 0x00020000
    v_lshrrev_b32 v4, 1, v2
    v_xor_b32 v4, v3, v4
    s_mul_i32 s53, s46, 8192
    s_mul_i32 s56, s45, 4096
    s_add_u32 s53, s53, s56
    s_mul_i32 s56, s46, 10240
    s_add_u32 s56, s56, 16384
    v_xor_b32 v5, 0, v4
    v_lshlrev_b32 v5, 4, v5
    v_lshl_add_u32 v5, v2, 7, v5
    v_add_u32 v7, s53, v5
    v_add_u32 v15, s56, v5
    v_add_u32 v9, 36864, v7
    v_add_u32 v17, 36864, v15
    v_add_u32 v11, 73728, v7
    v_add_u32 v19, 73728, v15
    v_add_u32 v13, 110592, v7
    v_add_u32 v21, 110592, v15
    v_xor_b32 v5, 4, v4
    v_lshlrev_b32 v5, 4, v5
    v_lshl_add_u32 v5, v2, 7, v5
    v_add_u32 v8, s53, v5
    v_add_u32 v16, s56, v5
    v_add_u32 v10, 36864, v8
    v_add_u32 v18, 36864, v16
    v_add_u32 v12, 73728, v8
    v_add_u32 v20, 73728, v16
    v_add_u32 v14, 110592, v8
    v_add_u32 v22, 110592, v16
    v_mov_b32 v108, 0
    v_mov_b32 v109, 0
    v_mov_b32 v110, 0
    v_mov_b32 v111, 0
    v_mov_b32 v112, 0
    v_mov_b32 v113, 0
    v_mov_b32 v114, 0
    v_mov_b32 v115, 0
    v_mov_b32 v116, 0
    v_mov_b32 v117, 0
    v_mov_b32 v118, 0
    v_mov_b32 v119, 0
    v_mov_b32 v120, 0
    v_mov_b32 v121, 0
    v_mov_b32 v122, 0
    v_mov_b32 v123, 0
    v_mov_b32 v124, 0
    v_mov_b32 v125, 0
    v_mov_b32 v126, 0
    v_mov_b32 v127, 0
    v_mov_b32 v128, 0
    v_mov_b32 v129, 0
    v_mov_b32 v130, 0
    v_mov_b32 v131, 0
    v_mov_b32 v132, 0
    v_mov_b32 v133, 0
    v_mov_b32 v134, 0
    v_mov_b32 v135, 0
    v_mov_b32 v136, 0
    v_mov_b32 v137, 0
    v_mov_b32 v138, 0
    v_mov_b32 v139, 0
    v_mov_b32 v140, 0
    v_mov_b32 v141, 0
    v_mov_b32 v142, 0
    v_mov_b32 v143, 0
    v_mov_b32 v144, 0
    v_mov_b32 v145, 0
    v_mov_b32 v146, 0
    v_mov_b32 v147, 0
    s_lshl_b32 s38, s45, 5
    s_add_u32 s38, s38, s39
    s_lshl_b32 s37, s46, 4
    s_add_u32 s38, s38, s37
    s_mul_i32 s57, s40, 2816
    s_add_u32 s57, s57, 32768
    s_lshl_b32 s58, s44, 1
    s_mov_b32 s59, 1280
    v_add_u32 v4, 0, v1
    v_mul_u32_u24 v5, 6554, v4
    v_lshrrev_b32 v5, 16, v5
    v_mul_u32_u24 v6, 10, v5
    v_sub_u32 v6, v4, v6
    v_lshlrev_b32 v6, 4, v6
    v_mul_u32_u24 v148, 176, v5
    v_add3_u32 v148, v148, v6, s57
    v_add_u32 v154, s58, v6
    v_add_u32 v5, s38, v5
    v_mul_lo_u32 v151, v5, s59
    v_add_u32 v151, v151, v154
    v_add_u32 v4, 64, v1
    v_mul_u32_u24 v5, 6554, v4
    v_lshrrev_b32 v5, 16, v5
    v_mul_u32_u24 v6, 10, v5
    v_sub_u32 v6, v4, v6
    v_lshlrev_b32 v6, 4, v6
    v_mul_u32_u24 v149, 176, v5
    v_add3_u32 v149, v149, v6, s57
    v_add_u32 v155, s58, v6
    v_add_u32 v5, s38, v5
    v_mul_lo_u32 v152, v5, s59
    v_add_u32 v152, v152, v155
    v_add_u32 v4, 128, v1
    v_mul_u32_u24 v5, 6554, v4
    v_lshrrev_b32 v5, 16, v5
    v_mul_u32_u24 v6, 10, v5
    v_sub_u32 v6, v4, v6
    v_lshlrev_b32 v6, 4, v6
    v_mul_u32_u24 v150, 176, v5
    v_add3_u32 v150, v150, v6, s57
    v_add_u32 v156, s58, v6
    v_add_u32 v5, s38, v5
    v_mul_lo_u32 v153, v5, s59
    v_add_u32 v153, v153, v156
    v_cmp_gt_u32 vcc, 160, v4
    v_mov_b32 v5, 0x7ffffff0
    s_nop 1
    v_cndmask_b32 v153, v5, v153, vcc
    v_cndmask_b32 v150, 0, v150, vcc
    v_mul_u32_u24 v157, 176, v2
    v_lshl_add_u32 v157, v3, 3, v157
    v_add_u32 v157, s57, v157
    s_mov_b32 s61, 6400
    buffer_load_dwordx4 v[172:175], v154, s[20:23], s61 offen
    buffer_load_dwordx4 v[176:179], v155, s[20:23], s61 offen
    buffer_load_dwordx4 v[180:183], v156, s[20:23], s61 offen
    buffer_load_dwordx4 v[196:199], v151, s[16:19], 0 offen
    buffer_load_dwordx4 v[200:203], v152, s[16:19], 0 offen
    buffer_load_dwordx4 v[204:207], v153, s[16:19], 0 offen
    s_barrier
    ds_read_b128 v[24:27], v7 offset:0
    ds_read_b128 v[40:43], v15 offset:0
    ds_read_b128 v[44:47], v15 offset:2048
    ds_read_b128 v[48:51], v15 offset:4096
    ds_read_b128 v[52:55], v15 offset:6144
    ds_read_b128 v[56:59], v15 offset:8192
    ds_read_b128 v[28:31], v7 offset:2048
    s_waitcnt lgkmcnt(0)
    v_mfma_f32_16x16x32_bf16 v[108:111], v[40:43], v[24:27], v[108:111]
    ds_read_b128 v[32:35], v8 offset:0
    v_mfma_f32_16x16x32_bf16 v[112:115], v[44:47], v[24:27], v[112:115]
    ds_read_b128 v[60:63], v16 offset:0
    v_mfma_f32_16x16x32_bf16 v[116:119], v[48:51], v[24:27], v[116:119]
    ds_read_b128 v[64:67], v16 offset:2048
    v_mfma_f32_16x16x32_bf16 v[120:123], v[52:55], v[24:27], v[120:123]
    ds_read_b128 v[68:71], v16 offset:4096
    v_mfma_f32_16x16x32_bf16 v[124:127], v[56:59], v[24:27], v[124:127]
    ds_read_b128 v[72:75], v16 offset:6144
    v_mfma_f32_16x16x32_bf16 v[128:131], v[40:43], v[28:31], v[128:131]
    ds_read_b128 v[76:79], v16 offset:8192
    v_mfma_f32_16x16x32_bf16 v[132:135], v[44:47], v[28:31], v[132:135]
    ds_read_b128 v[36:39], v8 offset:2048
    v_mfma_f32_16x16x32_bf16 v[136:139], v[48:51], v[28:31], v[136:139]
    v_mfma_f32_16x16x32_bf16 v[140:143], v[52:55], v[28:31], v[140:143]
    v_mfma_f32_16x16x32_bf16 v[144:147], v[56:59], v[28:31], v[144:147]
    s_waitcnt lgkmcnt(0)
    s_barrier
    v_mfma_f32_16x16x32_bf16 v[108:111], v[60:63], v[32:35], v[108:111]
    ds_read_b128 v[24:27], v9 offset:0
    v_mfma_f32_16x16x32_bf16 v[112:115], v[64:67], v[32:35], v[112:115]
    ds_read_b128 v[40:43], v17 offset:0
    v_mfma_f32_16x16x32_bf16 v[116:119], v[68:71], v[32:35], v[116:119]
    ds_read_b128 v[44:47], v17 offset:2048
    v_mfma_f32_16x16x32_bf16 v[120:123], v[72:75], v[32:35], v[120:123]
    ds_read_b128 v[48:51], v17 offset:4096
    v_mfma_f32_16x16x32_bf16 v[124:127], v[76:79], v[32:35], v[124:127]
    ds_read_b128 v[52:55], v17 offset:6144
    v_mfma_f32_16x16x32_bf16 v[128:131], v[60:63], v[36:39], v[128:131]
    ds_read_b128 v[56:59], v17 offset:8192
    v_mfma_f32_16x16x32_bf16 v[132:135], v[64:67], v[36:39], v[132:135]
    ds_read_b128 v[28:31], v9 offset:2048
    v_mfma_f32_16x16x32_bf16 v[136:139], v[68:71], v[36:39], v[136:139]
    v_mfma_f32_16x16x32_bf16 v[140:143], v[72:75], v[36:39], v[140:143]
    v_mfma_f32_16x16x32_bf16 v[144:147], v[76:79], v[36:39], v[144:147]
    s_waitcnt lgkmcnt(0)
    v_mfma_f32_16x16x32_bf16 v[108:111], v[40:43], v[24:27], v[108:111]
    ds_read_b128 v[32:35], v10 offset:0
    v_mfma_f32_16x16x32_bf16 v[112:115], v[44:47], v[24:27], v[112:115]
    ds_read_b128 v[60:63], v18 offset:0
    v_mfma_f32_16x16x32_bf16 v[116:119], v[48:51], v[24:27], v[116:119]
    ds_read_b128 v[64:67], v18 offset:2048
    v_mfma_f32_16x16x32_bf16 v[120:123], v[52:55], v[24:27], v[120:123]
    ds_read_b128 v[68:71], v18 offset:4096
    v_mfma_f32_16x16x32_bf16 v[124:127], v[56:59], v[24:27], v[124:127]
    ds_read_b128 v[72:75], v18 offset:6144
    v_mfma_f32_16x16x32_bf16 v[128:131], v[40:43], v[28:31], v[128:131]
    ds_read_b128 v[76:79], v18 offset:8192
    v_mfma_f32_16x16x32_bf16 v[132:135], v[44:47], v[28:31], v[132:135]
    ds_read_b128 v[36:39], v10 offset:2048
    v_mfma_f32_16x16x32_bf16 v[136:139], v[48:51], v[28:31], v[136:139]
    v_mfma_f32_16x16x32_bf16 v[140:143], v[52:55], v[28:31], v[140:143]
    v_mfma_f32_16x16x32_bf16 v[144:147], v[56:59], v[28:31], v[144:147]
    s_waitcnt lgkmcnt(0)
    s_barrier
    s_waitcnt vmcnt(0)
    v_mfma_f32_16x16x32_bf16 v[108:111], v[60:63], v[32:35], v[108:111]
    ds_read_b128 v[24:27], v11 offset:0
    v_mfma_f32_16x16x32_bf16 v[112:115], v[64:67], v[32:35], v[112:115]
    ds_read_b128 v[40:43], v19 offset:0
    v_mfma_f32_16x16x32_bf16 v[116:119], v[68:71], v[32:35], v[116:119]
    ds_read_b128 v[44:47], v19 offset:2048
    v_mfma_f32_16x16x32_bf16 v[120:123], v[72:75], v[32:35], v[120:123]
    ds_read_b128 v[48:51], v19 offset:4096
    v_mfma_f32_16x16x32_bf16 v[124:127], v[76:79], v[32:35], v[124:127]
    ds_read_b128 v[52:55], v19 offset:6144
    v_mfma_f32_16x16x32_bf16 v[128:131], v[60:63], v[36:39], v[128:131]
    ds_read_b128 v[56:59], v19 offset:8192
    v_mfma_f32_16x16x32_bf16 v[132:135], v[64:67], v[36:39], v[132:135]
    ds_read_b128 v[28:31], v11 offset:2048
    v_mfma_f32_16x16x32_bf16 v[136:139], v[68:71], v[36:39], v[136:139]
    v_lshlrev_b32 v160, 16, v172
    v_and_b32 v161, 0xffff0000, v172
    v_lshlrev_b32 v162, 16, v173
    v_mfma_f32_16x16x32_bf16 v[140:143], v[72:75], v[36:39], v[140:143]
    v_and_b32 v163, 0xffff0000, v173
    v_lshlrev_b32 v164, 16, v174
    v_and_b32 v165, 0xffff0000, v174
    v_mfma_f32_16x16x32_bf16 v[144:147], v[76:79], v[36:39], v[144:147]
    v_lshlrev_b32 v166, 16, v175
    v_and_b32 v167, 0xffff0000, v175
    v_lshlrev_b32 v168, 16, v176
    s_waitcnt lgkmcnt(0)
    v_mfma_f32_16x16x32_bf16 v[108:111], v[40:43], v[24:27], v[108:111]
    ds_read_b128 v[32:35], v12 offset:0
    v_mfma_f32_16x16x32_bf16 v[112:115], v[44:47], v[24:27], v[112:115]
    ds_read_b128 v[60:63], v20 offset:0
    v_mfma_f32_16x16x32_bf16 v[116:119], v[48:51], v[24:27], v[116:119]
    ds_read_b128 v[64:67], v20 offset:2048
    v_mfma_f32_16x16x32_bf16 v[120:123], v[52:55], v[24:27], v[120:123]
    ds_read_b128 v[68:71], v20 offset:4096
    v_mfma_f32_16x16x32_bf16 v[124:127], v[56:59], v[24:27], v[124:127]
    ds_read_b128 v[72:75], v20 offset:6144
    v_mfma_f32_16x16x32_bf16 v[128:131], v[40:43], v[28:31], v[128:131]
    ds_read_b128 v[76:79], v20 offset:8192
    v_mfma_f32_16x16x32_bf16 v[132:135], v[44:47], v[28:31], v[132:135]
    ds_read_b128 v[36:39], v12 offset:2048
    v_mfma_f32_16x16x32_bf16 v[136:139], v[48:51], v[28:31], v[136:139]
    v_and_b32 v169, 0xffff0000, v176
    v_lshlrev_b32 v170, 16, v177
    v_and_b32 v171, 0xffff0000, v177
    v_mfma_f32_16x16x32_bf16 v[140:143], v[52:55], v[28:31], v[140:143]
    v_lshlrev_b32 v172, 16, v178
    v_and_b32 v173, 0xffff0000, v178
    v_lshlrev_b32 v174, 16, v179
    v_mfma_f32_16x16x32_bf16 v[144:147], v[56:59], v[28:31], v[144:147]
    v_and_b32 v175, 0xffff0000, v179
    v_lshlrev_b32 v176, 16, v180
    v_and_b32 v177, 0xffff0000, v180
    s_waitcnt lgkmcnt(0)
    s_barrier
    v_mfma_f32_16x16x32_bf16 v[108:111], v[60:63], v[32:35], v[108:111]
    ds_read_b128 v[24:27], v13 offset:0
    v_mfma_f32_16x16x32_bf16 v[112:115], v[64:67], v[32:35], v[112:115]
    ds_read_b128 v[40:43], v21 offset:0
    v_mfma_f32_16x16x32_bf16 v[116:119], v[68:71], v[32:35], v[116:119]
    ds_read_b128 v[44:47], v21 offset:2048
    v_mfma_f32_16x16x32_bf16 v[120:123], v[72:75], v[32:35], v[120:123]
    ds_read_b128 v[48:51], v21 offset:4096
    v_mfma_f32_16x16x32_bf16 v[124:127], v[76:79], v[32:35], v[124:127]
    ds_read_b128 v[52:55], v21 offset:6144
    v_mfma_f32_16x16x32_bf16 v[128:131], v[60:63], v[36:39], v[128:131]
    ds_read_b128 v[56:59], v21 offset:8192
    v_mfma_f32_16x16x32_bf16 v[132:135], v[64:67], v[36:39], v[132:135]
    ds_read_b128 v[28:31], v13 offset:2048
    v_mfma_f32_16x16x32_bf16 v[136:139], v[68:71], v[36:39], v[136:139]
    v_lshlrev_b32 v178, 16, v181
    v_and_b32 v179, 0xffff0000, v181
    v_lshlrev_b32 v180, 16, v182
    v_mfma_f32_16x16x32_bf16 v[140:143], v[72:75], v[36:39], v[140:143]
    v_and_b32 v181, 0xffff0000, v182
    v_lshlrev_b32 v182, 16, v183
    v_and_b32 v183, 0xffff0000, v183
    v_mfma_f32_16x16x32_bf16 v[144:147], v[76:79], v[36:39], v[144:147]
    v_lshlrev_b32 v184, 16, v196
    v_and_b32 v185, 0xffff0000, v196
    v_lshlrev_b32 v186, 16, v197
    s_waitcnt lgkmcnt(0)
    v_mfma_f32_16x16x32_bf16 v[108:111], v[40:43], v[24:27], v[108:111]
    ds_read_b128 v[32:35], v14 offset:0
    v_mfma_f32_16x16x32_bf16 v[112:115], v[44:47], v[24:27], v[112:115]
    ds_read_b128 v[60:63], v22 offset:0
    v_mfma_f32_16x16x32_bf16 v[116:119], v[48:51], v[24:27], v[116:119]
    ds_read_b128 v[64:67], v22 offset:2048
    v_mfma_f32_16x16x32_bf16 v[120:123], v[52:55], v[24:27], v[120:123]
    ds_read_b128 v[68:71], v22 offset:4096
    v_mfma_f32_16x16x32_bf16 v[124:127], v[56:59], v[24:27], v[124:127]
    ds_read_b128 v[72:75], v22 offset:6144
    v_mfma_f32_16x16x32_bf16 v[128:131], v[40:43], v[28:31], v[128:131]
    ds_read_b128 v[76:79], v22 offset:8192
    v_mfma_f32_16x16x32_bf16 v[132:135], v[44:47], v[28:31], v[132:135]
    ds_read_b128 v[36:39], v14 offset:2048
    v_mfma_f32_16x16x32_bf16 v[136:139], v[48:51], v[28:31], v[136:139]
    v_and_b32 v187, 0xffff0000, v197
    v_lshlrev_b32 v188, 16, v198
    v_and_b32 v189, 0xffff0000, v198
    v_mfma_f32_16x16x32_bf16 v[140:143], v[52:55], v[28:31], v[140:143]
    v_lshlrev_b32 v190, 16, v199
    v_and_b32 v191, 0xffff0000, v199
    v_lshlrev_b32 v192, 16, v200
    v_mfma_f32_16x16x32_bf16 v[144:147], v[56:59], v[28:31], v[144:147]
    v_and_b32 v193, 0xffff0000, v200
    v_lshlrev_b32 v194, 16, v201
    v_and_b32 v195, 0xffff0000, v201
    s_waitcnt lgkmcnt(0)
    s_barrier
    v_mfma_f32_16x16x32_bf16 v[108:111], v[60:63], v[32:35], v[108:111]
    ds_read_b128 v[24:27], v7 offset:0
    v_mfma_f32_16x16x32_bf16 v[112:115], v[64:67], v[32:35], v[112:115]
    ds_read_b128 v[40:43], v15 offset:0
    v_mfma_f32_16x16x32_bf16 v[116:119], v[68:71], v[32:35], v[116:119]
    ds_read_b128 v[44:47], v15 offset:2048
    v_mfma_f32_16x16x32_bf16 v[120:123], v[72:75], v[32:35], v[120:123]
    ds_read_b128 v[48:51], v15 offset:4096
    v_mfma_f32_16x16x32_bf16 v[124:127], v[76:79], v[32:35], v[124:127]
    ds_read_b128 v[52:55], v15 offset:6144
    v_mfma_f32_16x16x32_bf16 v[128:131], v[60:63], v[36:39], v[128:131]
    ds_read_b128 v[56:59], v15 offset:8192
    v_mfma_f32_16x16x32_bf16 v[132:135], v[64:67], v[36:39], v[132:135]
    ds_read_b128 v[28:31], v7 offset:2048
    v_mfma_f32_16x16x32_bf16 v[136:139], v[68:71], v[36:39], v[136:139]
    v_lshlrev_b32 v196, 16, v202
    v_and_b32 v197, 0xffff0000, v202
    v_lshlrev_b32 v198, 16, v203
    v_mfma_f32_16x16x32_bf16 v[140:143], v[72:75], v[36:39], v[140:143]
    v_and_b32 v199, 0xffff0000, v203
    v_lshlrev_b32 v200, 16, v204
    v_and_b32 v201, 0xffff0000, v204
    v_mfma_f32_16x16x32_bf16 v[144:147], v[76:79], v[36:39], v[144:147]
    v_lshlrev_b32 v202, 16, v205
    v_and_b32 v203, 0xffff0000, v205
    v_lshlrev_b32 v204, 16, v206
    s_waitcnt lgkmcnt(0)
    v_mfma_f32_16x16x32_bf16 v[108:111], v[40:43], v[24:27], v[108:111]
    ds_read_b128 v[32:35], v8 offset:0
    v_mfma_f32_16x16x32_bf16 v[112:115], v[44:47], v[24:27], v[112:115]
    ds_read_b128 v[60:63], v16 offset:0
    v_mfma_f32_16x16x32_bf16 v[116:119], v[48:51], v[24:27], v[116:119]
    ds_read_b128 v[64:67], v16 offset:2048
    v_mfma_f32_16x16x32_bf16 v[120:123], v[52:55], v[24:27], v[120:123]
    ds_read_b128 v[68:71], v16 offset:4096
    v_mfma_f32_16x16x32_bf16 v[124:127], v[56:59], v[24:27], v[124:127]
    ds_read_b128 v[72:75], v16 offset:6144
    v_mfma_f32_16x16x32_bf16 v[128:131], v[40:43], v[28:31], v[128:131]
    ds_read_b128 v[76:79], v16 offset:8192
    v_mfma_f32_16x16x32_bf16 v[132:135], v[44:47], v[28:31], v[132:135]
    ds_read_b128 v[36:39], v8 offset:2048
    v_mfma_f32_16x16x32_bf16 v[136:139], v[48:51], v[28:31], v[136:139]
    v_and_b32 v205, 0xffff0000, v206
    v_lshlrev_b32 v206, 16, v207
    v_and_b32 v207, 0xffff0000, v207
    v_mfma_f32_16x16x32_bf16 v[140:143], v[52:55], v[28:31], v[140:143]
    v_mfma_f32_16x16x32_bf16 v[144:147], v[56:59], v[28:31], v[144:147]
    s_waitcnt lgkmcnt(0)
    s_barrier
    v_mfma_f32_16x16x32_bf16 v[108:111], v[60:63], v[32:35], v[108:111]
    ds_read_b128 v[24:27], v9 offset:0
    v_mfma_f32_16x16x32_bf16 v[112:115], v[64:67], v[32:35], v[112:115]
    ds_read_b128 v[40:43], v17 offset:0
    v_mfma_f32_16x16x32_bf16 v[116:119], v[68:71], v[32:35], v[116:119]
    ds_read_b128 v[44:47], v17 offset:2048
    v_mfma_f32_16x16x32_bf16 v[120:123], v[72:75], v[32:35], v[120:123]
    ds_read_b128 v[48:51], v17 offset:4096
    v_mfma_f32_16x16x32_bf16 v[124:127], v[76:79], v[32:35], v[124:127]
    ds_read_b128 v[52:55], v17 offset:6144
    v_mfma_f32_16x16x32_bf16 v[128:131], v[60:63], v[36:39], v[128:131]
    ds_read_b128 v[56:59], v17 offset:8192
    v_mfma_f32_16x16x32_bf16 v[132:135], v[64:67], v[36:39], v[132:135]
    ds_read_b128 v[28:31], v9 offset:2048
    v_mfma_f32_16x16x32_bf16 v[136:139], v[68:71], v[36:39], v[136:139]
    v_mfma_f32_16x16x32_bf16 v[140:143], v[72:75], v[36:39], v[140:143]
    v_mfma_f32_16x16x32_bf16 v[144:147], v[76:79], v[36:39], v[144:147]
    s_waitcnt lgkmcnt(0)
    v_mfma_f32_16x16x32_bf16 v[108:111], v[40:43], v[24:27], v[108:111]
    ds_read_b128 v[32:35], v10 offset:0
    v_mfma_f32_16x16x32_bf16 v[112:115], v[44:47], v[24:27], v[112:115]
    ds_read_b128 v[60:63], v18 offset:0
    v_mfma_f32_16x16x32_bf16 v[116:119], v[48:51], v[24:27], v[116:119]
    ds_read_b128 v[64:67], v18 offset:2048
    v_mfma_f32_16x16x32_bf16 v[120:123], v[52:55], v[24:27], v[120:123]
    ds_read_b128 v[68:71], v18 offset:4096
    v_mfma_f32_16x16x32_bf16 v[124:127], v[56:59], v[24:27], v[124:127]
    ds_read_b128 v[72:75], v18 offset:6144
    v_mfma_f32_16x16x32_bf16 v[128:131], v[40:43], v[28:31], v[128:131]
    ds_read_b128 v[76:79], v18 offset:8192
    v_mfma_f32_16x16x32_bf16 v[132:135], v[44:47], v[28:31], v[132:135]
    ds_read_b128 v[36:39], v10 offset:2048
    v_mfma_f32_16x16x32_bf16 v[136:139], v[48:51], v[28:31], v[136:139]
    v_mfma_f32_16x16x32_bf16 v[140:143], v[52:55], v[28:31], v[140:143]
    v_mfma_f32_16x16x32_bf16 v[144:147], v[56:59], v[28:31], v[144:147]
    s_waitcnt lgkmcnt(0)
    s_barrier
    v_mfma_f32_16x16x32_bf16 v[108:111], v[60:63], v[32:35], v[108:111]
    ds_read_b128 v[24:27], v11 offset:0
    v_mfma_f32_16x16x32_bf16 v[112:115], v[64:67], v[32:35], v[112:115]
    ds_read_b128 v[40:43], v19 offset:0
    v_mfma_f32_16x16x32_bf16 v[116:119], v[68:71], v[32:35], v[116:119]
    ds_read_b128 v[44:47], v19 offset:2048
    v_mfma_f32_16x16x32_bf16 v[120:123], v[72:75], v[32:35], v[120:123]
    ds_read_b128 v[48:51], v19 offset:4096
    v_mfma_f32_16x16x32_bf16 v[124:127], v[76:79], v[32:35], v[124:127]
    ds_read_b128 v[52:55], v19 offset:6144
    v_mfma_f32_16x16x32_bf16 v[128:131], v[60:63], v[36:39], v[128:131]
    ds_read_b128 v[56:59], v19 offset:8192
    v_mfma_f32_16x16x32_bf16 v[132:135], v[64:67], v[36:39], v[132:135]
    ds_read_b128 v[28:31], v11 offset:2048
    v_mfma_f32_16x16x32_bf16 v[136:139], v[68:71], v[36:39], v[136:139]
    v_mfma_f32_16x16x32_bf16 v[140:143], v[72:75], v[36:39], v[140:143]
    v_mfma_f32_16x16x32_bf16 v[144:147], v[76:79], v[36:39], v[144:147]
    s_waitcnt lgkmcnt(0)
    v_mfma_f32_16x16x32_bf16 v[108:111], v[40:43], v[24:27], v[108:111]
    ds_read_b128 v[32:35], v12 offset:0
    v_mfma_f32_16x16x32_bf16 v[112:115], v[44:47], v[24:27], v[112:115]
    ds_read_b128 v[60:63], v20 offset:0
    v_mfma_f32_16x16x32_bf16 v[116:119], v[48:51], v[24:27], v[116:119]
    ds_read_b128 v[64:67], v20 offset:2048
    v_mfma_f32_16x16x32_bf16 v[120:123], v[52:55], v[24:27], v[120:123]
    ds_read_b128 v[68:71], v20 offset:4096
    v_mfma_f32_16x16x32_bf16 v[124:127], v[56:59], v[24:27], v[124:127]
    ds_read_b128 v[72:75], v20 offset:6144
    v_mfma_f32_16x16x32_bf16 v[128:131], v[40:43], v[28:31], v[128:131]
    ds_read_b128 v[76:79], v20 offset:8192
    v_mfma_f32_16x16x32_bf16 v[132:135], v[44:47], v[28:31], v[132:135]
    ds_read_b128 v[36:39], v12 offset:2048
    v_mfma_f32_16x16x32_bf16 v[136:139], v[48:51], v[28:31], v[136:139]
    v_mfma_f32_16x16x32_bf16 v[140:143], v[52:55], v[28:31], v[140:143]
    v_mfma_f32_16x16x32_bf16 v[144:147], v[56:59], v[28:31], v[144:147]
    s_waitcnt lgkmcnt(0)
    s_barrier
    v_mfma_f32_16x16x32_bf16 v[108:111], v[60:63], v[32:35], v[108:111]
    ds_read_b128 v[24:27], v13 offset:0
    v_mfma_f32_16x16x32_bf16 v[112:115], v[64:67], v[32:35], v[112:115]
    ds_read_b128 v[40:43], v21 offset:0
    v_mfma_f32_16x16x32_bf16 v[116:119], v[68:71], v[32:35], v[116:119]
    ds_read_b128 v[44:47], v21 offset:2048
    v_mfma_f32_16x16x32_bf16 v[120:123], v[72:75], v[32:35], v[120:123]
    ds_read_b128 v[48:51], v21 offset:4096
    v_mfma_f32_16x16x32_bf16 v[124:127], v[76:79], v[32:35], v[124:127]
    ds_read_b128 v[52:55], v21 offset:6144
    v_mfma_f32_16x16x32_bf16 v[128:131], v[60:63], v[36:39], v[128:131]
    ds_read_b128 v[56:59], v21 offset:8192
    v_mfma_f32_16x16x32_bf16 v[132:135], v[64:67], v[36:39], v[132:135]
    ds_read_b128 v[28:31], v13 offset:2048
    v_mfma_f32_16x16x32_bf16 v[136:139], v[68:71], v[36:39], v[136:139]
    v_mfma_f32_16x16x32_bf16 v[140:143], v[72:75], v[36:39], v[140:143]
    v_mfma_f32_16x16x32_bf16 v[144:147], v[76:79], v[36:39], v[144:147]
    s_waitcnt lgkmcnt(0)
    v_mfma_f32_16x16x32_bf16 v[108:111], v[40:43], v[24:27], v[108:111]
    ds_read_b128 v[32:35], v14 offset:0
    v_mfma_f32_16x16x32_bf16 v[112:115], v[44:47], v[24:27], v[112:115]
    ds_read_b128 v[60:63], v22 offset:0
    v_mfma_f32_16x16x32_bf16 v[116:119], v[48:51], v[24:27], v[116:119]
    ds_read_b128 v[64:67], v22 offset:2048
    v_mfma_f32_16x16x32_bf16 v[120:123], v[52:55], v[24:27], v[120:123]
    ds_read_b128 v[68:71], v22 offset:4096
    v_mfma_f32_16x16x32_bf16 v[124:127], v[56:59], v[24:27], v[124:127]
    ds_read_b128 v[72:75], v22 offset:6144
    v_mfma_f32_16x16x32_bf16 v[128:131], v[40:43], v[28:31], v[128:131]
    ds_read_b128 v[76:79], v22 offset:8192
    v_mfma_f32_16x16x32_bf16 v[132:135], v[44:47], v[28:31], v[132:135]
    ds_read_b128 v[36:39], v14 offset:2048
    v_mfma_f32_16x16x32_bf16 v[136:139], v[48:51], v[28:31], v[136:139]
    v_mfma_f32_16x16x32_bf16 v[140:143], v[52:55], v[28:31], v[140:143]
    v_mfma_f32_16x16x32_bf16 v[144:147], v[56:59], v[28:31], v[144:147]
    s_waitcnt lgkmcnt(0)
    s_barrier
    v_mfma_f32_16x16x32_bf16 v[108:111], v[60:63], v[32:35], v[108:111]
    ds_read_b128 v[24:27], v7 offset:0
    v_mfma_f32_16x16x32_bf16 v[112:115], v[64:67], v[32:35], v[112:115]
    ds_read_b128 v[40:43], v15 offset:0
    v_mfma_f32_16x16x32_bf16 v[116:119], v[68:71], v[32:35], v[116:119]
    ds_read_b128 v[44:47], v15 offset:2048
    v_mfma_f32_16x16x32_bf16 v[120:123], v[72:75], v[32:35], v[120:123]
    ds_read_b128 v[48:51], v15 offset:4096
    v_mfma_f32_16x16x32_bf16 v[124:127], v[76:79], v[32:35], v[124:127]
    ds_read_b128 v[52:55], v15 offset:6144
    v_mfma_f32_16x16x32_bf16 v[128:131], v[60:63], v[36:39], v[128:131]
    ds_read_b128 v[56:59], v15 offset:8192
    v_mfma_f32_16x16x32_bf16 v[132:135], v[64:67], v[36:39], v[132:135]
    ds_read_b128 v[28:31], v7 offset:2048
    v_mfma_f32_16x16x32_bf16 v[136:139], v[68:71], v[36:39], v[136:139]
    v_mfma_f32_16x16x32_bf16 v[140:143], v[72:75], v[36:39], v[140:143]
    v_mfma_f32_16x16x32_bf16 v[144:147], v[76:79], v[36:39], v[144:147]
    s_waitcnt lgkmcnt(0)
    v_mfma_f32_16x16x32_bf16 v[108:111], v[40:43], v[24:27], v[108:111]
    ds_read_b128 v[32:35], v8 offset:0
    v_mfma_f32_16x16x32_bf16 v[112:115], v[44:47], v[24:27], v[112:115]
    ds_read_b128 v[60:63], v16 offset:0
    v_mfma_f32_16x16x32_bf16 v[116:119], v[48:51], v[24:27], v[116:119]
    ds_read_b128 v[64:67], v16 offset:2048
    v_mfma_f32_16x16x32_bf16 v[120:123], v[52:55], v[24:27], v[120:123]
    ds_read_b128 v[68:71], v16 offset:4096
    v_mfma_f32_16x16x32_bf16 v[124:127], v[56:59], v[24:27], v[124:127]
    ds_read_b128 v[72:75], v16 offset:6144
    v_mfma_f32_16x16x32_bf16 v[128:131], v[40:43], v[28:31], v[128:131]
    ds_read_b128 v[76:79], v16 offset:8192
    v_mfma_f32_16x16x32_bf16 v[132:135], v[44:47], v[28:31], v[132:135]
    ds_read_b128 v[36:39], v8 offset:2048
    v_mfma_f32_16x16x32_bf16 v[136:139], v[48:51], v[28:31], v[136:139]
    v_mfma_f32_16x16x32_bf16 v[140:143], v[52:55], v[28:31], v[140:143]
    v_mfma_f32_16x16x32_bf16 v[144:147], v[56:59], v[28:31], v[144:147]
    s_waitcnt lgkmcnt(0)
    s_barrier
    v_mfma_f32_16x16x32_bf16 v[108:111], v[60:63], v[32:35], v[108:111]
    ds_read_b128 v[24:27], v9 offset:0
    v_mfma_f32_16x16x32_bf16 v[112:115], v[64:67], v[32:35], v[112:115]
    ds_read_b128 v[40:43], v17 offset:0
    v_mfma_f32_16x16x32_bf16 v[116:119], v[68:71], v[32:35], v[116:119]
    ds_read_b128 v[44:47], v17 offset:2048
    v_mfma_f32_16x16x32_bf16 v[120:123], v[72:75], v[32:35], v[120:123]
    ds_read_b128 v[48:51], v17 offset:4096
    v_mfma_f32_16x16x32_bf16 v[124:127], v[76:79], v[32:35], v[124:127]
    ds_read_b128 v[52:55], v17 offset:6144
    v_mfma_f32_16x16x32_bf16 v[128:131], v[60:63], v[36:39], v[128:131]
    ds_read_b128 v[56:59], v17 offset:8192
    v_mfma_f32_16x16x32_bf16 v[132:135], v[64:67], v[36:39], v[132:135]
    ds_read_b128 v[28:31], v9 offset:2048
    v_mfma_f32_16x16x32_bf16 v[136:139], v[68:71], v[36:39], v[136:139]
    v_mfma_f32_16x16x32_bf16 v[140:143], v[72:75], v[36:39], v[140:143]
    v_mfma_f32_16x16x32_bf16 v[144:147], v[76:79], v[36:39], v[144:147]
    s_waitcnt lgkmcnt(0)
    v_mfma_f32_16x16x32_bf16 v[108:111], v[40:43], v[24:27], v[108:111]
    ds_read_b128 v[32:35], v10 offset:0
    v_mfma_f32_16x16x32_bf16 v[112:115], v[44:47], v[24:27], v[112:115]
    ds_read_b128 v[60:63], v18 offset:0
    v_mfma_f32_16x16x32_bf16 v[116:119], v[48:51], v[24:27], v[116:119]
    ds_read_b128 v[64:67], v18 offset:2048
    v_mfma_f32_16x16x32_bf16 v[120:123], v[52:55], v[24:27], v[120:123]
    ds_read_b128 v[68:71], v18 offset:4096
    v_mfma_f32_16x16x32_bf16 v[124:127], v[56:59], v[24:27], v[124:127]
    ds_read_b128 v[72:75], v18 offset:6144
    v_mfma_f32_16x16x32_bf16 v[128:131], v[40:43], v[28:31], v[128:131]
    ds_read_b128 v[76:79], v18 offset:8192
    v_mfma_f32_16x16x32_bf16 v[132:135], v[44:47], v[28:31], v[132:135]
    ds_read_b128 v[36:39], v10 offset:2048
    v_mfma_f32_16x16x32_bf16 v[136:139], v[48:51], v[28:31], v[136:139]
    v_mfma_f32_16x16x32_bf16 v[140:143], v[52:55], v[28:31], v[140:143]
    v_mfma_f32_16x16x32_bf16 v[144:147], v[56:59], v[28:31], v[144:147]
    s_waitcnt lgkmcnt(0)
    s_barrier
    v_mfma_f32_16x16x32_bf16 v[108:111], v[60:63], v[32:35], v[108:111]
    ds_read_b128 v[24:27], v11 offset:0
    v_mfma_f32_16x16x32_bf16 v[112:115], v[64:67], v[32:35], v[112:115]
    ds_read_b128 v[40:43], v19 offset:0
    v_mfma_f32_16x16x32_bf16 v[116:119], v[68:71], v[32:35], v[116:119]
    ds_read_b128 v[44:47], v19 offset:2048
    v_mfma_f32_16x16x32_bf16 v[120:123], v[72:75], v[32:35], v[120:123]
    ds_read_b128 v[48:51], v19 offset:4096
    v_mfma_f32_16x16x32_bf16 v[124:127], v[76:79], v[32:35], v[124:127]
    ds_read_b128 v[52:55], v19 offset:6144
    v_mfma_f32_16x16x32_bf16 v[128:131], v[60:63], v[36:39], v[128:131]
    ds_read_b128 v[56:59], v19 offset:8192
    v_mfma_f32_16x16x32_bf16 v[132:135], v[64:67], v[36:39], v[132:135]
    ds_read_b128 v[28:31], v11 offset:2048
    v_mfma_f32_16x16x32_bf16 v[136:139], v[68:71], v[36:39], v[136:139]
    v_mfma_f32_16x16x32_bf16 v[140:143], v[72:75], v[36:39], v[140:143]
    v_mfma_f32_16x16x32_bf16 v[144:147], v[76:79], v[36:39], v[144:147]
    s_waitcnt lgkmcnt(0)
    v_mfma_f32_16x16x32_bf16 v[108:111], v[40:43], v[24:27], v[108:111]
    ds_read_b128 v[32:35], v12 offset:0
    v_mfma_f32_16x16x32_bf16 v[112:115], v[44:47], v[24:27], v[112:115]
    ds_read_b128 v[60:63], v20 offset:0
    v_mfma_f32_16x16x32_bf16 v[116:119], v[48:51], v[24:27], v[116:119]
    ds_read_b128 v[64:67], v20 offset:2048
    v_mfma_f32_16x16x32_bf16 v[120:123], v[52:55], v[24:27], v[120:123]
    ds_read_b128 v[68:71], v20 offset:4096
    v_mfma_f32_16x16x32_bf16 v[124:127], v[56:59], v[24:27], v[124:127]
    ds_read_b128 v[72:75], v20 offset:6144
    v_mfma_f32_16x16x32_bf16 v[128:131], v[40:43], v[28:31], v[128:131]
    ds_read_b128 v[76:79], v20 offset:8192
    v_mfma_f32_16x16x32_bf16 v[132:135], v[44:47], v[28:31], v[132:135]
    ds_read_b128 v[36:39], v12 offset:2048
    v_mfma_f32_16x16x32_bf16 v[136:139], v[48:51], v[28:31], v[136:139]
    v_mfma_f32_16x16x32_bf16 v[140:143], v[52:55], v[28:31], v[140:143]
    v_mfma_f32_16x16x32_bf16 v[144:147], v[56:59], v[28:31], v[144:147]
    s_waitcnt lgkmcnt(0)
    s_barrier
    v_mfma_f32_16x16x32_bf16 v[108:111], v[60:63], v[32:35], v[108:111]
    ds_read_b128 v[24:27], v13 offset:0
    v_mfma_f32_16x16x32_bf16 v[112:115], v[64:67], v[32:35], v[112:115]
    ds_read_b128 v[40:43], v21 offset:0
    v_mfma_f32_16x16x32_bf16 v[116:119], v[68:71], v[32:35], v[116:119]
    ds_read_b128 v[44:47], v21 offset:2048
    v_mfma_f32_16x16x32_bf16 v[120:123], v[72:75], v[32:35], v[120:123]
    ds_read_b128 v[48:51], v21 offset:4096
    v_mfma_f32_16x16x32_bf16 v[124:127], v[76:79], v[32:35], v[124:127]
    ds_read_b128 v[52:55], v21 offset:6144
    v_mfma_f32_16x16x32_bf16 v[128:131], v[60:63], v[36:39], v[128:131]
    ds_read_b128 v[56:59], v21 offset:8192
    v_mfma_f32_16x16x32_bf16 v[132:135], v[64:67], v[36:39], v[132:135]
    ds_read_b128 v[28:31], v13 offset:2048
    v_mfma_f32_16x16x32_bf16 v[136:139], v[68:71], v[36:39], v[136:139]
    v_mfma_f32_16x16x32_bf16 v[140:143], v[72:75], v[36:39], v[140:143]
    v_mfma_f32_16x16x32_bf16 v[144:147], v[76:79], v[36:39], v[144:147]
    s_waitcnt lgkmcnt(0)
    v_mfma_f32_16x16x32_bf16 v[108:111], v[40:43], v[24:27], v[108:111]
    ds_read_b128 v[32:35], v14 offset:0
    v_mfma_f32_16x16x32_bf16 v[112:115], v[44:47], v[24:27], v[112:115]
    ds_read_b128 v[60:63], v22 offset:0
    v_mfma_f32_16x16x32_bf16 v[116:119], v[48:51], v[24:27], v[116:119]
    ds_read_b128 v[64:67], v22 offset:2048
    v_mfma_f32_16x16x32_bf16 v[120:123], v[52:55], v[24:27], v[120:123]
    ds_read_b128 v[68:71], v22 offset:4096
    v_mfma_f32_16x16x32_bf16 v[124:127], v[56:59], v[24:27], v[124:127]
    ds_read_b128 v[72:75], v22 offset:6144
    v_mfma_f32_16x16x32_bf16 v[128:131], v[40:43], v[28:31], v[128:131]
    ds_read_b128 v[76:79], v22 offset:8192
    v_mfma_f32_16x16x32_bf16 v[132:135], v[44:47], v[28:31], v[132:135]
    ds_read_b128 v[36:39], v14 offset:2048
    v_mfma_f32_16x16x32_bf16 v[136:139], v[48:51], v[28:31], v[136:139]
    v_mfma_f32_16x16x32_bf16 v[140:143], v[52:55], v[28:31], v[140:143]
    v_mfma_f32_16x16x32_bf16 v[144:147], v[56:59], v[28:31], v[144:147]
    s_waitcnt lgkmcnt(0)
    v_mfma_f32_16x16x32_bf16 v[108:111], v[60:63], v[32:35], v[108:111]
    v_mfma_f32_16x16x32_bf16 v[112:115], v[64:67], v[32:35], v[112:115]
    v_mfma_f32_16x16x32_bf16 v[116:119], v[68:71], v[32:35], v[116:119]
    v_mfma_f32_16x16x32_bf16 v[120:123], v[72:75], v[32:35], v[120:123]
    v_mfma_f32_16x16x32_bf16 v[124:127], v[76:79], v[32:35], v[124:127]
    v_mfma_f32_16x16x32_bf16 v[128:131], v[60:63], v[36:39], v[128:131]
    v_mfma_f32_16x16x32_bf16 v[132:135], v[64:67], v[36:39], v[132:135]
    v_mfma_f32_16x16x32_bf16 v[136:139], v[68:71], v[36:39], v[136:139]
    v_mfma_f32_16x16x32_bf16 v[140:143], v[72:75], v[36:39], v[140:143]
    v_mfma_f32_16x16x32_bf16 v[144:147], v[76:79], v[36:39], v[144:147]
    s_nop 7
    s_nop 7
    s_barrier
    v_lshlrev_b32 v4, 4, v1
    s_mul_i32 s57, s40, 5120
    s_add_u32 s57, s57, 0
    v_add_u32 v5, s57, v4
    s_xor_b32 s57, s40, 2
    s_mul_i32 s57, s57, 5120
    s_add_u32 s57, s57, 0
    v_add_u32 v6, s57, v4
    s_cmp_eq_u32 s46, 0
    s_cbranch_scc0 l4_kernel_4
    ds_write_b128 v5, v[128:131] offset:0
    ds_write_b128 v5, v[132:135] offset:1024
    ds_write_b128 v5, v[136:139] offset:2048
    ds_write_b128 v5, v[140:143] offset:3072
    ds_write_b128 v5, v[144:147] offset:4096
    s_waitcnt lgkmcnt(0)
    s_barrier
    ds_read_b128 v[40:43], v6 offset:0
    ds_read_b128 v[44:47], v6 offset:1024
    ds_read_b128 v[48:51], v6 offset:2048
    ds_read_b128 v[52:55], v6 offset:3072
    ds_read_b128 v[56:59], v6 offset:4096
    s_waitcnt lgkmcnt(0)
    v_add_f32 v108, v108, v40
    v_add_f32 v109, v109, v41
    v_add_f32 v110, v110, v42
    v_add_f32 v111, v111, v43
    v_add_f32 v112, v112, v44
    v_add_f32 v113, v113, v45
    v_add_f32 v114, v114, v46
    v_add_f32 v115, v115, v47
    v_add_f32 v116, v116, v48
    v_add_f32 v117, v117, v49
    v_add_f32 v118, v118, v50
    v_add_f32 v119, v119, v51
    v_add_f32 v120, v120, v52
    v_add_f32 v121, v121, v53
    v_add_f32 v122, v122, v54
    v_add_f32 v123, v123, v55
    v_add_f32 v124, v124, v56
    v_add_f32 v125, v125, v57
    v_add_f32 v126, v126, v58
    v_add_f32 v127, v127, v59
    s_branch l4_kernel_3
l4_kernel_4:
    ds_write_b128 v5, v[108:111] offset:0
    ds_write_b128 v5, v[112:115] offset:1024
    ds_write_b128 v5, v[116:119] offset:2048
    ds_write_b128 v5, v[120:123] offset:3072
    ds_write_b128 v5, v[124:127] offset:4096
    s_waitcnt lgkmcnt(0)
    s_barrier
    ds_read_b128 v[40:43], v6 offset:0
    ds_read_b128 v[44:47], v6 offset:1024
    ds_read_b128 v[48:51], v6 offset:2048
    ds_read_b128 v[52:55], v6 offset:3072
    ds_read_b128 v[56:59], v6 offset:4096
    s_waitcnt lgkmcnt(0)
    v_add_f32 v108, v128, v40
    v_add_f32 v109, v129, v41
    v_add_f32 v110, v130, v42
    v_add_f32 v111, v131, v43
    v_add_f32 v112, v132, v44
    v_add_f32 v113, v133, v45
    v_add_f32 v114, v134, v46
    v_add_f32 v115, v135, v47
    v_add_f32 v116, v136, v48
    v_add_f32 v117, v137, v49
    v_add_f32 v118, v138, v50
    v_add_f32 v119, v139, v51
    v_add_f32 v120, v140, v52
    v_add_f32 v121, v141, v53
    v_add_f32 v122, v142, v54
    v_add_f32 v123, v143, v55
    v_add_f32 v124, v144, v56
    v_add_f32 v125, v145, v57
    v_add_f32 v126, v146, v58
    v_add_f32 v127, v147, v59
l4_kernel_3:
    v_cvt_pk_bf16_f32 v24, v108, v109
    v_cvt_pk_bf16_f32 v25, v110, v111
    v_cvt_pk_bf16_f32 v26, v112, v113
    v_cvt_pk_bf16_f32 v27, v114, v115
    v_cvt_pk_bf16_f32 v28, v116, v117
    v_cvt_pk_bf16_f32 v29, v118, v119
    v_cvt_pk_bf16_f32 v30, v120, v121
    v_cvt_pk_bf16_f32 v31, v122, v123
    v_cvt_pk_bf16_f32 v32, v124, v125
    v_cvt_pk_bf16_f32 v33, v126, v127
    ds_write_b64 v157, v[24:25] offset:0
    ds_write_b64 v157, v[26:27] offset:32
    ds_write_b64 v157, v[28:29] offset:64
    ds_write_b64 v157, v[30:31] offset:96
    ds_write_b64 v157, v[32:33] offset:128
    s_waitcnt lgkmcnt(0)
    ds_read_b128 v[36:39], v148
    ds_read_b128 v[40:43], v149
    ds_read_b128 v[44:47], v150
    s_waitcnt lgkmcnt(2)
    v_lshlrev_b32 v48, 16, v36
    v_and_b32 v49, 0xffff0000, v36
    v_lshlrev_b32 v50, 16, v37
    v_and_b32 v51, 0xffff0000, v37
    v_lshlrev_b32 v52, 16, v38
    v_and_b32 v53, 0xffff0000, v38
    v_lshlrev_b32 v54, 16, v39
    v_and_b32 v55, 0xffff0000, v39
    v_pk_mul_f32 v[48:49], v[48:49], v[160:161]
    v_pk_mul_f32 v[50:51], v[50:51], v[162:163]
    v_pk_mul_f32 v[52:53], v[52:53], v[164:165]
    v_pk_mul_f32 v[54:55], v[54:55], v[166:167]
    v_cvt_pk_bf16_f32 v64, v48, v49
    v_cvt_pk_bf16_f32 v65, v50, v51
    v_cvt_pk_bf16_f32 v66, v52, v53
    v_cvt_pk_bf16_f32 v67, v54, v55
    v_lshlrev_b32 v48, 16, v64
    v_and_b32 v49, 0xffff0000, v64
    v_lshlrev_b32 v50, 16, v65
    v_and_b32 v51, 0xffff0000, v65
    v_lshlrev_b32 v52, 16, v66
    v_and_b32 v53, 0xffff0000, v66
    v_lshlrev_b32 v54, 16, v67
    v_and_b32 v55, 0xffff0000, v67
    v_pk_add_f32 v[48:49], v[48:49], v[184:185]
    v_pk_add_f32 v[50:51], v[50:51], v[186:187]
    v_pk_add_f32 v[52:53], v[52:53], v[188:189]
    v_pk_add_f32 v[54:55], v[54:55], v[190:191]
    v_cvt_pk_bf16_f32 v68, v48, v49
    v_cvt_pk_bf16_f32 v69, v50, v51
    v_cvt_pk_bf16_f32 v70, v52, v53
    v_cvt_pk_bf16_f32 v71, v54, v55
    buffer_store_dwordx4 v[68:71], v151, s[24:27], 0 offen
    s_waitcnt lgkmcnt(1)
    v_lshlrev_b32 v48, 16, v40
    v_and_b32 v49, 0xffff0000, v40
    v_lshlrev_b32 v50, 16, v41
    v_and_b32 v51, 0xffff0000, v41
    v_lshlrev_b32 v52, 16, v42
    v_and_b32 v53, 0xffff0000, v42
    v_lshlrev_b32 v54, 16, v43
    v_and_b32 v55, 0xffff0000, v43
    v_pk_mul_f32 v[48:49], v[48:49], v[168:169]
    v_pk_mul_f32 v[50:51], v[50:51], v[170:171]
    v_pk_mul_f32 v[52:53], v[52:53], v[172:173]
    v_pk_mul_f32 v[54:55], v[54:55], v[174:175]
    v_cvt_pk_bf16_f32 v64, v48, v49
    v_cvt_pk_bf16_f32 v65, v50, v51
    v_cvt_pk_bf16_f32 v66, v52, v53
    v_cvt_pk_bf16_f32 v67, v54, v55
    v_lshlrev_b32 v48, 16, v64
    v_and_b32 v49, 0xffff0000, v64
    v_lshlrev_b32 v50, 16, v65
    v_and_b32 v51, 0xffff0000, v65
    v_lshlrev_b32 v52, 16, v66
    v_and_b32 v53, 0xffff0000, v66
    v_lshlrev_b32 v54, 16, v67
    v_and_b32 v55, 0xffff0000, v67
    v_pk_add_f32 v[48:49], v[48:49], v[192:193]
    v_pk_add_f32 v[50:51], v[50:51], v[194:195]
    v_pk_add_f32 v[52:53], v[52:53], v[196:197]
    v_pk_add_f32 v[54:55], v[54:55], v[198:199]
    v_cvt_pk_bf16_f32 v72, v48, v49
    v_cvt_pk_bf16_f32 v73, v50, v51
    v_cvt_pk_bf16_f32 v74, v52, v53
    v_cvt_pk_bf16_f32 v75, v54, v55
    buffer_store_dwordx4 v[72:75], v152, s[24:27], 0 offen
    s_waitcnt lgkmcnt(0)
    v_lshlrev_b32 v48, 16, v44
    v_and_b32 v49, 0xffff0000, v44
    v_lshlrev_b32 v50, 16, v45
    v_and_b32 v51, 0xffff0000, v45
    v_lshlrev_b32 v52, 16, v46
    v_and_b32 v53, 0xffff0000, v46
    v_lshlrev_b32 v54, 16, v47
    v_and_b32 v55, 0xffff0000, v47
    v_pk_mul_f32 v[48:49], v[48:49], v[176:177]
    v_pk_mul_f32 v[50:51], v[50:51], v[178:179]
    v_pk_mul_f32 v[52:53], v[52:53], v[180:181]
    v_pk_mul_f32 v[54:55], v[54:55], v[182:183]
    v_cvt_pk_bf16_f32 v64, v48, v49
    v_cvt_pk_bf16_f32 v65, v50, v51
    v_cvt_pk_bf16_f32 v66, v52, v53
    v_cvt_pk_bf16_f32 v67, v54, v55
    v_lshlrev_b32 v48, 16, v64
    v_and_b32 v49, 0xffff0000, v64
    v_lshlrev_b32 v50, 16, v65
    v_and_b32 v51, 0xffff0000, v65
    v_lshlrev_b32 v52, 16, v66
    v_and_b32 v53, 0xffff0000, v66
    v_lshlrev_b32 v54, 16, v67
    v_and_b32 v55, 0xffff0000, v67
    v_pk_add_f32 v[48:49], v[48:49], v[200:201]
    v_pk_add_f32 v[50:51], v[50:51], v[202:203]
    v_pk_add_f32 v[52:53], v[52:53], v[204:205]
    v_pk_add_f32 v[54:55], v[54:55], v[206:207]
    v_cvt_pk_bf16_f32 v76, v48, v49
    v_cvt_pk_bf16_f32 v77, v50, v51
    v_cvt_pk_bf16_f32 v78, v52, v53
    v_cvt_pk_bf16_f32 v79, v54, v55
    buffer_store_dwordx4 v[76:79], v153, s[24:27], 0 offen
l4_kernel_end:
    s_endpgm
l4_kernel_prod:
    s_sub_u32 s50, s40, 4
    v_lshrrev_b32 v10, 3, v1
    v_and_b32 v11, 7, v1
    s_and_b32 s51, s50, 1
    s_lshl_b32 s51, s51, 2
    v_lshrrev_b32 v12, 1, v10
    v_add_u32 v12, s51, v12
    v_xor_b32 v12, v11, v12
    v_lshlrev_b32 v12, 4, v12
    v_mul_u32_u24 v14, 3072, v10
    v_add_u32 v14, v14, v12
    v_mul_u32_u24 v15, 3072, v10
    v_add_u32 v15, v15, v12
    s_lshl_b32 s54, s50, 10
    s_mul_i32 s52, s50, 8
    s_add_u32 s53, s52, s47
    s_mul_i32 s53, s53, 3072
    s_add_u32 s56, s52, s44
    s_mul_i32 s56, s56, 3072
    s_cmp_ge_u32 s50, 2
    s_mov_b32 s57, 196608
    s_cselect_b32 s64, 4294919680, s57
    s_add_u32 s64, s64, s56
    s_waitcnt lgkmcnt(0)
    s_add_u32 s8, s4, 0x1400000
    s_addc_u32 s9, s5, 0
    s_mov_b32 s10, 0x600000
    s_mov_b32 s11, 0x00020000
    s_add_u32 s12, s4, 0x600000
    s_addc_u32 s13, s5, 0
    s_mov_b32 s14, 0x1e0000
    s_mov_b32 s15, 0x00020000
    s_add_u32 m0, s54, 0
    s_add_u32 s55, s53, 0
    buffer_load_dwordx4 v14, s[8:11], s55 offen lds
    s_add_u32 m0, s54, 4096
    s_add_u32 s55, s53, 98304
    buffer_load_dwordx4 v14, s[8:11], s55 offen lds
    s_add_u32 m0, s54, 8192
    s_add_u32 s55, s53, 1536
    buffer_load_dwordx4 v14, s[8:11], s55 offen lds
    s_add_u32 m0, s54, 12288
    s_add_u32 s55, s53, 99840
    buffer_load_dwordx4 v14, s[8:11], s55 offen lds
    s_add_u32 m0, s54, 16384
    s_add_u32 s55, s56, 0
    buffer_load_dwordx4 v15, s[12:15], s55 offen lds
    s_add_u32 m0, s54, 20480
    s_add_u32 s55, s56, 98304
    buffer_load_dwordx4 v15, s[12:15], s55 offen lds
    s_add_u32 m0, s54, 24576
    s_add_u32 s55, s64, 0
    buffer_load_dwordx4 v15, s[12:15], s55 offen lds
    s_add_u32 m0, s54, 28672
    s_add_u32 s55, s56, 50688
    buffer_load_dwordx4 v15, s[12:15], s55 offen lds
    s_add_u32 m0, s54, 32768
    s_add_u32 s55, s56, 148992
    buffer_load_dwordx4 v15, s[12:15], s55 offen lds
    s_add_u32 m0, s54, 36864
    s_add_u32 s55, s53, 128
    buffer_load_dwordx4 v14, s[8:11], s55 offen lds
    s_add_u32 m0, s54, 40960
    s_add_u32 s55, s53, 98432
    buffer_load_dwordx4 v14, s[8:11], s55 offen lds
    s_add_u32 m0, s54, 45056
    s_add_u32 s55, s53, 1664
    buffer_load_dwordx4 v14, s[8:11], s55 offen lds
    s_add_u32 m0, s54, 49152
    s_add_u32 s55, s53, 99968
    buffer_load_dwordx4 v14, s[8:11], s55 offen lds
    s_add_u32 m0, s54, 53248
    s_add_u32 s55, s56, 128
    buffer_load_dwordx4 v15, s[12:15], s55 offen lds
    s_add_u32 m0, s54, 57344
    s_add_u32 s55, s56, 98432
    buffer_load_dwordx4 v15, s[12:15], s55 offen lds
    s_add_u32 m0, s54, 61440
    s_add_u32 s55, s64, 128
    buffer_load_dwordx4 v15, s[12:15], s55 offen lds
    s_add_u32 m0, s54, 65536
    s_add_u32 s55, s56, 50816
    buffer_load_dwordx4 v15, s[12:15], s55 offen lds
    s_add_u32 m0, s54, 69632
    s_add_u32 s55, s56, 149120
    buffer_load_dwordx4 v15, s[12:15], s55 offen lds
    s_waitcnt vmcnt(9)
    s_barrier
    s_add_u32 m0, s54, 73728
    s_add_u32 s55, s53, 256
    buffer_load_dwordx4 v14, s[8:11], s55 offen lds
    s_add_u32 m0, s54, 77824
    s_add_u32 s55, s53, 98560
    buffer_load_dwordx4 v14, s[8:11], s55 offen lds
    s_add_u32 m0, s54, 81920
    s_add_u32 s55, s53, 1792
    buffer_load_dwordx4 v14, s[8:11], s55 offen lds
    s_add_u32 m0, s54, 86016
    s_add_u32 s55, s53, 100096
    buffer_load_dwordx4 v14, s[8:11], s55 offen lds
    s_add_u32 m0, s54, 90112
    s_add_u32 s55, s56, 256
    buffer_load_dwordx4 v15, s[12:15], s55 offen lds
    s_add_u32 m0, s54, 94208
    s_add_u32 s55, s56, 98560
    buffer_load_dwordx4 v15, s[12:15], s55 offen lds
    s_add_u32 m0, s54, 98304
    s_add_u32 s55, s64, 256
    buffer_load_dwordx4 v15, s[12:15], s55 offen lds
    s_add_u32 m0, s54, 102400
    s_add_u32 s55, s56, 50944
    buffer_load_dwordx4 v15, s[12:15], s55 offen lds
    s_add_u32 m0, s54, 106496
    s_add_u32 s55, s56, 149248
    buffer_load_dwordx4 v15, s[12:15], s55 offen lds
    s_add_u32 m0, s54, 110592
    s_add_u32 s55, s53, 384
    buffer_load_dwordx4 v14, s[8:11], s55 offen lds
    s_add_u32 m0, s54, 114688
    s_add_u32 s55, s53, 98688
    buffer_load_dwordx4 v14, s[8:11], s55 offen lds
    s_add_u32 m0, s54, 118784
    s_add_u32 s55, s53, 1920
    buffer_load_dwordx4 v14, s[8:11], s55 offen lds
    s_add_u32 m0, s54, 122880
    s_add_u32 s55, s53, 100224
    buffer_load_dwordx4 v14, s[8:11], s55 offen lds
    s_add_u32 m0, s54, 126976
    s_add_u32 s55, s56, 384
    buffer_load_dwordx4 v15, s[12:15], s55 offen lds
    s_add_u32 m0, s54, 131072
    s_add_u32 s55, s56, 98688
    buffer_load_dwordx4 v15, s[12:15], s55 offen lds
    s_add_u32 m0, s54, 135168
    s_add_u32 s55, s64, 384
    buffer_load_dwordx4 v15, s[12:15], s55 offen lds
    s_add_u32 m0, s54, 139264
    s_add_u32 s55, s56, 51072
    buffer_load_dwordx4 v15, s[12:15], s55 offen lds
    s_add_u32 m0, s54, 143360
    s_add_u32 s55, s56, 149376
    buffer_load_dwordx4 v15, s[12:15], s55 offen lds
    s_waitcnt vmcnt(18)
    s_barrier
    s_add_u32 m0, s54, 0
    s_add_u32 s55, s53, 512
    buffer_load_dwordx4 v14, s[8:11], s55 offen lds
    s_add_u32 m0, s54, 4096
    s_add_u32 s55, s53, 98816
    buffer_load_dwordx4 v14, s[8:11], s55 offen lds
    s_add_u32 m0, s54, 8192
    s_add_u32 s55, s53, 2048
    buffer_load_dwordx4 v14, s[8:11], s55 offen lds
    s_add_u32 m0, s54, 12288
    s_add_u32 s55, s53, 100352
    buffer_load_dwordx4 v14, s[8:11], s55 offen lds
    s_add_u32 m0, s54, 16384
    s_add_u32 s55, s56, 512
    buffer_load_dwordx4 v15, s[12:15], s55 offen lds
    s_add_u32 m0, s54, 20480
    s_add_u32 s55, s56, 98816
    buffer_load_dwordx4 v15, s[12:15], s55 offen lds
    s_add_u32 m0, s54, 24576
    s_add_u32 s55, s64, 512
    buffer_load_dwordx4 v15, s[12:15], s55 offen lds
    s_add_u32 m0, s54, 28672
    s_add_u32 s55, s56, 51200
    buffer_load_dwordx4 v15, s[12:15], s55 offen lds
    s_add_u32 m0, s54, 32768
    s_add_u32 s55, s56, 149504
    buffer_load_dwordx4 v15, s[12:15], s55 offen lds
    s_waitcnt vmcnt(18)
    s_barrier
    s_add_u32 m0, s54, 36864
    s_add_u32 s55, s53, 640
    buffer_load_dwordx4 v14, s[8:11], s55 offen lds
    s_add_u32 m0, s54, 40960
    s_add_u32 s55, s53, 98944
    buffer_load_dwordx4 v14, s[8:11], s55 offen lds
    s_add_u32 m0, s54, 45056
    s_add_u32 s55, s53, 2176
    buffer_load_dwordx4 v14, s[8:11], s55 offen lds
    s_add_u32 m0, s54, 49152
    s_add_u32 s55, s53, 100480
    buffer_load_dwordx4 v14, s[8:11], s55 offen lds
    s_add_u32 m0, s54, 53248
    s_add_u32 s55, s56, 640
    buffer_load_dwordx4 v15, s[12:15], s55 offen lds
    s_add_u32 m0, s54, 57344
    s_add_u32 s55, s56, 98944
    buffer_load_dwordx4 v15, s[12:15], s55 offen lds
    s_add_u32 m0, s54, 61440
    s_add_u32 s55, s64, 640
    buffer_load_dwordx4 v15, s[12:15], s55 offen lds
    s_add_u32 m0, s54, 65536
    s_add_u32 s55, s56, 51328
    buffer_load_dwordx4 v15, s[12:15], s55 offen lds
    s_add_u32 m0, s54, 69632
    s_add_u32 s55, s56, 149632
    buffer_load_dwordx4 v15, s[12:15], s55 offen lds
    s_waitcnt vmcnt(18)
    s_barrier
    s_add_u32 m0, s54, 73728
    s_add_u32 s55, s53, 768
    buffer_load_dwordx4 v14, s[8:11], s55 offen lds
    s_add_u32 m0, s54, 77824
    s_add_u32 s55, s53, 99072
    buffer_load_dwordx4 v14, s[8:11], s55 offen lds
    s_add_u32 m0, s54, 81920
    s_add_u32 s55, s53, 2304
    buffer_load_dwordx4 v14, s[8:11], s55 offen lds
    s_add_u32 m0, s54, 86016
    s_add_u32 s55, s53, 100608
    buffer_load_dwordx4 v14, s[8:11], s55 offen lds
    s_add_u32 m0, s54, 90112
    s_add_u32 s55, s56, 768
    buffer_load_dwordx4 v15, s[12:15], s55 offen lds
    s_add_u32 m0, s54, 94208
    s_add_u32 s55, s56, 99072
    buffer_load_dwordx4 v15, s[12:15], s55 offen lds
    s_add_u32 m0, s54, 98304
    s_add_u32 s55, s64, 768
    buffer_load_dwordx4 v15, s[12:15], s55 offen lds
    s_add_u32 m0, s54, 102400
    s_add_u32 s55, s56, 51456
    buffer_load_dwordx4 v15, s[12:15], s55 offen lds
    s_add_u32 m0, s54, 106496
    s_add_u32 s55, s56, 149760
    buffer_load_dwordx4 v15, s[12:15], s55 offen lds
    s_waitcnt vmcnt(18)
    s_barrier
    s_add_u32 m0, s54, 110592
    s_add_u32 s55, s53, 896
    buffer_load_dwordx4 v14, s[8:11], s55 offen lds
    s_add_u32 m0, s54, 114688
    s_add_u32 s55, s53, 99200
    buffer_load_dwordx4 v14, s[8:11], s55 offen lds
    s_add_u32 m0, s54, 118784
    s_add_u32 s55, s53, 2432
    buffer_load_dwordx4 v14, s[8:11], s55 offen lds
    s_add_u32 m0, s54, 122880
    s_add_u32 s55, s53, 100736
    buffer_load_dwordx4 v14, s[8:11], s55 offen lds
    s_add_u32 m0, s54, 126976
    s_add_u32 s55, s56, 896
    buffer_load_dwordx4 v15, s[12:15], s55 offen lds
    s_add_u32 m0, s54, 131072
    s_add_u32 s55, s56, 99200
    buffer_load_dwordx4 v15, s[12:15], s55 offen lds
    s_add_u32 m0, s54, 135168
    s_add_u32 s55, s64, 896
    buffer_load_dwordx4 v15, s[12:15], s55 offen lds
    s_add_u32 m0, s54, 139264
    s_add_u32 s55, s56, 51584
    buffer_load_dwordx4 v15, s[12:15], s55 offen lds
    s_add_u32 m0, s54, 143360
    s_add_u32 s55, s56, 149888
    buffer_load_dwordx4 v15, s[12:15], s55 offen lds
    s_waitcnt vmcnt(18)
    s_barrier
    s_add_u32 m0, s54, 0
    s_add_u32 s55, s53, 1024
    buffer_load_dwordx4 v14, s[8:11], s55 offen lds
    s_add_u32 m0, s54, 4096
    s_add_u32 s55, s53, 99328
    buffer_load_dwordx4 v14, s[8:11], s55 offen lds
    s_add_u32 m0, s54, 8192
    s_add_u32 s55, s53, 2560
    buffer_load_dwordx4 v14, s[8:11], s55 offen lds
    s_add_u32 m0, s54, 12288
    s_add_u32 s55, s53, 100864
    buffer_load_dwordx4 v14, s[8:11], s55 offen lds
    s_add_u32 m0, s54, 16384
    s_add_u32 s55, s56, 1024
    buffer_load_dwordx4 v15, s[12:15], s55 offen lds
    s_add_u32 m0, s54, 20480
    s_add_u32 s55, s56, 99328
    buffer_load_dwordx4 v15, s[12:15], s55 offen lds
    s_add_u32 m0, s54, 24576
    s_add_u32 s55, s64, 1024
    buffer_load_dwordx4 v15, s[12:15], s55 offen lds
    s_add_u32 m0, s54, 28672
    s_add_u32 s55, s56, 51712
    buffer_load_dwordx4 v15, s[12:15], s55 offen lds
    s_add_u32 m0, s54, 32768
    s_add_u32 s55, s56, 150016
    buffer_load_dwordx4 v15, s[12:15], s55 offen lds
    s_waitcnt vmcnt(18)
    s_barrier
    s_add_u32 m0, s54, 36864
    s_add_u32 s55, s53, 1152
    buffer_load_dwordx4 v14, s[8:11], s55 offen lds
    s_add_u32 m0, s54, 40960
    s_add_u32 s55, s53, 99456
    buffer_load_dwordx4 v14, s[8:11], s55 offen lds
    s_add_u32 m0, s54, 45056
    s_add_u32 s55, s53, 2688
    buffer_load_dwordx4 v14, s[8:11], s55 offen lds
    s_add_u32 m0, s54, 49152
    s_add_u32 s55, s53, 100992
    buffer_load_dwordx4 v14, s[8:11], s55 offen lds
    s_add_u32 m0, s54, 53248
    s_add_u32 s55, s56, 1152
    buffer_load_dwordx4 v15, s[12:15], s55 offen lds
    s_add_u32 m0, s54, 57344
    s_add_u32 s55, s56, 99456
    buffer_load_dwordx4 v15, s[12:15], s55 offen lds
    s_add_u32 m0, s54, 61440
    s_add_u32 s55, s64, 1152
    buffer_load_dwordx4 v15, s[12:15], s55 offen lds
    s_add_u32 m0, s54, 65536
    s_add_u32 s55, s56, 51840
    buffer_load_dwordx4 v15, s[12:15], s55 offen lds
    s_add_u32 m0, s54, 69632
    s_add_u32 s55, s56, 150144
    buffer_load_dwordx4 v15, s[12:15], s55 offen lds
    s_waitcnt vmcnt(18)
    s_barrier
    s_add_u32 m0, s54, 73728
    s_add_u32 s55, s53, 1280
    buffer_load_dwordx4 v14, s[8:11], s55 offen lds
    s_add_u32 m0, s54, 77824
    s_add_u32 s55, s53, 99584
    buffer_load_dwordx4 v14, s[8:11], s55 offen lds
    s_add_u32 m0, s54, 81920
    s_add_u32 s55, s53, 2816
    buffer_load_dwordx4 v14, s[8:11], s55 offen lds
    s_add_u32 m0, s54, 86016
    s_add_u32 s55, s53, 101120
    buffer_load_dwordx4 v14, s[8:11], s55 offen lds
    s_add_u32 m0, s54, 90112
    s_add_u32 s55, s56, 1280
    buffer_load_dwordx4 v15, s[12:15], s55 offen lds
    s_add_u32 m0, s54, 94208
    s_add_u32 s55, s56, 99584
    buffer_load_dwordx4 v15, s[12:15], s55 offen lds
    s_add_u32 m0, s54, 98304
    s_add_u32 s55, s64, 1280
    buffer_load_dwordx4 v15, s[12:15], s55 offen lds
    s_add_u32 m0, s54, 102400
    s_add_u32 s55, s56, 51968
    buffer_load_dwordx4 v15, s[12:15], s55 offen lds
    s_add_u32 m0, s54, 106496
    s_add_u32 s55, s56, 150272
    buffer_load_dwordx4 v15, s[12:15], s55 offen lds
    s_waitcnt vmcnt(18)
    s_barrier
    s_add_u32 m0, s54, 110592
    s_add_u32 s55, s53, 1408
    buffer_load_dwordx4 v14, s[8:11], s55 offen lds
    s_add_u32 m0, s54, 114688
    s_add_u32 s55, s53, 99712
    buffer_load_dwordx4 v14, s[8:11], s55 offen lds
    s_add_u32 m0, s54, 118784
    s_add_u32 s55, s53, 2944
    buffer_load_dwordx4 v14, s[8:11], s55 offen lds
    s_add_u32 m0, s54, 122880
    s_add_u32 s55, s53, 101248
    buffer_load_dwordx4 v14, s[8:11], s55 offen lds
    s_add_u32 m0, s54, 126976
    s_add_u32 s55, s56, 1408
    buffer_load_dwordx4 v15, s[12:15], s55 offen lds
    s_add_u32 m0, s54, 131072
    s_add_u32 s55, s56, 99712
    buffer_load_dwordx4 v15, s[12:15], s55 offen lds
    s_add_u32 m0, s54, 135168
    s_add_u32 s55, s64, 1408
    buffer_load_dwordx4 v15, s[12:15], s55 offen lds
    s_add_u32 m0, s54, 139264
    s_add_u32 s55, s56, 52096
    buffer_load_dwordx4 v15, s[12:15], s55 offen lds
    s_add_u32 m0, s54, 143360
    s_add_u32 s55, s56, 150400
    buffer_load_dwordx4 v15, s[12:15], s55 offen lds
    s_waitcnt vmcnt(18)
    s_barrier
    s_waitcnt vmcnt(9)
    s_barrier
    s_waitcnt vmcnt(0)
    s_barrier
    s_endpgm
.section .rodata,"a"
.p2align 6
.amdhsa_kernel k0_kernel
  .amdhsa_next_free_vgpr 124
  .amdhsa_next_free_sgpr 96
  .amdhsa_accum_offset 124
  .amdhsa_group_segment_fixed_size 0
  .amdhsa_kernarg_size 104
  .amdhsa_user_sgpr_count 2
  .amdhsa_user_sgpr_kernarg_segment_ptr 1
  .amdhsa_system_sgpr_workgroup_id_x 1
  .amdhsa_float_denorm_mode_32 3
.end_amdhsa_kernel
.p2align 6
.amdhsa_kernel l1_kernel
  .amdhsa_next_free_vgpr 227
  .amdhsa_next_free_sgpr 102
  .amdhsa_accum_offset 228
  .amdhsa_group_segment_fixed_size 0
  .amdhsa_kernarg_size 104
  .amdhsa_user_sgpr_count 2
  .amdhsa_user_sgpr_kernarg_segment_ptr 1
  .amdhsa_system_sgpr_workgroup_id_x 1
  .amdhsa_float_denorm_mode_32 3
.end_amdhsa_kernel
.p2align 6
.amdhsa_kernel l2_kernel
  .amdhsa_next_free_vgpr 233
  .amdhsa_next_free_sgpr 102
  .amdhsa_accum_offset 236
  .amdhsa_group_segment_fixed_size 0
  .amdhsa_kernarg_size 104
  .amdhsa_user_sgpr_count 2
  .amdhsa_user_sgpr_kernarg_segment_ptr 1
  .amdhsa_system_sgpr_workgroup_id_x 1
  .amdhsa_float_denorm_mode_32 3
.end_amdhsa_kernel
.p2align 6
.amdhsa_kernel l3_kernel
  .amdhsa_next_free_vgpr 179
  .amdhsa_next_free_sgpr 102
  .amdhsa_accum_offset 180
  .amdhsa_group_segment_fixed_size 0
  .amdhsa_kernarg_size 104
  .amdhsa_user_sgpr_count 2
  .amdhsa_user_sgpr_kernarg_segment_ptr 1
  .amdhsa_system_sgpr_workgroup_id_x 1
  .amdhsa_float_denorm_mode_32 3
.end_amdhsa_kernel
.p2align 6
.amdhsa_kernel l4_kernel
  .amdhsa_next_free_vgpr 208
  .amdhsa_next_free_sgpr 102
  .amdhsa_accum_offset 208
  .amdhsa_group_segment_fixed_size 0
  .amdhsa_kernarg_size 104
  .amdhsa_user_sgpr_count 2
  .amdhsa_user_sgpr_kernarg_segment_ptr 1
  .amdhsa_system_sgpr_workgroup_id_x 1
  .amdhsa_float_denorm_mode_32 3
.end_amdhsa_kernel
```
